```python
import torch

def _softmax(x, axis=-1):
    return torch.softmax(x, dim=axis)
def _gelu(x):
    return torch.nn.functional.gelu(x, approximate="tanh")
def _silu(x):
    return torch.nn.functional.silu(x)
def _sigmoid(x):
    return torch.sigmoid(x)
def _layernorm(x, axis=-1, eps=1e-5):
    m = x.mean(dim=axis, keepdim=True)
    v = x.var(dim=axis, keepdim=True, unbiased=False)
    return (x - m) / torch.sqrt(v + eps)
def _scatter_add(tgt, idx, src, axis=0):
    return tgt.clone().index_add_(axis, idx, src)
def _segment_sum(src, seg, n):
    out = torch.zeros((n,) + src.shape[1:], dtype=src.dtype)
    return out.index_add_(0, seg, src)
def _pad(x, pw):
    flat = tuple(v for pair in reversed(pw) for v in pair)
    return torch.nn.functional.pad(x, flat)

kernel_name = 'gated_mix__spectral_gfnet__dense_activation_silu__prompt'

def setup_inputs():

    _w = (lambda a: (lambda t: t.to(torch.bfloat16) if t.is_floating_point() else t)(torch.as_tensor(a)))
    def _A_setup():
        B, S, D = 1, 2048, 576
        Df = D // 2 + 1
        return {
            "x": _w((lambda *s: torch.randn(*s, dtype=torch.bfloat16) * 0.05)(B, S, D)),
            "w_r": _w((lambda *s: torch.randn(*s, dtype=torch.bfloat16) * 0.4)(S, Df) * 0.02),
            "w_i": _w((lambda *s: torch.randn(*s, dtype=torch.bfloat16) * 0.4)(S, Df) * 0.02),
        }
    _A_in = _A_setup()

    def _B_setup():
        B, S, D, F = 1, 2048, 576, 4608
        return {
            "x": _w((lambda *s: torch.randn(*s, dtype=torch.bfloat16) * 0.05)(B, S, D)),
            "w1": _w((lambda *s: torch.randn(*s, dtype=torch.bfloat16) * 3.2)(D, F) * (D ** -0.5)),
            "w2": _w((lambda *s: torch.randn(*s, dtype=torch.bfloat16) * 0.05)(F, D) * (F ** -0.5)),
        }
    _B_in = _B_setup()

    return {
        "A_x": _A_in["x"],
        "A_w_r": _A_in["w_r"],
        "A_w_i": _A_in["w_i"],
        "B_x": _B_in["x"],
        "B_w1": _B_in["w1"],
        "B_w2": _B_in["w2"],
        "gate_w": _w((lambda *s: torch.randn(*s, dtype=torch.bfloat16) * 0.05)(576) * 16.0),
    }

def reference(A_x, A_w_r, A_w_i, B_x, B_w1, B_w2, gate_w):
    def _A_ref(x, w_r, w_i):
        B, S, D = x.shape
        X = (lambda x, axes=(-2,-1): torch.fft.rfft2(x.float(), dim=axes))(x, axes=(-2, -1))
        W = w_r + 1j * w_i
        X = X * W
        y = (lambda x, s, axes=(-2,-1): torch.fft.irfft2(x, s=s, dim=axes).to(torch.bfloat16))(X, (S, D), axes=(-2, -1))
        return y

    def _B_ref(x, w1, w2):
        h = torch.einsum("bsd,df->bsf", x, w1)
        h = _silu(h)
        out = torch.einsum("bsf,fd->bsd", h, w2)
        return out

    x = A_x
    g = _sigmoid((x * gate_w).sum(-1, keepdims=True))
    a = _A_ref(x, A_w_r, A_w_i)
    b = _B_ref(x, B_w1, B_w2)
    return g * a + (1 - g) * b
```

```asm
; @launch grid=(256,1,1) block=(256,1,1) lds=163840
.amdgcn_target "amdgcn-amd-amdhsa--gfx950"
.text
.globl gated_mix__spectral_gfnet__dense_activation_silu__prompt_kernel
.p2align 8
.type gated_mix__spectral_gfnet__dense_activation_silu__prompt_kernel,@function
gated_mix__spectral_gfnet__dense_activation_silu__prompt_kernel:
s_cmp_ge_u32 s2, 256
s_cbranch_scc1 Lkf_end
s_load_dwordx8 s[76:83], s[0:1], 0
s_load_dwordx8 s[84:91], s[0:1], 32
s_load_dwordx4 s[92:95], s[0:1], 64
s_lshr_b32 s43, s2, 3
s_getpc_b64 s[66:67]
Lpc_gated_mix__spectral_gfnet__dense_activation_silu__prompt_kernel:
s_sub_u32 s66, s66, Lpc_gated_mix__spectral_gfnet__dense_activation_silu__prompt_kernel-gated_mix__spectral_gfnet__dense_activation_silu__prompt_kernel
s_subb_u32 s67, s67, 0
v_and_b32 v40, 31, v0
s_lshl_b32 s68, s43, 5
v_add_u32 v40, s68, v40
v_lshlrev_b32 v40, 6, v40
s_mov_b32 s68, Lkf_last-gated_mix__spectral_gfnet__dense_activation_silu__prompt_kernel-4
v_min_u32 v40, s68, v40
v_and_b32 v40, -4, v40
global_load_dword v39, v40, s[66:67]
v_and_b32 v1, 63, v0
v_lshrrev_b32 v2, 6, v0
s_bfe_u32 s37, s2, 65538
s_lshl_b32 s37, s37, 4
s_lshr_b32 s3, s2, 4
s_add_u32 s37, s37, s3
v_readfirstlane_b32 s38, v2
v_lshrrev_b32 v40, 3, v1
v_lshrrev_b32 v41, 1, v40
v_xor_b32 v41, v41, v1
v_and_b32 v41, 7, v41
v_lshl_add_u32 v40, v2, 4, v40
v_mul_u32_u24 v40, 36864, v40
v_lshl_add_u32 v28, v41, 4, v40
v_xor_b32 v41, 4, v41
v_lshl_add_u32 v29, v41, 4, v40
v_add_u32 v29, 293888, v29
s_mul_i32 s44, s37, 5
s_lshr_b32 s44, s44, 2
s_mul_i32 s3, s44, 57
s_lshr_b32 s3, s3, 9
s_mul_i32 s3, s3, 9
s_sub_u32 s44, s44, s3
s_mul_i32 s3, s37, 1152
s_lshl_b32 s43, s38, 11
s_mov_b32 s10, 2359296
s_mov_b32 s11, 0x20000
s_lshl_b32 s54, s44, 7
s_add_u32 s42, s54, s3
s_mov_b32 m0, s43
s_waitcnt lgkmcnt(0)
s_mov_b32 s8, s76
s_and_b32 s9, s77, 0xffff
buffer_load_dwordx4 v28, s[8:11], s42 offen lds
buffer_load_dwordx4 v29, s[8:11], s42 offen offset:1024 lds
s_add_u32 s45, s44, 1
s_cmp_eq_u32 s45, 9
s_cselect_b32 s45, 0, s45
s_lshl_b32 s55, s45, 7
s_add_u32 s42, s55, s3
s_add_u32 m0, s43, 8192
s_nop 0
buffer_load_dwordx4 v28, s[8:11], s42 offen lds
buffer_load_dwordx4 v29, s[8:11], s42 offen offset:1024 lds
s_add_u32 s46, s45, 1
s_cmp_eq_u32 s46, 9
s_cselect_b32 s46, 0, s46
s_lshl_b32 s56, s46, 7
s_add_u32 s42, s56, s3
s_add_u32 m0, s43, 16384
s_nop 0
buffer_load_dwordx4 v28, s[8:11], s42 offen lds
buffer_load_dwordx4 v29, s[8:11], s42 offen offset:1024 lds
s_add_u32 s47, s46, 1
s_cmp_eq_u32 s47, 9
s_cselect_b32 s47, 0, s47
s_lshl_b32 s57, s47, 7
s_add_u32 s42, s57, s3
s_add_u32 m0, s43, 24576
s_nop 0
buffer_load_dwordx4 v28, s[8:11], s42 offen lds
buffer_load_dwordx4 v29, s[8:11], s42 offen offset:1024 lds
s_add_u32 s48, s47, 1
s_cmp_eq_u32 s48, 9
s_cselect_b32 s48, 0, s48
s_lshl_b32 s58, s48, 7
s_add_u32 s42, s58, s3
s_add_u32 m0, s43, 32768
s_nop 0
buffer_load_dwordx4 v28, s[8:11], s42 offen lds
buffer_load_dwordx4 v29, s[8:11], s42 offen offset:1024 lds
s_add_u32 s49, s48, 1
s_cmp_eq_u32 s49, 9
s_cselect_b32 s49, 0, s49
s_lshl_b32 s59, s49, 7
s_add_u32 s42, s59, s3
s_add_u32 m0, s43, 40960
s_nop 0
buffer_load_dwordx4 v28, s[8:11], s42 offen lds
buffer_load_dwordx4 v29, s[8:11], s42 offen offset:1024 lds
s_add_u32 s50, s49, 1
s_cmp_eq_u32 s50, 9
s_cselect_b32 s50, 0, s50
s_lshl_b32 s60, s50, 7
s_add_u32 s42, s60, s3
s_add_u32 m0, s43, 49152
s_nop 0
buffer_load_dwordx4 v28, s[8:11], s42 offen lds
buffer_load_dwordx4 v29, s[8:11], s42 offen offset:1024 lds
s_add_u32 s51, s50, 1
s_cmp_eq_u32 s51, 9
s_cselect_b32 s51, 0, s51
s_lshl_b32 s61, s51, 7
s_add_u32 s42, s61, s3
s_add_u32 m0, s43, 57344
s_nop 0
buffer_load_dwordx4 v28, s[8:11], s42 offen lds
buffer_load_dwordx4 v29, s[8:11], s42 offen offset:1024 lds
s_add_u32 s52, s51, 1
s_cmp_eq_u32 s52, 9
s_cselect_b32 s52, 0, s52
s_lshl_b32 s62, s52, 7
s_add_u32 s42, s62, s3
s_add_u32 m0, s43, 65536
s_nop 0
buffer_load_dwordx4 v28, s[8:11], s42 offen lds
buffer_load_dwordx4 v29, s[8:11], s42 offen offset:1024 lds
s_mov_b32 s4, s94
s_and_b32 s5, s95, 0xffff
s_mov_b32 s6, 33554432
s_mov_b32 s7, 0x20000
s_mov_b64 s[72:73], s[92:93]
s_mov_b64 s[12:13], s[84:85]
s_mov_b64 s[16:17], s[86:87]
s_mov_b64 s[20:21], s[78:79]
s_mov_b64 s[24:25], s[80:81]
s_mov_b64 s[32:33], s[90:91]
s_mov_b64 s[68:69], s[88:89]
s_and_b32 s36, s2, 3
s_lshl_b32 s36, s36, 1
s_bfe_u32 s3, s2, 65539
s_add_u32 s36, s36, s3
s_lshl_b32 s28, s36, 1
s_add_u32 s28, s28, s38
s_cmp_lt_u32 s38, 2
s_cselect_b32 s29, 1, 0
s_and_b32 s3, s36, 6
s_lshl_b32 s3, s3, 2
s_add_u32 s3, s3, s38
s_cmp_eq_u32 s3, 10
s_cselect_b32 s29, 1, s29
s_add_u32 s3, s36, 14
s_cmp_eq_u32 s38, 2
s_cselect_b32 s28, s3, s28
v_lshrrev_b32 v40, 5, v1
v_bfe_u32 v41, v1, 1, 3
v_xor_b32 v41, v41, v40
v_and_b32 v42, 31, v1
v_lshlrev_b32 v42, 7, v42
s_mov_b32 s100, 7456541
s_movk_i32 s101, 576
v_xor_b32 v43, 0, v41
v_lshl_add_u32 v96, v43, 4, v42
v_xor_b32 v43, 2, v41
v_lshl_add_u32 v97, v43, 4, v42
v_xor_b32 v43, 4, v41
v_lshl_add_u32 v98, v43, 4, v42
v_xor_b32 v43, 6, v41
v_lshl_add_u32 v99, v43, 4, v42
s_cmp_eq_u32 s29, 0
s_cbranch_scc1 Lkf_notask
v_and_b32 v57, 15, v1
s_lshl_b32 s3, s28, 4
v_add_u32 v57, s3, v57
v_bfe_u32 v59, v1, 4, 1
v_cvt_f32_u32 v58, v59
v_mul_f32 v58, 0.25, v58
v_lshl_add_u32 v59, v57, 1, v59
v_cmp_eq_u32 vcc, 1, v59
v_mov_b32 v59, 288
s_nop 0
v_cndmask_b32 v57, v57, v59, vcc
v_mov_b32 v59, 0
v_cndmask_b32 v58, v58, v59, vcc
s_lshr_b32 s3, s54, 1
v_lshl_add_u32 v59, v40, 3, s3
v_mul_u32_u24 v59, v59, v57
v_mul_hi_u32 v69, v59, s100
v_mul_u32_u24 v69, s101, v69
v_sub_u32 v69, v59, v69
v_cvt_f32_u32 v69, v69
v_fmamk_f32 v69, v69, 0x3ae38e39, v58
v_cvt_f32_u32 v68, v57
v_mul_f32 v68, 0x3ae38e39, v68
v_mul_f32 v56, 0x41800000, v68
v_fmamk_f32 v40, v68, 0x00000000, v69
v_fmamk_f32 v41, v68, 0x3f800000, v69
v_fmamk_f32 v42, v68, 0x40000000, v69
v_fmamk_f32 v43, v68, 0x40400000, v69
v_fmamk_f32 v44, v68, 0x40800000, v69
v_fmamk_f32 v45, v68, 0x40a00000, v69
v_fmamk_f32 v46, v68, 0x40c00000, v69
v_fmamk_f32 v47, v68, 0x40e00000, v69
v_fmamk_f32 v48, v68, 0x41800000, v69
v_fmamk_f32 v49, v68, 0x41880000, v69
v_fmamk_f32 v50, v68, 0x41900000, v69
v_fmamk_f32 v51, v68, 0x41980000, v69
v_fmamk_f32 v52, v68, 0x41a00000, v69
v_fmamk_f32 v53, v68, 0x41a80000, v69
v_fmamk_f32 v54, v68, 0x41b00000, v69
v_fmamk_f32 v55, v68, 0x41b80000, v69
v_cos_f32 v56, v56
v_cos_f32 v40, v40
v_cos_f32 v41, v41
v_cos_f32 v42, v42
v_cos_f32 v43, v43
v_cos_f32 v44, v44
v_cos_f32 v45, v45
v_cos_f32 v46, v46
v_cos_f32 v47, v47
v_cos_f32 v48, v48
v_cos_f32 v49, v49
v_cos_f32 v50, v50
v_cos_f32 v51, v51
v_cos_f32 v52, v52
v_cos_f32 v53, v53
v_cos_f32 v54, v54
v_cos_f32 v55, v55
v_add_f32 v56, v56, v56
v_cvt_pk_bf16_f32 v60, v40, v41
v_cvt_pk_bf16_f32 v61, v42, v43
v_cvt_pk_bf16_f32 v62, v44, v45
v_cvt_pk_bf16_f32 v63, v46, v47
v_cvt_pk_bf16_f32 v64, v48, v49
v_cvt_pk_bf16_f32 v65, v50, v51
v_cvt_pk_bf16_f32 v66, v52, v53
v_cvt_pk_bf16_f32 v67, v54, v55
s_waitcnt vmcnt(12)
s_barrier
ds_read_b128 a[0:3], v96 offset:0
ds_read_b128 a[4:7], v96 offset:4096
ds_read_b128 a[8:11], v97 offset:0
ds_read_b128 a[12:15], v97 offset:4096
ds_read_b128 a[16:19], v98 offset:0
ds_read_b128 a[20:23], v98 offset:4096
ds_read_b128 a[24:27], v99 offset:0
ds_read_b128 a[28:31], v99 offset:4096
ds_read_b128 a[32:35], v96 offset:8192
ds_read_b128 a[36:39], v96 offset:12288
ds_read_b128 a[40:43], v97 offset:8192
ds_read_b128 a[44:47], v97 offset:12288
s_waitcnt lgkmcnt(9)
v_mfma_f32_32x32x16_bf16 v[160:175], a[0:3], v[60:63], 0
v_fma_f32 v40, v56, v48, -v40
v_fma_f32 v41, v56, v49, -v41
v_fma_f32 v42, v56, v50, -v42
v_fma_f32 v43, v56, v51, -v43
v_fma_f32 v44, v56, v52, -v44
v_fma_f32 v45, v56, v53, -v45
s_mul_i32 s40, s37, 57
s_lshr_b32 s40, s40, 9
s_mul_i32 s40, s40, 9
s_sub_u32 s40, s37, s40
s_mul_i32 s41, s38, 20480
s_add_u32 s41, s41, 73728
v_mfma_f32_32x32x16_bf16 v[160:175], a[8:11], v[64:67], v[160:175]
v_fma_f32 v46, v56, v54, -v46
v_fma_f32 v47, v56, v55, -v47
v_cvt_pk_bf16_f32 v108, v40, v41
v_cvt_pk_bf16_f32 v109, v42, v43
v_cvt_pk_bf16_f32 v110, v44, v45
v_cvt_pk_bf16_f32 v111, v46, v47
s_mul_i32 s3, s36, 1152
s_add_u32 s12, s12, s3
s_addc_u32 s13, s13, 0
s_and_b32 s13, s13, 0xffff
s_mov_b32 s14, 0
s_waitcnt lgkmcnt(8)
v_mfma_f32_32x32x16_bf16 v[176:191], a[4:7], v[60:63], 0
v_fma_f32 v48, v56, v40, -v48
v_fma_f32 v49, v56, v41, -v49
v_fma_f32 v50, v56, v42, -v50
v_fma_f32 v51, v56, v43, -v51
v_fma_f32 v52, v56, v44, -v52
v_fma_f32 v53, v56, v45, -v53
s_mov_b32 s15, 0x20000
s_sub_u32 s14, 5308416, s3
s_mul_i32 s44, s44, 589824
s_mul_i32 s45, s45, 589824
s_mul_i32 s46, s46, 589824
v_mfma_f32_32x32x16_bf16 v[176:191], a[12:15], v[64:67], v[176:191]
v_fma_f32 v54, v56, v46, -v54
v_fma_f32 v55, v56, v47, -v55
v_cvt_pk_bf16_f32 v112, v48, v49
v_cvt_pk_bf16_f32 v113, v50, v51
v_cvt_pk_bf16_f32 v114, v52, v53
v_cvt_pk_bf16_f32 v115, v54, v55
s_mul_i32 s47, s47, 589824
s_mul_i32 s48, s48, 589824
s_mul_i32 s49, s49, 589824
s_mul_i32 s50, s50, 589824
s_mul_i32 s51, s51, 589824
s_mul_i32 s52, s52, 589824
ds_read_b128 a[48:51], v98 offset:8192
ds_read_b128 a[52:55], v98 offset:12288
ds_read_b128 a[56:59], v99 offset:8192
ds_read_b128 a[60:63], v99 offset:12288
s_waitcnt lgkmcnt(9)
v_mfma_f32_32x32x16_bf16 v[160:175], a[16:19], v[108:111], v[160:175]
v_fma_f32 v40, v56, v48, -v40
v_fma_f32 v41, v56, v49, -v41
v_fma_f32 v42, v56, v50, -v42
v_fma_f32 v43, v56, v51, -v43
v_fma_f32 v44, v56, v52, -v44
v_fma_f32 v45, v56, v53, -v45
s_add_u32 s65, 8, s40
s_sub_u32 s3, s65, 9
s_cmp_ge_u32 s65, 9
s_cselect_b32 s65, s3, s65
s_lshl_b32 s97, s65, 7
v_mfma_f32_32x32x16_bf16 v[160:175], a[24:27], v[112:115], v[160:175]
v_fma_f32 v46, v56, v54, -v46
v_fma_f32 v47, v56, v55, -v47
v_cvt_pk_bf16_f32 v60, v40, v41
v_cvt_pk_bf16_f32 v61, v42, v43
v_cvt_pk_bf16_f32 v62, v44, v45
v_cvt_pk_bf16_f32 v63, v46, v47
s_mul_i32 s3, s38, 147456
s_add_u32 s65, s97, s3
s_lshl_b32 s66, s38, 1
s_add_u32 s63, s66, s40
s_sub_u32 s3, s63, 9
s_waitcnt lgkmcnt(8)
v_mfma_f32_32x32x16_bf16 v[176:191], a[20:23], v[108:111], v[176:191]
v_fma_f32 v48, v56, v40, -v48
v_fma_f32 v49, v56, v41, -v49
v_fma_f32 v50, v56, v42, -v50
v_fma_f32 v51, v56, v43, -v51
v_fma_f32 v52, v56, v44, -v52
v_fma_f32 v53, v56, v45, -v53
s_cmp_ge_u32 s63, 9
s_cselect_b32 s63, s3, s63
s_add_u32 s66, s66, 1
s_add_u32 s64, s66, s40
s_sub_u32 s3, s64, 9
s_cmp_ge_u32 s64, 9
v_mfma_f32_32x32x16_bf16 v[176:191], a[28:31], v[112:115], v[176:191]
v_fma_f32 v54, v56, v46, -v54
v_fma_f32 v55, v56, v47, -v55
v_cvt_pk_bf16_f32 v64, v48, v49
v_cvt_pk_bf16_f32 v65, v50, v51
v_cvt_pk_bf16_f32 v66, v52, v53
v_cvt_pk_bf16_f32 v67, v54, v55
s_cselect_b32 s64, s3, s64
s_lshl_b32 s63, s63, 7
s_lshl_b32 s64, s64, 7
v_lshrrev_b32 v69, 3, v1
v_bfe_u32 v70, v1, 4, 1
ds_read_b128 a[64:67], v96 offset:16384
ds_read_b128 a[68:71], v96 offset:20480
ds_read_b128 a[72:75], v97 offset:16384
ds_read_b128 a[76:79], v97 offset:20480
s_waitcnt lgkmcnt(9)
v_mfma_f32_32x32x16_bf16 v[160:175], a[32:35], v[60:63], v[160:175]
v_fma_f32 v40, v56, v48, -v40
v_fma_f32 v41, v56, v49, -v41
v_fma_f32 v42, v56, v50, -v42
v_fma_f32 v43, v56, v51, -v43
v_fma_f32 v44, v56, v52, -v44
v_fma_f32 v45, v56, v53, -v45
v_lshlrev_b32 v70, 2, v70
v_xor_b32 v70, v70, v1
v_and_b32 v70, 7, v70
v_lshlrev_b32 v70, 4, v70
v_mul_u32_u24 v4, 9216, v69
v_mfma_f32_32x32x16_bf16 v[160:175], a[40:43], v[64:67], v[160:175]
v_fma_f32 v46, v56, v54, -v46
v_fma_f32 v47, v56, v55, -v47
v_cvt_pk_bf16_f32 v108, v40, v41
v_cvt_pk_bf16_f32 v109, v42, v43
v_cvt_pk_bf16_f32 v110, v44, v45
v_cvt_pk_bf16_f32 v111, v46, v47
v_add_u32 v4, v4, v70
v_add_u32 v5, 72704, v4
v_mul_u32_u24 v6, 1152, v69
v_add_u32 v6, v6, v70
v_add_u32 v7, 8192, v6
s_waitcnt lgkmcnt(8)
v_mfma_f32_32x32x16_bf16 v[176:191], a[36:39], v[60:63], v[176:191]
v_fma_f32 v48, v56, v40, -v48
v_fma_f32 v49, v56, v41, -v49
v_fma_f32 v50, v56, v42, -v50
v_fma_f32 v51, v56, v43, -v51
v_fma_f32 v52, v56, v44, -v52
v_fma_f32 v53, v56, v45, -v53
s_and_b32 s3, s38, 1
s_lshl_b32 s75, s36, 1
s_add_u32 s75, s75, s3
v_mfma_f32_32x32x16_bf16 v[176:191], a[44:47], v[64:67], v[176:191]
v_fma_f32 v54, v56, v46, -v54
v_fma_f32 v55, v56, v47, -v55
v_cvt_pk_bf16_f32 v112, v48, v49
v_cvt_pk_bf16_f32 v113, v50, v51
v_cvt_pk_bf16_f32 v114, v52, v53
v_cvt_pk_bf16_f32 v115, v54, v55
s_mov_b32 s74, s37
s_lshr_b32 s30, s38, 1
ds_read_b128 a[80:83], v98 offset:16384
ds_read_b128 a[84:87], v98 offset:20480
ds_read_b128 a[88:91], v99 offset:16384
ds_read_b128 a[92:95], v99 offset:20480
s_waitcnt lgkmcnt(9)
v_mfma_f32_32x32x16_bf16 v[160:175], a[48:51], v[108:111], v[160:175]
v_fma_f32 v40, v56, v48, -v40
v_fma_f32 v41, v56, v49, -v41
v_fma_f32 v42, v56, v50, -v42
v_fma_f32 v43, v56, v51, -v43
v_fma_f32 v44, v56, v52, -v44
v_fma_f32 v45, v56, v53, -v45
s_and_b32 s3, s36, 6
s_lshl_b32 s3, s3, 2
v_mfma_f32_32x32x16_bf16 v[160:175], a[56:59], v[112:115], v[160:175]
v_fma_f32 v46, v56, v54, -v46
v_fma_f32 v47, v56, v55, -v47
v_cvt_pk_bf16_f32 v60, v40, v41
v_cvt_pk_bf16_f32 v61, v42, v43
v_cvt_pk_bf16_f32 v62, v44, v45
v_cvt_pk_bf16_f32 v63, v46, v47
s_add_u32 s3, s3, s38
s_add_u32 s66, s36, 10
s_waitcnt lgkmcnt(8)
v_mfma_f32_32x32x16_bf16 v[176:191], a[52:55], v[108:111], v[176:191]
v_fma_f32 v48, v56, v40, -v48
v_fma_f32 v49, v56, v41, -v49
v_fma_f32 v50, v56, v42, -v50
v_fma_f32 v51, v56, v43, -v51
v_fma_f32 v52, v56, v44, -v52
v_fma_f32 v53, v56, v45, -v53
s_cmp_eq_u32 s3, 24
s_cselect_b32 s75, s66, s75
s_cselect_b32 s30, 1, s30
s_lshl_b32 s3, s36, 2
v_mfma_f32_32x32x16_bf16 v[176:191], a[60:63], v[112:115], v[176:191]
v_fma_f32 v54, v56, v46, -v54
v_fma_f32 v55, v56, v47, -v55
v_cvt_pk_bf16_f32 v64, v48, v49
v_cvt_pk_bf16_f32 v65, v50, v51
v_cvt_pk_bf16_f32 v66, v52, v53
v_cvt_pk_bf16_f32 v67, v54, v55
s_add_u32 s3, s3, s38
s_cmp_eq_u32 s3, 5
s_cselect_b32 s3, s37, 99
s_waitcnt vmcnt(0)
s_barrier
ds_read_b128 a[96:99], v96 offset:24576
ds_read_b128 a[100:103], v96 offset:28672
ds_read_b128 a[104:107], v97 offset:24576
ds_read_b128 a[108:111], v97 offset:28672
s_waitcnt lgkmcnt(9)
v_mfma_f32_32x32x16_bf16 v[160:175], a[64:67], v[60:63], v[160:175]
v_fma_f32 v40, v56, v48, -v40
v_fma_f32 v41, v56, v49, -v41
v_fma_f32 v42, v56, v50, -v42
v_fma_f32 v43, v56, v51, -v43
v_fma_f32 v44, v56, v52, -v44
v_fma_f32 v45, v56, v53, -v45
s_cmp_lt_u32 s3, 18
s_cselect_b32 s75, s37, s75
s_cselect_b32 s74, 32, s74
s_cselect_b32 s30, 1, s30
s_and_b32 s21, s21, 0xffff
v_mfma_f32_32x32x16_bf16 v[160:175], a[72:75], v[64:67], v[160:175]
v_fma_f32 v46, v56, v54, -v46
v_fma_f32 v47, v56, v55, -v47
v_cvt_pk_bf16_f32 v108, v40, v41
v_cvt_pk_bf16_f32 v109, v42, v43
v_cvt_pk_bf16_f32 v110, v44, v45
v_cvt_pk_bf16_f32 v111, v46, v47
s_mov_b32 s22, 1183744
s_mov_b32 s23, 0x20000
s_waitcnt lgkmcnt(8)
v_mfma_f32_32x32x16_bf16 v[176:191], a[68:71], v[60:63], v[176:191]
v_fma_f32 v48, v56, v40, -v48
v_fma_f32 v49, v56, v41, -v49
v_fma_f32 v50, v56, v42, -v50
v_fma_f32 v51, v56, v43, -v51
v_fma_f32 v52, v56, v44, -v52
v_fma_f32 v53, v56, v45, -v53
s_and_b32 s25, s25, 0xffff
s_mov_b32 s26, 1183744
v_mfma_f32_32x32x16_bf16 v[176:191], a[76:79], v[64:67], v[176:191]
v_fma_f32 v54, v56, v46, -v54
v_fma_f32 v55, v56, v47, -v55
v_cvt_pk_bf16_f32 v112, v48, v49
v_cvt_pk_bf16_f32 v113, v50, v51
v_cvt_pk_bf16_f32 v114, v52, v53
v_cvt_pk_bf16_f32 v115, v54, v55
s_mov_b32 s27, 0x20000
s_cmp_eq_u32 s30, 1
s_cbranch_scc0 Lsk_wl_1
v_lshrrev_b32 v104, 1, v1
v_lshl_add_u32 v104, v104, 6, s74
v_sub_u32 v105, 2048, v104
v_and_b32 v105, 2047, v105
v_and_b32 v106, 1, v1
v_lshlrev_b32 v106, 4, v106
s_movk_i32 s67, 578
v_mad_u32_u24 v104, v104, s67, v106
v_mad_u32_u24 v105, v105, s67, v106
s_lshl_b32 s67, s75, 5
buffer_load_dwordx4 v[32:35], v104, s[20:23], s67 offen
buffer_load_dwordx4 v[36:39], v104, s[24:27], s67 offen
buffer_load_dwordx4 v[88:91], v105, s[20:23], s67 offen
buffer_load_dwordx4 v[92:95], v105, s[24:27], s67 offen
s_sub_u32 s3, s30, 1
s_or_b32 s3, s3, s75
s_cbranch_scc1 Lsk_g0l_2
v_and_b32 v104, 31, v1
v_lshlrev_b32 v104, 6, v104
v_add_u32 v104, s74, v104
v_sub_u32 v105, 2048, v104
v_and_b32 v105, 2047, v105
v_mul_u32_u24 v104, 578, v104
v_mul_u32_u24 v105, 578, v105
buffer_load_ushort v128, v104, s[20:23], 0 offen offset:0
buffer_load_ushort v129, v104, s[24:27], 0 offen offset:0
buffer_load_ushort v130, v105, s[20:23], 0 offen offset:0
buffer_load_ushort v131, v105, s[24:27], 0 offen offset:0
buffer_load_ushort v132, v104, s[20:23], 0 offen offset:576
buffer_load_ushort v133, v104, s[24:27], 0 offen offset:576
buffer_load_ushort v134, v105, s[20:23], 0 offen offset:576
buffer_load_ushort v135, v105, s[24:27], 0 offen offset:576
Lsk_g0l_2:
Lsk_wl_1:
ds_read_b128 a[112:115], v98 offset:24576
ds_read_b128 a[116:119], v98 offset:28672
ds_read_b128 a[120:123], v99 offset:24576
ds_read_b128 a[124:127], v99 offset:28672
s_waitcnt lgkmcnt(9)
v_mfma_f32_32x32x16_bf16 v[160:175], a[80:83], v[108:111], v[160:175]
v_fma_f32 v40, v56, v48, -v40
v_fma_f32 v41, v56, v49, -v41
v_fma_f32 v42, v56, v50, -v42
v_fma_f32 v43, v56, v51, -v43
v_fma_f32 v44, v56, v52, -v44
v_fma_f32 v45, v56, v53, -v45
v_bfe_u32 v124, v1, 2, 2
v_lshlrev_b32 v125, 7, v124
v_mfma_f32_32x32x16_bf16 v[160:175], a[88:91], v[112:115], v[160:175]
v_fma_f32 v46, v56, v54, -v46
v_fma_f32 v47, v56, v55, -v47
v_cvt_pk_bf16_f32 v60, v40, v41
v_cvt_pk_bf16_f32 v61, v42, v43
v_cvt_pk_bf16_f32 v62, v44, v45
v_cvt_pk_bf16_f32 v63, v46, v47
v_lshrrev_b32 v124, 1, v124
v_lshl_add_u32 v125, v124, 6, v125
s_waitcnt lgkmcnt(8)
v_mfma_f32_32x32x16_bf16 v[176:191], a[84:87], v[108:111], v[176:191]
v_fma_f32 v48, v56, v40, -v48
v_fma_f32 v49, v56, v41, -v49
v_fma_f32 v50, v56, v42, -v50
v_fma_f32 v51, v56, v43, -v51
v_fma_f32 v52, v56, v44, -v52
v_fma_f32 v53, v56, v45, -v53
v_bfe_u32 v124, v1, 4, 1
v_lshl_add_u32 v125, v124, 5, v125
v_mfma_f32_32x32x16_bf16 v[176:191], a[92:95], v[112:115], v[176:191]
v_fma_f32 v54, v56, v46, -v54
v_fma_f32 v55, v56, v47, -v55
v_cvt_pk_bf16_f32 v64, v48, v49
v_cvt_pk_bf16_f32 v65, v50, v51
v_cvt_pk_bf16_f32 v66, v52, v53
v_cvt_pk_bf16_f32 v67, v54, v55
v_add_u32 v125, s41, v125
v_and_b32 v8, 3, v1
ds_read_b128 a[128:131], v96 offset:32768
ds_read_b128 a[132:135], v96 offset:36864
ds_read_b128 a[136:139], v97 offset:32768
ds_read_b128 a[140:143], v97 offset:36864
s_waitcnt lgkmcnt(9)
v_mfma_f32_32x32x16_bf16 v[160:175], a[96:99], v[60:63], v[160:175]
v_fma_f32 v40, v56, v48, -v40
v_fma_f32 v41, v56, v49, -v41
v_fma_f32 v42, v56, v50, -v42
v_fma_f32 v43, v56, v51, -v43
v_fma_f32 v44, v56, v52, -v44
v_fma_f32 v45, v56, v53, -v45
v_lshl_add_u32 v8, v8, 3, v125
v_and_b32 v124, 1, v1
v_mfma_f32_32x32x16_bf16 v[160:175], a[104:107], v[64:67], v[160:175]
v_fma_f32 v46, v56, v54, -v46
v_fma_f32 v47, v56, v55, -v47
v_cvt_pk_bf16_f32 v108, v40, v41
v_cvt_pk_bf16_f32 v109, v42, v43
v_cvt_pk_bf16_f32 v110, v44, v45
v_cvt_pk_bf16_f32 v111, v46, v47
v_lshl_add_u32 v125, v124, 4, v125
v_bfe_u32 v124, v1, 1, 1
s_waitcnt lgkmcnt(8)
v_mfma_f32_32x32x16_bf16 v[176:191], a[100:103], v[60:63], v[176:191]
v_fma_f32 v48, v56, v40, -v48
v_fma_f32 v49, v56, v41, -v49
v_fma_f32 v50, v56, v42, -v50
v_fma_f32 v51, v56, v43, -v51
v_fma_f32 v52, v56, v44, -v52
v_fma_f32 v53, v56, v45, -v53
v_lshl_add_u32 v125, v124, 3, v125
v_lshrrev_b32 v124, 5, v1
v_mfma_f32_32x32x16_bf16 v[176:191], a[108:111], v[64:67], v[176:191]
v_fma_f32 v54, v56, v46, -v54
v_fma_f32 v55, v56, v47, -v55
v_cvt_pk_bf16_f32 v112, v48, v49
v_cvt_pk_bf16_f32 v113, v50, v51
v_cvt_pk_bf16_f32 v114, v52, v53
v_cvt_pk_bf16_f32 v115, v54, v55
v_lshl_add_u32 v8, v124, 10, v8
v_xor_b32 v9, 64, v8
ds_read_b128 a[144:147], v98 offset:32768
ds_read_b128 a[148:151], v98 offset:36864
ds_read_b128 a[152:155], v99 offset:32768
ds_read_b128 a[156:159], v99 offset:36864
s_waitcnt lgkmcnt(9)
v_mfma_f32_32x32x16_bf16 v[160:175], a[112:115], v[108:111], v[160:175]
v_fma_f32 v40, v56, v48, -v40
v_fma_f32 v41, v56, v49, -v41
v_fma_f32 v42, v56, v50, -v42
v_fma_f32 v43, v56, v51, -v43
v_fma_f32 v44, v56, v52, -v44
v_fma_f32 v45, v56, v53, -v45
s_add_u32 m0, s41, 0
s_add_u32 s42, s44, s65
buffer_load_dwordx4 v4, s[12:15], s42 offen lds
v_lshl_add_u32 v10, v124, 9, v125
v_xor_b32 v11, 64, v10
v_mfma_f32_32x32x16_bf16 v[160:175], a[120:123], v[112:115], v[160:175]
v_fma_f32 v46, v56, v54, -v46
v_fma_f32 v47, v56, v55, -v47
v_cvt_pk_bf16_f32 v60, v40, v41
v_cvt_pk_bf16_f32 v61, v42, v43
v_cvt_pk_bf16_f32 v62, v44, v45
v_cvt_pk_bf16_f32 v63, v46, v47
v_lshlrev_b32 v12, 4, v1
v_add_u32 v28, 155648, v12
s_waitcnt lgkmcnt(8)
v_mfma_f32_32x32x16_bf16 v[176:191], a[116:119], v[108:111], v[176:191]
v_fma_f32 v48, v56, v40, -v48
v_fma_f32 v49, v56, v41, -v49
v_fma_f32 v50, v56, v42, -v50
v_fma_f32 v51, v56, v43, -v51
v_fma_f32 v52, v56, v44, -v52
v_fma_f32 v53, v56, v45, -v53
buffer_load_dwordx4 v5, s[12:15], s42 offen offset:1024 lds
v_add_u32 v100, 0x10000, v96
v_add_u32 v101, 0x10000, v97
v_mfma_f32_32x32x16_bf16 v[176:191], a[124:127], v[112:115], v[176:191]
v_fma_f32 v54, v56, v46, -v54
v_fma_f32 v55, v56, v47, -v55
v_cvt_pk_bf16_f32 v64, v48, v49
v_cvt_pk_bf16_f32 v65, v50, v51
v_cvt_pk_bf16_f32 v66, v52, v53
v_cvt_pk_bf16_f32 v67, v54, v55
v_add_u32 v102, 0x10000, v98
v_add_u32 v103, 0x10000, v99
ds_read_b128 a[160:163], v96 offset:40960
ds_read_b128 a[164:167], v96 offset:45056
ds_read_b128 a[168:171], v97 offset:40960
ds_read_b128 a[172:175], v97 offset:45056
s_waitcnt lgkmcnt(9)
v_mfma_f32_32x32x16_bf16 v[160:175], a[128:131], v[60:63], v[160:175]
v_fma_f32 v40, v56, v48, -v40
v_fma_f32 v41, v56, v49, -v41
v_fma_f32 v42, v56, v50, -v42
v_fma_f32 v43, v56, v51, -v43
v_fma_f32 v44, v56, v52, -v44
v_fma_f32 v45, v56, v53, -v45
s_add_u32 m0, s41, 2048
s_add_u32 s42, s45, s65
buffer_load_dwordx4 v4, s[12:15], s42 offen lds
v_mfma_f32_32x32x16_bf16 v[160:175], a[136:139], v[64:67], v[160:175]
v_fma_f32 v46, v56, v54, -v46
v_fma_f32 v47, v56, v55, -v47
v_cvt_pk_bf16_f32 v108, v40, v41
v_cvt_pk_bf16_f32 v109, v42, v43
v_cvt_pk_bf16_f32 v110, v44, v45
v_cvt_pk_bf16_f32 v111, v46, v47
s_waitcnt lgkmcnt(8)
v_mfma_f32_32x32x16_bf16 v[176:191], a[132:135], v[60:63], v[176:191]
v_fma_f32 v48, v56, v40, -v48
v_fma_f32 v49, v56, v41, -v49
v_fma_f32 v50, v56, v42, -v50
v_fma_f32 v51, v56, v43, -v51
v_fma_f32 v52, v56, v44, -v52
v_fma_f32 v53, v56, v45, -v53
buffer_load_dwordx4 v5, s[12:15], s42 offen offset:1024 lds
v_mfma_f32_32x32x16_bf16 v[176:191], a[140:143], v[64:67], v[176:191]
v_fma_f32 v54, v56, v46, -v54
v_fma_f32 v55, v56, v47, -v55
v_cvt_pk_bf16_f32 v112, v48, v49
v_cvt_pk_bf16_f32 v113, v50, v51
v_cvt_pk_bf16_f32 v114, v52, v53
v_cvt_pk_bf16_f32 v115, v54, v55
s_barrier
ds_read_b128 v[192:195], v28 offset:0
ds_read_b128 v[196:199], v28 offset:1024
ds_read_b128 v[200:203], v28 offset:2048
ds_read_b128 v[204:207], v28 offset:3072
ds_read_b128 v[208:211], v28 offset:4096
ds_read_b128 v[212:215], v28 offset:5120
ds_read_b128 v[216:219], v28 offset:6144
ds_read_b128 v[220:223], v28 offset:7168
ds_read_b128 a[176:179], v98 offset:40960
ds_read_b128 a[180:183], v98 offset:45056
ds_read_b128 a[184:187], v99 offset:40960
ds_read_b128 a[188:191], v99 offset:45056
s_waitcnt lgkmcnt(15)
v_mfma_f32_32x32x16_bf16 v[160:175], a[144:147], v[108:111], v[160:175]
v_fma_f32 v40, v56, v48, -v40
v_fma_f32 v41, v56, v49, -v41
v_fma_f32 v42, v56, v50, -v42
v_fma_f32 v43, v56, v51, -v43
v_fma_f32 v44, v56, v52, -v44
v_fma_f32 v45, v56, v53, -v45
s_add_u32 m0, s41, 4096
s_add_u32 s42, s46, s65
buffer_load_dwordx4 v4, s[12:15], s42 offen lds
v_mfma_f32_32x32x16_bf16 v[160:175], a[152:155], v[112:115], v[160:175]
v_fma_f32 v46, v56, v54, -v46
v_fma_f32 v47, v56, v55, -v47
v_cvt_pk_bf16_f32 v60, v40, v41
v_cvt_pk_bf16_f32 v61, v42, v43
v_cvt_pk_bf16_f32 v62, v44, v45
v_cvt_pk_bf16_f32 v63, v46, v47
v_mfma_f32_32x32x16_bf16 v[176:191], a[148:151], v[108:111], v[176:191]
v_fma_f32 v48, v56, v40, -v48
v_fma_f32 v49, v56, v41, -v49
v_fma_f32 v50, v56, v42, -v50
v_fma_f32 v51, v56, v43, -v51
v_fma_f32 v52, v56, v44, -v52
v_fma_f32 v53, v56, v45, -v53
v_mfma_f32_32x32x16_bf16 v[176:191], a[156:159], v[112:115], v[176:191]
v_fma_f32 v54, v56, v46, -v54
v_fma_f32 v55, v56, v47, -v55
v_cvt_pk_bf16_f32 v64, v48, v49
v_cvt_pk_bf16_f32 v65, v50, v51
v_cvt_pk_bf16_f32 v66, v52, v53
v_cvt_pk_bf16_f32 v67, v54, v55
buffer_load_dwordx4 v5, s[12:15], s42 offen offset:1024 lds
ds_read_b128 a[192:195], v96 offset:49152
ds_read_b128 a[196:199], v96 offset:53248
ds_read_b128 a[200:203], v97 offset:49152
ds_read_b128 a[204:207], v97 offset:53248
s_waitcnt lgkmcnt(15)
v_mfma_f32_32x32x16_bf16 v[160:175], a[160:163], v[60:63], v[160:175]
v_fma_f32 v40, v56, v48, -v40
v_fma_f32 v41, v56, v49, -v41
v_fma_f32 v42, v56, v50, -v42
v_fma_f32 v43, v56, v51, -v43
v_fma_f32 v44, v56, v52, -v44
v_fma_f32 v45, v56, v53, -v45
v_mfma_f32_32x32x16_bf16 v[160:175], a[168:171], v[64:67], v[160:175]
v_fma_f32 v46, v56, v54, -v46
v_fma_f32 v47, v56, v55, -v47
v_cvt_pk_bf16_f32 v108, v40, v41
v_cvt_pk_bf16_f32 v109, v42, v43
v_cvt_pk_bf16_f32 v110, v44, v45
v_cvt_pk_bf16_f32 v111, v46, v47
s_add_u32 m0, s41, 6144
s_add_u32 s42, s47, s65
buffer_load_dwordx4 v4, s[12:15], s42 offen lds
v_mfma_f32_32x32x16_bf16 v[176:191], a[164:167], v[60:63], v[176:191]
v_fma_f32 v48, v56, v40, -v48
v_fma_f32 v49, v56, v41, -v49
v_fma_f32 v50, v56, v42, -v50
v_fma_f32 v51, v56, v43, -v51
v_fma_f32 v52, v56, v44, -v52
v_fma_f32 v53, v56, v45, -v53
v_mfma_f32_32x32x16_bf16 v[176:191], a[172:175], v[64:67], v[176:191]
v_fma_f32 v54, v56, v46, -v54
v_fma_f32 v55, v56, v47, -v55
v_cvt_pk_bf16_f32 v112, v48, v49
v_cvt_pk_bf16_f32 v113, v50, v51
v_cvt_pk_bf16_f32 v114, v52, v53
v_cvt_pk_bf16_f32 v115, v54, v55
buffer_load_dwordx4 v5, s[12:15], s42 offen offset:1024 lds
ds_read_b128 a[208:211], v98 offset:49152
ds_read_b128 a[212:215], v98 offset:53248
ds_read_b128 a[216:219], v99 offset:49152
ds_read_b128 a[220:223], v99 offset:53248
s_waitcnt lgkmcnt(9)
v_mfma_f32_32x32x16_bf16 v[160:175], a[176:179], v[108:111], v[160:175]
v_fma_f32 v40, v56, v48, -v40
v_fma_f32 v41, v56, v49, -v41
v_fma_f32 v42, v56, v50, -v42
v_fma_f32 v43, v56, v51, -v43
v_fma_f32 v44, v56, v52, -v44
v_fma_f32 v45, v56, v53, -v45
v_mfma_f32_32x32x16_bf16 v[160:175], a[184:187], v[112:115], v[160:175]
v_fma_f32 v46, v56, v54, -v46
v_fma_f32 v47, v56, v55, -v47
v_cvt_pk_bf16_f32 v60, v40, v41
v_cvt_pk_bf16_f32 v61, v42, v43
v_cvt_pk_bf16_f32 v62, v44, v45
v_cvt_pk_bf16_f32 v63, v46, v47
s_add_u32 m0, s41, 8192
s_add_u32 s42, s48, s65
buffer_load_dwordx4 v4, s[12:15], s42 offen lds
s_waitcnt lgkmcnt(8)
v_mfma_f32_32x32x16_bf16 v[176:191], a[180:183], v[108:111], v[176:191]
v_fma_f32 v48, v56, v40, -v48
v_fma_f32 v49, v56, v41, -v49
v_fma_f32 v50, v56, v42, -v50
v_fma_f32 v51, v56, v43, -v51
v_fma_f32 v52, v56, v44, -v52
v_fma_f32 v53, v56, v45, -v53
v_mfma_f32_32x32x16_bf16 v[176:191], a[188:191], v[112:115], v[176:191]
v_fma_f32 v54, v56, v46, -v54
v_fma_f32 v55, v56, v47, -v55
v_cvt_pk_bf16_f32 v64, v48, v49
v_cvt_pk_bf16_f32 v65, v50, v51
v_cvt_pk_bf16_f32 v66, v52, v53
v_cvt_pk_bf16_f32 v67, v54, v55
ds_read_b128 a[224:227], v96 offset:57344
ds_read_b128 a[228:231], v96 offset:61440
ds_read_b128 a[232:235], v97 offset:57344
ds_read_b128 a[236:239], v97 offset:61440
s_waitcnt lgkmcnt(9)
v_mfma_f32_32x32x16_bf16 v[160:175], a[192:195], v[60:63], v[160:175]
v_fma_f32 v40, v56, v48, -v40
v_fma_f32 v41, v56, v49, -v41
v_fma_f32 v42, v56, v50, -v42
v_fma_f32 v43, v56, v51, -v43
v_fma_f32 v44, v56, v52, -v44
v_fma_f32 v45, v56, v53, -v45
buffer_load_dwordx4 v5, s[12:15], s42 offen offset:1024 lds
v_mfma_f32_32x32x16_bf16 v[160:175], a[200:203], v[64:67], v[160:175]
v_fma_f32 v46, v56, v54, -v46
v_fma_f32 v47, v56, v55, -v47
v_cvt_pk_bf16_f32 v108, v40, v41
v_cvt_pk_bf16_f32 v109, v42, v43
v_cvt_pk_bf16_f32 v110, v44, v45
v_cvt_pk_bf16_f32 v111, v46, v47
s_waitcnt lgkmcnt(8)
v_mfma_f32_32x32x16_bf16 v[176:191], a[196:199], v[60:63], v[176:191]
v_fma_f32 v48, v56, v40, -v48
v_fma_f32 v49, v56, v41, -v49
v_fma_f32 v50, v56, v42, -v50
v_fma_f32 v51, v56, v43, -v51
v_fma_f32 v52, v56, v44, -v52
v_fma_f32 v53, v56, v45, -v53
s_add_u32 m0, s41, 10240
s_add_u32 s42, s49, s65
buffer_load_dwordx4 v4, s[12:15], s42 offen lds
v_mfma_f32_32x32x16_bf16 v[176:191], a[204:207], v[64:67], v[176:191]
v_fma_f32 v54, v56, v46, -v54
v_fma_f32 v55, v56, v47, -v55
v_cvt_pk_bf16_f32 v112, v48, v49
v_cvt_pk_bf16_f32 v113, v50, v51
v_cvt_pk_bf16_f32 v114, v52, v53
v_cvt_pk_bf16_f32 v115, v54, v55
ds_read_b128 a[240:243], v98 offset:57344
ds_read_b128 a[244:247], v98 offset:61440
ds_read_b128 a[248:251], v99 offset:57344
ds_read_b128 a[252:255], v99 offset:61440
s_waitcnt lgkmcnt(9)
v_mfma_f32_32x32x16_bf16 v[160:175], a[208:211], v[108:111], v[160:175]
v_fma_f32 v40, v56, v48, -v40
v_fma_f32 v41, v56, v49, -v41
v_fma_f32 v42, v56, v50, -v42
v_fma_f32 v43, v56, v51, -v43
v_fma_f32 v44, v56, v52, -v44
v_fma_f32 v45, v56, v53, -v45
buffer_load_dwordx4 v5, s[12:15], s42 offen offset:1024 lds
v_mfma_f32_32x32x16_bf16 v[160:175], a[216:219], v[112:115], v[160:175]
v_fma_f32 v46, v56, v54, -v46
v_fma_f32 v47, v56, v55, -v47
v_cvt_pk_bf16_f32 v60, v40, v41
v_cvt_pk_bf16_f32 v61, v42, v43
v_cvt_pk_bf16_f32 v62, v44, v45
v_cvt_pk_bf16_f32 v63, v46, v47
s_waitcnt lgkmcnt(8)
v_mfma_f32_32x32x16_bf16 v[176:191], a[212:215], v[108:111], v[176:191]
v_fma_f32 v48, v56, v40, -v48
v_fma_f32 v49, v56, v41, -v49
v_fma_f32 v50, v56, v42, -v50
v_fma_f32 v51, v56, v43, -v51
v_fma_f32 v52, v56, v44, -v52
v_fma_f32 v53, v56, v45, -v53
s_add_u32 m0, s41, 12288
s_add_u32 s42, s50, s65
buffer_load_dwordx4 v4, s[12:15], s42 offen lds
v_mfma_f32_32x32x16_bf16 v[176:191], a[220:223], v[112:115], v[176:191]
v_fma_f32 v54, v56, v46, -v54
v_fma_f32 v55, v56, v47, -v55
v_cvt_pk_bf16_f32 v64, v48, v49
v_cvt_pk_bf16_f32 v65, v50, v51
v_cvt_pk_bf16_f32 v66, v52, v53
v_cvt_pk_bf16_f32 v67, v54, v55
s_barrier
ds_read_b128 v[224:227], v100 offset:0
ds_read_b128 v[228:231], v100 offset:4096
ds_read_b128 v[232:235], v101 offset:0
ds_read_b128 v[236:239], v101 offset:4096
s_waitcnt lgkmcnt(9)
v_mfma_f32_32x32x16_bf16 v[160:175], a[224:227], v[60:63], v[160:175]
v_fma_f32 v40, v56, v48, -v40
v_fma_f32 v41, v56, v49, -v41
v_fma_f32 v42, v56, v50, -v42
v_fma_f32 v43, v56, v51, -v43
v_fma_f32 v44, v56, v52, -v44
v_fma_f32 v45, v56, v53, -v45
buffer_load_dwordx4 v5, s[12:15], s42 offen offset:1024 lds
v_mfma_f32_32x32x16_bf16 v[160:175], a[232:235], v[64:67], v[160:175]
v_fma_f32 v46, v56, v54, -v46
v_fma_f32 v47, v56, v55, -v47
v_cvt_pk_bf16_f32 v108, v40, v41
v_cvt_pk_bf16_f32 v109, v42, v43
v_cvt_pk_bf16_f32 v110, v44, v45
v_cvt_pk_bf16_f32 v111, v46, v47
s_waitcnt lgkmcnt(8)
v_mfma_f32_32x32x16_bf16 v[176:191], a[228:231], v[60:63], v[176:191]
v_fma_f32 v48, v56, v40, -v48
v_fma_f32 v49, v56, v41, -v49
v_fma_f32 v50, v56, v42, -v50
v_fma_f32 v51, v56, v43, -v51
v_fma_f32 v52, v56, v44, -v52
v_fma_f32 v53, v56, v45, -v53
v_mfma_f32_32x32x16_bf16 v[176:191], a[236:239], v[64:67], v[176:191]
v_fma_f32 v54, v56, v46, -v54
v_fma_f32 v55, v56, v47, -v55
v_cvt_pk_bf16_f32 v112, v48, v49
v_cvt_pk_bf16_f32 v113, v50, v51
v_cvt_pk_bf16_f32 v114, v52, v53
v_cvt_pk_bf16_f32 v115, v54, v55
s_add_u32 m0, s41, 14336
s_add_u32 s42, s51, s65
buffer_load_dwordx4 v4, s[12:15], s42 offen lds
ds_read_b128 v[240:243], v102 offset:0
ds_read_b128 v[244:247], v102 offset:4096
ds_read_b128 v[248:251], v103 offset:0
ds_read_b128 v[252:255], v103 offset:4096
s_waitcnt lgkmcnt(9)
v_mfma_f32_32x32x16_bf16 v[160:175], a[240:243], v[108:111], v[160:175]
v_fma_f32 v40, v56, v48, -v40
v_fma_f32 v41, v56, v49, -v41
v_fma_f32 v42, v56, v50, -v42
v_fma_f32 v43, v56, v51, -v43
v_fma_f32 v44, v56, v52, -v44
v_fma_f32 v45, v56, v53, -v45
v_mfma_f32_32x32x16_bf16 v[160:175], a[248:251], v[112:115], v[160:175]
v_fma_f32 v46, v56, v54, -v46
v_fma_f32 v47, v56, v55, -v47
v_cvt_pk_bf16_f32 v60, v40, v41
v_cvt_pk_bf16_f32 v61, v42, v43
v_cvt_pk_bf16_f32 v62, v44, v45
v_cvt_pk_bf16_f32 v63, v46, v47
buffer_load_dwordx4 v5, s[12:15], s42 offen offset:1024 lds
s_waitcnt lgkmcnt(8)
v_mfma_f32_32x32x16_bf16 v[176:191], a[244:247], v[108:111], v[176:191]
v_fma_f32 v48, v56, v40, -v48
v_fma_f32 v49, v56, v41, -v49
v_fma_f32 v50, v56, v42, -v50
v_fma_f32 v51, v56, v43, -v51
v_fma_f32 v52, v56, v44, -v52
v_fma_f32 v53, v56, v45, -v53
v_mfma_f32_32x32x16_bf16 v[176:191], a[252:255], v[112:115], v[176:191]
v_fma_f32 v54, v56, v46, -v54
v_fma_f32 v55, v56, v47, -v55
v_cvt_pk_bf16_f32 v64, v48, v49
v_cvt_pk_bf16_f32 v65, v50, v51
v_cvt_pk_bf16_f32 v66, v52, v53
v_cvt_pk_bf16_f32 v67, v54, v55
s_add_u32 m0, s41, 16384
s_add_u32 s42, s52, s65
buffer_load_dwordx4 v4, s[12:15], s42 offen lds
s_waitcnt lgkmcnt(5)
v_mfma_f32_32x32x16_bf16 v[160:175], v[224:227], v[60:63], v[160:175]
v_fma_f32 v40, v56, v48, -v40
v_fma_f32 v41, v56, v49, -v41
v_fma_f32 v42, v56, v50, -v42
v_fma_f32 v43, v56, v51, -v43
v_fma_f32 v44, v56, v52, -v44
v_fma_f32 v45, v56, v53, -v45
v_mfma_f32_32x32x16_bf16 v[160:175], v[232:235], v[64:67], v[160:175]
v_fma_f32 v46, v56, v54, -v46
v_fma_f32 v47, v56, v55, -v47
v_cvt_pk_bf16_f32 v108, v40, v41
v_cvt_pk_bf16_f32 v109, v42, v43
v_cvt_pk_bf16_f32 v110, v44, v45
v_cvt_pk_bf16_f32 v111, v46, v47
buffer_load_dwordx4 v5, s[12:15], s42 offen offset:1024 lds
s_waitcnt lgkmcnt(4)
v_mfma_f32_32x32x16_bf16 v[176:191], v[228:231], v[60:63], v[176:191]
v_fma_f32 v48, v56, v40, -v48
v_fma_f32 v49, v56, v41, -v49
v_fma_f32 v50, v56, v42, -v50
v_fma_f32 v51, v56, v43, -v51
v_fma_f32 v52, v56, v44, -v52
v_fma_f32 v53, v56, v45, -v53
v_mfma_f32_32x32x16_bf16 v[176:191], v[236:239], v[64:67], v[176:191]
v_fma_f32 v54, v56, v46, -v54
v_fma_f32 v55, v56, v47, -v55
v_cvt_pk_bf16_f32 v112, v48, v49
v_cvt_pk_bf16_f32 v113, v50, v51
v_cvt_pk_bf16_f32 v114, v52, v53
v_cvt_pk_bf16_f32 v115, v54, v55
s_waitcnt lgkmcnt(1)
v_mfma_f32_32x32x16_bf16 v[160:175], v[240:243], v[108:111], v[160:175]
v_mfma_f32_32x32x16_bf16 v[160:175], v[248:251], v[112:115], v[160:175]
s_waitcnt lgkmcnt(0)
v_mfma_f32_32x32x16_bf16 v[176:191], v[244:247], v[108:111], v[176:191]
v_mfma_f32_32x32x16_bf16 v[176:191], v[252:255], v[112:115], v[176:191]
v_and_b32 v68, 1, v1
v_cvt_f32_u32 v68, v68
v_mul_f32 v68, 0xbe800000, v68
v_cvt_f32_u32 v69, s37
v_fmamk_f32 v68, v69, 0x3c800000, v68
v_cos_f32 v68, v68
v_and_b32 v70, 31, v1
v_mul_u32_u24 v70, 73728, v70
v_lshrrev_b32 v69, 5, v1
v_lshl_add_u32 v70, v69, 4, v70
v_cvt_pk_bf16_f32 v64, v68, -v68
v_and_b32 v71, 1, v1
v_lshlrev_b32 v71, 6, v71
v_lshl_add_u32 v71, v69, 4, v71
v_add_u32 v71, 2359296, v71
v_mov_b32 v65, v64
v_mov_b32 v66, v64
v_mov_b32 v67, v64
s_lshl_b32 s3, s28, 5
s_add_u32 s3, s3, s37
s_lshl_b32 s3, s3, 7
s_add_u32 s3, s3, 18874368
v_cvt_pk_bf16_f32 v40, v160, v161
v_cvt_pk_bf16_f32 v41, v162, v163
v_cvt_pk_bf16_f32 v42, v164, v165
v_cvt_pk_bf16_f32 v43, v166, v167
v_cvt_pk_bf16_f32 v44, v168, v169
v_cvt_pk_bf16_f32 v45, v170, v171
v_cvt_pk_bf16_f32 v46, v172, v173
v_cvt_pk_bf16_f32 v47, v174, v175
v_cvt_pk_bf16_f32 v48, v176, v177
v_cvt_pk_bf16_f32 v49, v178, v179
v_cvt_pk_bf16_f32 v50, v180, v181
v_cvt_pk_bf16_f32 v51, v182, v183
v_cvt_pk_bf16_f32 v52, v184, v185
v_cvt_pk_bf16_f32 v53, v186, v187
v_cvt_pk_bf16_f32 v54, v188, v189
v_cvt_pk_bf16_f32 v55, v190, v191
v_mfma_f32_32x32x16_bf16 v[96:111], v[40:43], v[192:195], 0
v_mfma_f32_32x32x16_bf16 v[112:127], v[40:43], v[196:199], 0
v_mfma_f32_32x32x16_bf16 v[160:175], v[40:43], v[64:67], 0
v_mfma_f32_32x32x16_bf16 v[96:111], v[44:47], v[200:203], v[96:111]
v_mfma_f32_32x32x16_bf16 v[112:127], v[44:47], v[204:207], v[112:127]
v_mfma_f32_32x32x16_bf16 v[160:175], v[44:47], v[64:67], v[160:175]
v_mfma_f32_32x32x16_bf16 v[96:111], v[48:51], v[208:211], v[96:111]
v_mfma_f32_32x32x16_bf16 v[112:127], v[48:51], v[212:215], v[112:127]
v_mfma_f32_32x32x16_bf16 v[160:175], v[48:51], v[64:67], v[160:175]
v_mfma_f32_32x32x16_bf16 v[96:111], v[52:55], v[216:219], v[96:111]
v_mfma_f32_32x32x16_bf16 v[112:127], v[52:55], v[220:223], v[112:127]
v_mfma_f32_32x32x16_bf16 v[160:175], v[52:55], v[64:67], v[160:175]
s_nop 9
v_cvt_pk_bf16_f32 v176, v96, v97
v_cvt_pk_bf16_f32 v177, v98, v99
v_cvt_pk_bf16_f32 v178, v100, v101
v_cvt_pk_bf16_f32 v179, v102, v103
buffer_store_dwordx4 v[176:179], v70, s[4:7], s3 offen offset:0 sc1
v_cvt_pk_bf16_f32 v180, v104, v105
v_cvt_pk_bf16_f32 v181, v106, v107
v_cvt_pk_bf16_f32 v182, v108, v109
v_cvt_pk_bf16_f32 v183, v110, v111
buffer_store_dwordx4 v[180:183], v70, s[4:7], s3 offen offset:32 sc1
v_cvt_pk_bf16_f32 v184, v112, v113
v_cvt_pk_bf16_f32 v185, v114, v115
v_cvt_pk_bf16_f32 v186, v116, v117
v_cvt_pk_bf16_f32 v187, v118, v119
buffer_store_dwordx4 v[184:187], v70, s[4:7], s3 offen offset:64 sc1
v_cvt_pk_bf16_f32 v188, v120, v121
v_cvt_pk_bf16_f32 v189, v122, v123
v_cvt_pk_bf16_f32 v190, v124, v125
v_cvt_pk_bf16_f32 v191, v126, v127
buffer_store_dwordx4 v[188:191], v70, s[4:7], s3 offen offset:96 sc1
s_mov_b32 exec_lo, 3
s_mov_b32 exec_hi, 3
v_cvt_pk_bf16_f32 v192, v160, v161
v_cvt_pk_bf16_f32 v193, v162, v163
v_cvt_pk_bf16_f32 v194, v164, v165
v_cvt_pk_bf16_f32 v195, v166, v167
buffer_store_dwordx4 v[192:195], v71, s[4:7], s3 offen offset:0 sc1
v_cvt_pk_bf16_f32 v196, v168, v169
v_cvt_pk_bf16_f32 v197, v170, v171
v_cvt_pk_bf16_f32 v198, v172, v173
v_cvt_pk_bf16_f32 v199, v174, v175
buffer_store_dwordx4 v[196:199], v71, s[4:7], s3 offen offset:32 sc1
s_mov_b64 exec, -1
s_branch Lkf_join0
Lkf_notask:
s_cmp_lg_u32 s38, 3
s_cbranch_scc1 Lkf_pn
s_and_b32 s69, s69, 0xffff
s_mov_b32 s70, 1152
s_mov_b32 s71, 0x20000
v_lshlrev_b32 v12, 4, v1
s_mov_b32 m0, 153600
s_nop 0
buffer_load_dwordx4 v12, s[68:71], 0 offen lds
buffer_load_dwordx4 v12, s[68:71], 0 offen offset:1024 lds
s_mul_i32 s3, s37, 13056
s_add_u32 s3, s3, s36
s_lshl_b32 s3, s3, 2
s_add_u32 s3, s3, 25329664
v_mul_u32_u24 v42, 4352, v1
v_add_u32 v42, s3, v42
v_mov_b32 v43, 0
s_mul_i32 s67, s36, 2176
s_add_u32 s3, s67, s37
s_lshl_b32 s3, s3, 2
s_add_u32 s3, s3, 25165824
v_writelane_b32 v42, s3, 12
s_add_u32 s3, s3, 4352
v_writelane_b32 v42, s3, 13
s_add_u32 s3, s3, 81920
v_writelane_b32 v42, s3, 16
s_sub_u32 s3, s3, 4352
v_writelane_b32 v42, s3, 15
s_lshr_b32 s67, s67, 1
s_add_u32 s67, s67, s37
s_lshl_b32 s67, s67, 2
s_add_u32 s3, s67, 25226752
s_and_b32 s66, s36, 6
s_cmp_eq_u32 s66, 2
s_cselect_b32 s3, s3, 67108864
v_writelane_b32 v42, s3, 14
s_add_u32 s3, s67, 25291264
s_cmp_eq_u32 s66, 6
s_cselect_b32 s3, s3, 67108864
v_writelane_b32 v42, s3, 17
s_mul_i32 s3, s37, 4352
s_add_u32 s3, s3, 25247872
s_cmp_eq_u32 s36, 1
s_cselect_b32 s66, s37, 99
s_cmp_lt_u32 s66, 18
s_cselect_b32 s3, s3, 67108864
v_writelane_b32 v42, s3, 18
s_mov_b64 exec, 0x7ffff
buffer_store_dword v43, v42, s[4:7], 0 offen sc1
s_mov_b64 exec, -1
s_waitcnt vmcnt(15)
s_barrier
s_mul_i32 s40, s37, 57
s_lshr_b32 s40, s40, 9
s_mul_i32 s40, s40, 9
s_sub_u32 s40, s37, s40
s_mul_i32 s41, s38, 20480
s_add_u32 s41, s41, 73728
s_mul_i32 s3, s36, 1152
s_add_u32 s12, s12, s3
s_addc_u32 s13, s13, 0
s_and_b32 s13, s13, 0xffff
s_mov_b32 s14, 0
s_mov_b32 s15, 0x20000
s_sub_u32 s14, 5308416, s3
s_mul_i32 s44, s44, 589824
s_mul_i32 s45, s45, 589824
s_mul_i32 s46, s46, 589824
s_mul_i32 s47, s47, 589824
s_mul_i32 s48, s48, 589824
s_mul_i32 s49, s49, 589824
s_mul_i32 s50, s50, 589824
s_mul_i32 s51, s51, 589824
s_mul_i32 s52, s52, 589824
s_add_u32 s65, 8, s40
s_sub_u32 s3, s65, 9
s_cmp_ge_u32 s65, 9
s_cselect_b32 s65, s3, s65
s_lshl_b32 s97, s65, 7
s_mul_i32 s3, s38, 147456
s_add_u32 s65, s97, s3
s_lshl_b32 s66, s38, 1
s_add_u32 s63, s66, s40
s_sub_u32 s3, s63, 9
s_cmp_ge_u32 s63, 9
s_cselect_b32 s63, s3, s63
s_add_u32 s66, s66, 1
s_add_u32 s64, s66, s40
s_sub_u32 s3, s64, 9
s_cmp_ge_u32 s64, 9
s_cselect_b32 s64, s3, s64
s_lshl_b32 s63, s63, 7
s_lshl_b32 s64, s64, 7
v_lshrrev_b32 v69, 3, v1
v_bfe_u32 v70, v1, 4, 1
v_lshlrev_b32 v70, 2, v70
v_xor_b32 v70, v70, v1
v_and_b32 v70, 7, v70
v_lshlrev_b32 v70, 4, v70
v_mul_u32_u24 v4, 9216, v69
v_add_u32 v4, v4, v70
v_add_u32 v5, 72704, v4
v_mul_u32_u24 v6, 1152, v69
v_add_u32 v6, v6, v70
v_add_u32 v7, 8192, v6
v_bfe_u32 v40, v1, 2, 2
v_lshlrev_b32 v41, 7, v40
v_lshrrev_b32 v40, 1, v40
v_lshl_add_u32 v41, v40, 6, v41
v_bfe_u32 v40, v1, 4, 1
v_lshl_add_u32 v41, v40, 5, v41
v_add_u32 v41, s41, v41
v_and_b32 v8, 3, v1
v_lshl_add_u32 v8, v8, 3, v41
v_and_b32 v40, 1, v1
v_lshl_add_u32 v41, v40, 4, v41
v_bfe_u32 v40, v1, 1, 1
v_lshl_add_u32 v41, v40, 3, v41
v_lshrrev_b32 v40, 5, v1
v_lshl_add_u32 v8, v40, 10, v8
v_xor_b32 v9, 64, v8
v_lshl_add_u32 v10, v40, 9, v41
v_xor_b32 v11, 64, v10
v_lshlrev_b32 v12, 4, v1
v_add_u32 v28, 155648, v12
v_add_u32 v100, 0x10000, v96
v_add_u32 v101, 0x10000, v97
v_add_u32 v102, 0x10000, v98
v_add_u32 v103, 0x10000, v99
v_lshrrev_b32 v40, 5, v1
v_lshlrev_b32 v40, 4, v40
s_add_u32 s3, s41, 18432
v_add_u32 v40, s3, v40
ds_read_b128 a[0:3], v96 offset:0
ds_read_b128 a[4:7], v96 offset:4096
s_waitcnt vmcnt(1)
v_add_u32 v41, s54, v40
ds_read_b128 v[44:47], v41 offset:0
ds_read_b128 v[48:51], v41 offset:32
ds_read_b128 v[52:55], v41 offset:64
ds_read_b128 v[56:59], v41 offset:96
ds_read_b128 a[8:11], v97 offset:0
ds_read_b128 a[12:15], v97 offset:4096
ds_read_b128 a[16:19], v98 offset:0
ds_read_b128 a[20:23], v98 offset:4096
ds_read_b128 a[24:27], v99 offset:0
ds_read_b128 a[28:31], v99 offset:4096
s_barrier
ds_read_b128 a[32:35], v96 offset:8192
ds_read_b128 a[36:39], v96 offset:12288
v_add_u32 v41, s55, v40
ds_read_b128 v[60:63], v41 offset:0
ds_read_b128 v[64:67], v41 offset:32
ds_read_b128 v[68:71], v41 offset:64
ds_read_b128 v[72:75], v41 offset:96
s_waitcnt lgkmcnt(15)
v_mfma_f32_32x32x16_bf16 v[160:175], v[44:47], a[0:3], 0
v_and_b32 v77, 31, v1
v_cvt_f32_u32 v76, v77
v_mul_f32 v76, 0x3c800000, v76
v_lshrrev_b32 v77, 5, v1
v_lshlrev_b32 v77, 7, v77
v_add_u32 v77, s37, v77
v_mfma_f32_32x32x16_bf16 v[176:191], v[44:47], a[4:7], 0
v_cvt_f32_u32 v77, v77
v_mul_f32 v77, 0x3d000000, v77
v_mul_f32 v77, v77, v76
v_mul_f32 v78, 0x41000000, v76
v_cos_f32 v78, v78
ds_read_b128 a[40:43], v97 offset:8192
ds_read_b128 a[44:47], v97 offset:12288
s_waitcnt lgkmcnt(12)
v_mfma_f32_32x32x16_bf16 v[104:119], v[48:51], a[8:11], 0
v_fmamk_f32 v84, v76, 0x00000000, v77
v_fmamk_f32 v85, v76, 0x3f800000, v77
v_fmamk_f32 v86, v76, 0x40000000, v77
v_fmamk_f32 v87, v76, 0x40400000, v77
v_cos_f32 v80, v84
v_mfma_f32_32x32x16_bf16 v[120:135], v[48:51], a[12:15], 0
v_sin_f32 v84, v84
v_cos_f32 v81, v85
v_sin_f32 v85, v85
v_cos_f32 v82, v86
v_sin_f32 v86, v86
ds_read_b128 a[48:51], v98 offset:8192
ds_read_b128 a[52:55], v98 offset:12288
s_waitcnt lgkmcnt(12)
v_mfma_f32_32x32x16_bf16 v[160:175], v[52:55], a[16:19], v[160:175]
v_cos_f32 v83, v87
v_sin_f32 v87, v87
v_fmamk_f32 v140, v76, 0x41000000, v77
v_fmamk_f32 v141, v76, 0x41100000, v77
v_fmamk_f32 v142, v76, 0x41200000, v77
v_mfma_f32_32x32x16_bf16 v[176:191], v[52:55], a[20:23], v[176:191]
v_fmamk_f32 v143, v76, 0x41300000, v77
v_cos_f32 v136, v140
v_sin_f32 v140, v140
v_cos_f32 v137, v141
v_sin_f32 v141, v141
ds_read_b128 a[56:59], v99 offset:8192
ds_read_b128 a[60:63], v99 offset:12288
s_waitcnt lgkmcnt(12)
v_mfma_f32_32x32x16_bf16 v[104:119], v[56:59], a[24:27], v[104:119]
v_cos_f32 v138, v142
v_sin_f32 v142, v142
v_cos_f32 v139, v143
v_sin_f32 v143, v143
v_add_f32 v78, v78, v78
v_cvt_pk_bf16_f32 v192, v80, v81
v_mfma_f32_32x32x16_bf16 v[120:135], v[56:59], a[28:31], v[120:135]
v_cvt_pk_bf16_f32 v193, v82, v83
v_cvt_pk_bf16_f32 v196, v84, v85
v_cvt_pk_bf16_f32 v197, v86, v87
v_cvt_pk_bf16_f32 v194, v136, v137
v_cvt_pk_bf16_f32 v195, v138, v139
ds_read_b128 a[64:67], v96 offset:16384
ds_read_b128 a[68:71], v96 offset:20480
v_add_u32 v41, s56, v40
ds_read_b128 v[44:47], v41 offset:0
ds_read_b128 v[48:51], v41 offset:32
ds_read_b128 v[52:55], v41 offset:64
ds_read_b128 v[56:59], v41 offset:96
s_waitcnt lgkmcnt(15)
v_mfma_f32_32x32x16_bf16 v[160:175], v[60:63], a[32:35], v[160:175]
v_cvt_pk_bf16_f32 v198, v140, v141
v_cvt_pk_bf16_f32 v199, v142, v143
v_fma_f32 v80, v78, v136, -v80
v_fma_f32 v81, v78, v137, -v81
v_fma_f32 v82, v78, v138, -v82
v_mfma_f32_32x32x16_bf16 v[176:191], v[60:63], a[36:39], v[176:191]
v_fma_f32 v83, v78, v139, -v83
v_cvt_pk_bf16_f32 v200, v80, v81
v_cvt_pk_bf16_f32 v201, v82, v83
v_fma_f32 v84, v78, v140, -v84
v_fma_f32 v85, v78, v141, -v85
ds_read_b128 a[72:75], v97 offset:16384
ds_read_b128 a[76:79], v97 offset:20480
s_waitcnt lgkmcnt(12)
v_mfma_f32_32x32x16_bf16 v[104:119], v[64:67], a[40:43], v[104:119]
v_fma_f32 v86, v78, v142, -v86
v_fma_f32 v87, v78, v143, -v87
v_cvt_pk_bf16_f32 v204, v84, v85
v_cvt_pk_bf16_f32 v205, v86, v87
v_fma_f32 v136, v78, v80, -v136
v_mfma_f32_32x32x16_bf16 v[120:135], v[64:67], a[44:47], v[120:135]
v_fma_f32 v137, v78, v81, -v137
v_fma_f32 v138, v78, v82, -v138
v_fma_f32 v139, v78, v83, -v139
v_cvt_pk_bf16_f32 v202, v136, v137
v_cvt_pk_bf16_f32 v203, v138, v139
ds_read_b128 a[80:83], v98 offset:16384
ds_read_b128 a[84:87], v98 offset:20480
s_waitcnt lgkmcnt(12)
v_mfma_f32_32x32x16_bf16 v[160:175], v[68:71], a[48:51], v[160:175]
v_fma_f32 v140, v78, v84, -v140
v_fma_f32 v141, v78, v85, -v141
v_fma_f32 v142, v78, v86, -v142
v_fma_f32 v143, v78, v87, -v143
v_cvt_pk_bf16_f32 v206, v140, v141
v_cvt_pk_bf16_f32 v207, v142, v143
v_mfma_f32_32x32x16_bf16 v[176:191], v[68:71], a[52:55], v[176:191]
v_fma_f32 v80, v78, v136, -v80
v_fma_f32 v81, v78, v137, -v81
v_fma_f32 v82, v78, v138, -v82
v_fma_f32 v83, v78, v139, -v83
v_cvt_pk_bf16_f32 v208, v80, v81
ds_read_b128 a[88:91], v99 offset:16384
ds_read_b128 a[92:95], v99 offset:20480
s_waitcnt lgkmcnt(12)
v_mfma_f32_32x32x16_bf16 v[104:119], v[72:75], a[56:59], v[104:119]
v_cvt_pk_bf16_f32 v209, v82, v83
v_fma_f32 v84, v78, v140, -v84
v_fma_f32 v85, v78, v141, -v85
v_fma_f32 v86, v78, v142, -v86
v_fma_f32 v87, v78, v143, -v87
v_mfma_f32_32x32x16_bf16 v[120:135], v[72:75], a[60:63], v[120:135]
v_cvt_pk_bf16_f32 v212, v84, v85
v_cvt_pk_bf16_f32 v213, v86, v87
v_fma_f32 v136, v78, v80, -v136
v_fma_f32 v137, v78, v81, -v137
v_fma_f32 v138, v78, v82, -v138
ds_read_b128 a[96:99], v96 offset:24576
ds_read_b128 a[100:103], v96 offset:28672
v_add_u32 v41, s57, v40
ds_read_b128 v[60:63], v41 offset:0
ds_read_b128 v[64:67], v41 offset:32
ds_read_b128 v[68:71], v41 offset:64
ds_read_b128 v[72:75], v41 offset:96
s_waitcnt lgkmcnt(15)
v_mfma_f32_32x32x16_bf16 v[160:175], v[44:47], a[64:67], v[160:175]
v_fma_f32 v139, v78, v83, -v139
v_cvt_pk_bf16_f32 v210, v136, v137
v_cvt_pk_bf16_f32 v211, v138, v139
v_fma_f32 v140, v78, v84, -v140
v_fma_f32 v141, v78, v85, -v141
v_mfma_f32_32x32x16_bf16 v[176:191], v[44:47], a[68:71], v[176:191]
v_fma_f32 v142, v78, v86, -v142
v_fma_f32 v143, v78, v87, -v143
v_cvt_pk_bf16_f32 v214, v140, v141
v_cvt_pk_bf16_f32 v215, v142, v143
v_fma_f32 v80, v78, v136, -v80
ds_read_b128 a[104:107], v97 offset:24576
ds_read_b128 a[108:111], v97 offset:28672
s_waitcnt lgkmcnt(12)
v_mfma_f32_32x32x16_bf16 v[104:119], v[48:51], a[72:75], v[104:119]
v_fma_f32 v81, v78, v137, -v81
v_fma_f32 v82, v78, v138, -v82
v_fma_f32 v83, v78, v139, -v83
v_cvt_pk_bf16_f32 v216, v80, v81
v_cvt_pk_bf16_f32 v217, v82, v83
v_fma_f32 v84, v78, v140, -v84
v_mfma_f32_32x32x16_bf16 v[120:135], v[48:51], a[76:79], v[120:135]
v_fma_f32 v85, v78, v141, -v85
v_fma_f32 v86, v78, v142, -v86
v_fma_f32 v87, v78, v143, -v87
v_cvt_pk_bf16_f32 v220, v84, v85
v_cvt_pk_bf16_f32 v221, v86, v87
ds_read_b128 a[112:115], v98 offset:24576
ds_read_b128 a[116:119], v98 offset:28672
s_waitcnt lgkmcnt(12)
v_mfma_f32_32x32x16_bf16 v[160:175], v[52:55], a[80:83], v[160:175]
v_fma_f32 v136, v78, v80, -v136
v_fma_f32 v137, v78, v81, -v137
v_fma_f32 v138, v78, v82, -v138
v_fma_f32 v139, v78, v83, -v139
v_cvt_pk_bf16_f32 v218, v136, v137
v_mfma_f32_32x32x16_bf16 v[176:191], v[52:55], a[84:87], v[176:191]
v_cvt_pk_bf16_f32 v219, v138, v139
v_fma_f32 v140, v78, v84, -v140
v_fma_f32 v141, v78, v85, -v141
v_fma_f32 v142, v78, v86, -v142
v_fma_f32 v143, v78, v87, -v143
ds_read_b128 a[120:123], v99 offset:24576
ds_read_b128 a[124:127], v99 offset:28672
s_waitcnt lgkmcnt(12)
v_mfma_f32_32x32x16_bf16 v[104:119], v[56:59], a[88:91], v[104:119]
v_cvt_pk_bf16_f32 v222, v140, v141
v_cvt_pk_bf16_f32 v223, v142, v143
ds_write_b128 v28, v[192:195] offset:0
ds_write_b128 v28, v[196:199] offset:1024
ds_write_b128 v28, v[200:203] offset:2048
v_mfma_f32_32x32x16_bf16 v[120:135], v[56:59], a[92:95], v[120:135]
ds_write_b128 v28, v[204:207] offset:3072
ds_write_b128 v28, v[208:211] offset:4096
ds_write_b128 v28, v[212:215] offset:5120
ds_write_b128 v28, v[216:219] offset:6144
ds_write_b128 v28, v[220:223] offset:7168
s_waitcnt vmcnt(0) lgkmcnt(0)
s_barrier
s_and_b32 s67, s2, 7
s_lshl_b32 s67, s67, 5
v_mov_b32 v42, s67
v_mov_b32 v43, 1
s_mov_b64 exec, 1
global_atomic_add v42, v43, s[72:73] sc1
s_mov_b64 exec, -1
ds_read_b128 a[128:131], v96 offset:32768
ds_read_b128 a[132:135], v96 offset:36864
v_add_u32 v41, s58, v40
ds_read_b128 v[44:47], v41 offset:0
ds_read_b128 v[48:51], v41 offset:32
ds_read_b128 v[52:55], v41 offset:64
ds_read_b128 v[56:59], v41 offset:96
v_mfma_f32_32x32x16_bf16 v[160:175], v[60:63], a[96:99], v[160:175]
s_add_u32 m0, s41, 0
s_add_u32 s42, s44, s65
buffer_load_dwordx4 v4, s[12:15], s42 offen lds
s_and_b32 s3, s38, 1
s_lshl_b32 s75, s36, 1
s_add_u32 s75, s75, s3
s_mov_b32 s74, s37
s_lshr_b32 s30, s38, 1
v_mfma_f32_32x32x16_bf16 v[176:191], v[60:63], a[100:103], v[176:191]
s_and_b32 s3, s36, 6
s_lshl_b32 s3, s3, 2
s_add_u32 s3, s3, s38
s_add_u32 s66, s36, 10
s_cmp_eq_u32 s3, 24
s_cselect_b32 s75, s66, s75
s_cselect_b32 s30, 1, s30
ds_read_b128 a[136:139], v97 offset:32768
ds_read_b128 a[140:143], v97 offset:36864
v_mfma_f32_32x32x16_bf16 v[104:119], v[64:67], a[104:107], v[104:119]
buffer_load_dwordx4 v5, s[12:15], s42 offen offset:1024 lds
s_lshl_b32 s3, s36, 2
s_add_u32 s3, s3, s38
s_cmp_eq_u32 s3, 5
s_cselect_b32 s3, s37, 99
s_cmp_lt_u32 s3, 18
s_cselect_b32 s75, s37, s75
s_cselect_b32 s74, 32, s74
s_cselect_b32 s30, 1, s30
s_and_b32 s21, s21, 0xffff
v_mfma_f32_32x32x16_bf16 v[120:135], v[64:67], a[108:111], v[120:135]
s_mov_b32 s22, 1183744
s_mov_b32 s23, 0x20000
s_and_b32 s25, s25, 0xffff
s_mov_b32 s26, 1183744
s_mov_b32 s27, 0x20000
ds_read_b128 a[144:147], v98 offset:32768
ds_read_b128 a[148:151], v98 offset:36864
v_mfma_f32_32x32x16_bf16 v[160:175], v[68:71], a[112:115], v[160:175]
s_add_u32 m0, s41, 2048
s_add_u32 s42, s45, s65
buffer_load_dwordx4 v4, s[12:15], s42 offen lds
s_cmp_eq_u32 s30, 1
s_cbranch_scc0 Lsk_wl_3
v_lshrrev_b32 v136, 1, v1
v_lshl_add_u32 v136, v136, 6, s74
v_sub_u32 v137, 2048, v136
v_and_b32 v137, 2047, v137
v_and_b32 v138, 1, v1
v_lshlrev_b32 v138, 4, v138
s_movk_i32 s67, 578
v_mad_u32_u24 v136, v136, s67, v138
v_mad_u32_u24 v137, v137, s67, v138
s_lshl_b32 s67, s75, 5
buffer_load_dwordx4 v[32:35], v136, s[20:23], s67 offen
buffer_load_dwordx4 v[36:39], v136, s[24:27], s67 offen
buffer_load_dwordx4 v[88:91], v137, s[20:23], s67 offen
buffer_load_dwordx4 v[92:95], v137, s[24:27], s67 offen
s_sub_u32 s3, s30, 1
s_or_b32 s3, s3, s75
s_cbranch_scc1 Lsk_g0l_4
v_and_b32 v136, 31, v1
v_lshlrev_b32 v136, 6, v136
v_add_u32 v136, s74, v136
v_sub_u32 v137, 2048, v136
v_and_b32 v137, 2047, v137
v_mul_u32_u24 v136, 578, v136
v_mul_u32_u24 v137, 578, v137
buffer_load_ushort v128, v136, s[20:23], 0 offen offset:0
buffer_load_ushort v129, v136, s[24:27], 0 offen offset:0
buffer_load_ushort v130, v137, s[20:23], 0 offen offset:0
buffer_load_ushort v131, v137, s[24:27], 0 offen offset:0
buffer_load_ushort v132, v136, s[20:23], 0 offen offset:576
buffer_load_ushort v133, v136, s[24:27], 0 offen offset:576
buffer_load_ushort v134, v137, s[20:23], 0 offen offset:576
buffer_load_ushort v135, v137, s[24:27], 0 offen offset:576
Lsk_g0l_4:
Lsk_wl_3:
v_mfma_f32_32x32x16_bf16 v[176:191], v[68:71], a[116:119], v[176:191]
ds_read_b128 a[152:155], v99 offset:32768
ds_read_b128 a[156:159], v99 offset:36864
v_mfma_f32_32x32x16_bf16 v[104:119], v[72:75], a[120:123], v[104:119]
buffer_load_dwordx4 v5, s[12:15], s42 offen offset:1024 lds
v_mfma_f32_32x32x16_bf16 v[120:135], v[72:75], a[124:127], v[120:135]
ds_read_b128 a[160:163], v96 offset:40960
ds_read_b128 a[164:167], v96 offset:45056
v_add_u32 v41, s59, v40
ds_read_b128 v[60:63], v41 offset:0
ds_read_b128 v[64:67], v41 offset:32
ds_read_b128 v[68:71], v41 offset:64
ds_read_b128 v[72:75], v41 offset:96
s_waitcnt lgkmcnt(15)
v_mfma_f32_32x32x16_bf16 v[160:175], v[44:47], a[128:131], v[160:175]
s_add_u32 m0, s41, 4096
s_add_u32 s42, s46, s65
buffer_load_dwordx4 v4, s[12:15], s42 offen lds
v_mfma_f32_32x32x16_bf16 v[176:191], v[44:47], a[132:135], v[176:191]
ds_read_b128 a[168:171], v97 offset:40960
ds_read_b128 a[172:175], v97 offset:45056
s_waitcnt lgkmcnt(12)
v_mfma_f32_32x32x16_bf16 v[104:119], v[48:51], a[136:139], v[104:119]
buffer_load_dwordx4 v5, s[12:15], s42 offen offset:1024 lds
v_mfma_f32_32x32x16_bf16 v[120:135], v[48:51], a[140:143], v[120:135]
ds_read_b128 a[176:179], v98 offset:40960
ds_read_b128 a[180:183], v98 offset:45056
s_waitcnt lgkmcnt(12)
v_mfma_f32_32x32x16_bf16 v[160:175], v[52:55], a[144:147], v[160:175]
s_add_u32 m0, s41, 6144
s_add_u32 s42, s47, s65
buffer_load_dwordx4 v4, s[12:15], s42 offen lds
v_mfma_f32_32x32x16_bf16 v[176:191], v[52:55], a[148:151], v[176:191]
ds_read_b128 a[184:187], v99 offset:40960
ds_read_b128 a[188:191], v99 offset:45056
s_waitcnt lgkmcnt(12)
v_mfma_f32_32x32x16_bf16 v[104:119], v[56:59], a[152:155], v[104:119]
buffer_load_dwordx4 v5, s[12:15], s42 offen offset:1024 lds
v_mfma_f32_32x32x16_bf16 v[120:135], v[56:59], a[156:159], v[120:135]
ds_read_b128 a[192:195], v96 offset:49152
ds_read_b128 a[196:199], v96 offset:53248
v_add_u32 v41, s60, v40
ds_read_b128 v[44:47], v41 offset:0
ds_read_b128 v[48:51], v41 offset:32
ds_read_b128 v[52:55], v41 offset:64
ds_read_b128 v[56:59], v41 offset:96
s_waitcnt lgkmcnt(15)
v_mfma_f32_32x32x16_bf16 v[160:175], v[60:63], a[160:163], v[160:175]
s_add_u32 m0, s41, 8192
s_add_u32 s42, s48, s65
buffer_load_dwordx4 v4, s[12:15], s42 offen lds
v_and_b32 v76, 15, v1
v_cvt_f32_u32 v76, v76
v_mul_f32 v76, 0x3d000000, v76
v_add_f32 v77, 0.5, v76
v_mfma_f32_32x32x16_bf16 v[176:191], v[60:63], a[164:167], v[176:191]
v_lshrrev_b32 v78, 4, v1
v_lshlrev_b32 v78, 2, v78
v_cvt_f32_u32 v78, v78
ds_read_b128 a[200:203], v97 offset:49152
ds_read_b128 a[204:207], v97 offset:53248
s_waitcnt lgkmcnt(12)
v_mfma_f32_32x32x16_bf16 v[104:119], v[64:67], a[168:171], v[104:119]
buffer_load_dwordx4 v5, s[12:15], s42 offen offset:1024 lds
v_add_f32 v80, 0x00000000, v78
v_add_f32 v81, 0x3f800000, v78
v_mul_f32 v82, v80, v76
v_mul_f32 v83, v81, v76
v_mfma_f32_32x32x16_bf16 v[120:135], v[64:67], a[172:175], v[120:135]
v_cos_f32 v84, v82
v_sin_f32 v86, v82
v_cos_f32 v85, v83
ds_read_b128 a[208:211], v98 offset:49152
ds_read_b128 a[212:215], v98 offset:53248
s_waitcnt lgkmcnt(12)
v_mfma_f32_32x32x16_bf16 v[160:175], v[68:71], a[176:179], v[160:175]
s_add_u32 m0, s41, 10240
s_add_u32 s42, s49, s65
buffer_load_dwordx4 v4, s[12:15], s42 offen lds
v_sin_f32 v87, v83
v_cvt_pk_bf16_f32 v192, v84, v85
v_cvt_pk_bf16_f32 v200, v86, v87
v_mfma_f32_32x32x16_bf16 v[176:191], v[68:71], a[180:183], v[176:191]
v_cvt_pk_bf16_f32 v208, -v86, -v87
v_mul_f32 v82, v80, v77
v_mul_f32 v83, v81, v77
v_cos_f32 v84, v82
ds_read_b128 a[216:219], v99 offset:49152
ds_read_b128 a[220:223], v99 offset:53248
s_waitcnt lgkmcnt(12)
v_mfma_f32_32x32x16_bf16 v[104:119], v[72:75], a[184:187], v[104:119]
buffer_load_dwordx4 v5, s[12:15], s42 offen offset:1024 lds
v_sin_f32 v86, v82
v_cos_f32 v85, v83
v_sin_f32 v87, v83
v_mfma_f32_32x32x16_bf16 v[120:135], v[72:75], a[188:191], v[120:135]
v_cvt_pk_bf16_f32 v196, v84, v85
v_cvt_pk_bf16_f32 v204, v86, v87
v_cvt_pk_bf16_f32 v212, -v86, -v87
ds_read_b128 a[224:227], v96 offset:57344
ds_read_b128 a[228:231], v96 offset:61440
v_add_u32 v41, s61, v40
ds_read_b128 v[60:63], v41 offset:0
ds_read_b128 v[64:67], v41 offset:32
ds_read_b128 v[68:71], v41 offset:64
ds_read_b128 v[72:75], v41 offset:96
s_waitcnt lgkmcnt(15)
v_mfma_f32_32x32x16_bf16 v[160:175], v[44:47], a[192:195], v[160:175]
s_add_u32 m0, s41, 12288
s_add_u32 s42, s50, s65
buffer_load_dwordx4 v4, s[12:15], s42 offen lds
v_add_f32 v80, 0x40000000, v78
v_add_f32 v81, 0x40400000, v78
v_mul_f32 v82, v80, v76
v_mul_f32 v83, v81, v76
v_mfma_f32_32x32x16_bf16 v[176:191], v[44:47], a[196:199], v[176:191]
v_cos_f32 v84, v82
v_sin_f32 v86, v82
v_cos_f32 v85, v83
ds_read_b128 a[232:235], v97 offset:57344
ds_read_b128 a[236:239], v97 offset:61440
s_waitcnt lgkmcnt(12)
v_mfma_f32_32x32x16_bf16 v[104:119], v[48:51], a[200:203], v[104:119]
buffer_load_dwordx4 v5, s[12:15], s42 offen offset:1024 lds
v_sin_f32 v87, v83
v_cvt_pk_bf16_f32 v193, v84, v85
v_cvt_pk_bf16_f32 v201, v86, v87
v_mfma_f32_32x32x16_bf16 v[120:135], v[48:51], a[204:207], v[120:135]
v_cvt_pk_bf16_f32 v209, -v86, -v87
v_mul_f32 v82, v80, v77
v_mul_f32 v83, v81, v77
v_cos_f32 v84, v82
s_barrier
ds_read_b128 a[240:243], v98 offset:57344
ds_read_b128 a[244:247], v98 offset:61440
s_waitcnt lgkmcnt(12)
v_mfma_f32_32x32x16_bf16 v[160:175], v[52:55], a[208:211], v[160:175]
s_add_u32 m0, s41, 14336
s_add_u32 s42, s51, s65
buffer_load_dwordx4 v4, s[12:15], s42 offen lds
v_sin_f32 v86, v82
v_cos_f32 v85, v83
v_sin_f32 v87, v83
v_mfma_f32_32x32x16_bf16 v[176:191], v[52:55], a[212:215], v[176:191]
v_cvt_pk_bf16_f32 v197, v84, v85
v_cvt_pk_bf16_f32 v205, v86, v87
v_cvt_pk_bf16_f32 v213, -v86, -v87
ds_read_b128 a[248:251], v99 offset:57344
ds_read_b128 a[252:255], v99 offset:61440
s_waitcnt lgkmcnt(12)
v_mfma_f32_32x32x16_bf16 v[104:119], v[56:59], a[216:219], v[104:119]
buffer_load_dwordx4 v5, s[12:15], s42 offen offset:1024 lds
v_add_f32 v80, 0x41800000, v78
v_add_f32 v81, 0x41880000, v78
v_mul_f32 v82, v80, v76
v_mul_f32 v83, v81, v76
v_mfma_f32_32x32x16_bf16 v[120:135], v[56:59], a[220:223], v[120:135]
v_cos_f32 v84, v82
v_sin_f32 v86, v82
v_cos_f32 v85, v83
ds_read_b128 v[224:227], v100 offset:0
ds_read_b128 v[228:231], v100 offset:4096
v_add_u32 v41, s62, v40
ds_read_b128 v[44:47], v41 offset:0
ds_read_b128 v[48:51], v41 offset:32
ds_read_b128 v[52:55], v41 offset:64
ds_read_b128 v[56:59], v41 offset:96
s_waitcnt lgkmcnt(15)
v_mfma_f32_32x32x16_bf16 v[160:175], v[60:63], a[224:227], v[160:175]
s_add_u32 m0, s41, 16384
s_add_u32 s42, s52, s65
buffer_load_dwordx4 v4, s[12:15], s42 offen lds
v_sin_f32 v87, v83
v_cvt_pk_bf16_f32 v194, v84, v85
v_cvt_pk_bf16_f32 v202, v86, v87
v_mfma_f32_32x32x16_bf16 v[176:191], v[60:63], a[228:231], v[176:191]
v_cvt_pk_bf16_f32 v210, -v86, -v87
v_mul_f32 v82, v80, v77
v_mul_f32 v83, v81, v77
v_cos_f32 v84, v82
ds_read_b128 v[232:235], v101 offset:0
ds_read_b128 v[236:239], v101 offset:4096
s_waitcnt lgkmcnt(12)
v_mfma_f32_32x32x16_bf16 v[104:119], v[64:67], a[232:235], v[104:119]
buffer_load_dwordx4 v5, s[12:15], s42 offen offset:1024 lds
v_sin_f32 v86, v82
v_cos_f32 v85, v83
v_sin_f32 v87, v83
v_mfma_f32_32x32x16_bf16 v[120:135], v[64:67], a[236:239], v[120:135]
v_cvt_pk_bf16_f32 v198, v84, v85
v_cvt_pk_bf16_f32 v206, v86, v87
v_cvt_pk_bf16_f32 v214, -v86, -v87
ds_read_b128 v[240:243], v102 offset:0
ds_read_b128 v[244:247], v102 offset:4096
s_waitcnt lgkmcnt(12)
v_mfma_f32_32x32x16_bf16 v[160:175], v[68:71], a[240:243], v[160:175]
v_add_f32 v80, 0x41900000, v78
v_add_f32 v81, 0x41980000, v78
v_mul_f32 v82, v80, v76
v_mul_f32 v83, v81, v76
v_mfma_f32_32x32x16_bf16 v[176:191], v[68:71], a[244:247], v[176:191]
v_cos_f32 v84, v82
v_sin_f32 v86, v82
v_cos_f32 v85, v83
ds_read_b128 v[248:251], v103 offset:0
ds_read_b128 v[252:255], v103 offset:4096
s_waitcnt lgkmcnt(12)
v_mfma_f32_32x32x16_bf16 v[104:119], v[72:75], a[248:251], v[104:119]
v_sin_f32 v87, v83
v_cvt_pk_bf16_f32 v195, v84, v85
v_cvt_pk_bf16_f32 v203, v86, v87
v_mfma_f32_32x32x16_bf16 v[120:135], v[72:75], a[252:255], v[120:135]
v_cvt_pk_bf16_f32 v211, -v86, -v87
v_mul_f32 v82, v80, v77
v_mul_f32 v83, v81, v77
v_cos_f32 v84, v82
s_waitcnt lgkmcnt(9)
v_mfma_f32_32x32x16_bf16 v[160:175], v[44:47], v[224:227], v[160:175]
v_sin_f32 v86, v82
v_cos_f32 v85, v83
v_sin_f32 v87, v83
v_mfma_f32_32x32x16_bf16 v[176:191], v[44:47], v[228:231], v[176:191]
v_cvt_pk_bf16_f32 v199, v84, v85
v_cvt_pk_bf16_f32 v207, v86, v87
v_cvt_pk_bf16_f32 v215, -v86, -v87
s_waitcnt lgkmcnt(4)
v_mfma_f32_32x32x16_bf16 v[104:119], v[48:51], v[232:235], v[104:119]
ds_write_b128 v28, v[192:195] offset:0
ds_write_b128 v28, v[196:199] offset:1024
v_mfma_f32_32x32x16_bf16 v[120:135], v[48:51], v[236:239], v[120:135]
ds_write_b128 v28, v[200:203] offset:2048
s_waitcnt lgkmcnt(5)
v_mfma_f32_32x32x16_bf16 v[160:175], v[52:55], v[240:243], v[160:175]
ds_write_b128 v28, v[204:207] offset:3072
ds_write_b128 v28, v[208:211] offset:4096
v_mfma_f32_32x32x16_bf16 v[176:191], v[52:55], v[244:247], v[176:191]
ds_write_b128 v28, v[212:215] offset:5120
s_waitcnt lgkmcnt(6)
v_mfma_f32_32x32x16_bf16 v[104:119], v[56:59], v[248:251], v[104:119]
v_mfma_f32_32x32x16_bf16 v[120:135], v[56:59], v[252:255], v[120:135]
v_and_b32 v44, 31, v1
v_lshlrev_b32 v44, 2, v44
v_add_u32 v44, 162816, v44
v_mov_b32 v45, 0x7149f2ca
s_nop 6
v_add_f32 v160, v160, v104
v_mul_f32 v40, 0x3fb8aa3b, v160
v_exp_f32 v41, v40
v_exp_f32 v42, -v40
v_add_f32 v41, 1.0, v41
v_add_f32 v42, 1.0, v42
v_min_f32 v41, v41, v45
v_rcp_f32 v42, v42
s_nop 0
v_mul_f32 v42, 0x35e38e39, v42
ds_write_b32 v44, v41 offset:0
ds_write_b32 v44, v42 offset:256
v_add_f32 v176, v176, v120
v_mul_f32 v40, 0x3fb8aa3b, v176
v_exp_f32 v41, v40
v_exp_f32 v42, -v40
v_add_f32 v41, 1.0, v41
v_add_f32 v42, 1.0, v42
v_min_f32 v41, v41, v45
v_rcp_f32 v42, v42
s_nop 0
v_mul_f32 v42, 0x35e38e39, v42
ds_write_b32 v44, v41 offset:128
ds_write_b32 v44, v42 offset:384
s_branch Lkf_join0
Lkf_pn:
s_waitcnt vmcnt(12)
s_barrier
s_mul_i32 s40, s37, 57
s_lshr_b32 s40, s40, 9
s_mul_i32 s40, s40, 9
s_sub_u32 s40, s37, s40
s_mul_i32 s41, s38, 20480
s_add_u32 s41, s41, 73728
s_mul_i32 s3, s36, 1152
s_add_u32 s12, s12, s3
s_addc_u32 s13, s13, 0
s_and_b32 s13, s13, 0xffff
s_mov_b32 s14, 0
s_mov_b32 s15, 0x20000
s_sub_u32 s14, 5308416, s3
s_mul_i32 s44, s44, 589824
s_mul_i32 s45, s45, 589824
s_mul_i32 s46, s46, 589824
s_mul_i32 s47, s47, 589824
s_mul_i32 s48, s48, 589824
s_mul_i32 s49, s49, 589824
s_mul_i32 s50, s50, 589824
s_mul_i32 s51, s51, 589824
s_mul_i32 s52, s52, 589824
s_add_u32 s65, 8, s40
s_sub_u32 s3, s65, 9
s_cmp_ge_u32 s65, 9
s_cselect_b32 s65, s3, s65
s_lshl_b32 s97, s65, 7
s_mul_i32 s3, s38, 147456
s_add_u32 s65, s97, s3
s_lshl_b32 s66, s38, 1
s_add_u32 s63, s66, s40
s_sub_u32 s3, s63, 9
s_cmp_ge_u32 s63, 9
s_cselect_b32 s63, s3, s63
s_add_u32 s66, s66, 1
s_add_u32 s64, s66, s40
s_sub_u32 s3, s64, 9
s_cmp_ge_u32 s64, 9
s_cselect_b32 s64, s3, s64
s_lshl_b32 s63, s63, 7
s_lshl_b32 s64, s64, 7
v_lshrrev_b32 v69, 3, v1
v_bfe_u32 v70, v1, 4, 1
v_lshlrev_b32 v70, 2, v70
v_xor_b32 v70, v70, v1
v_and_b32 v70, 7, v70
v_lshlrev_b32 v70, 4, v70
v_mul_u32_u24 v4, 9216, v69
v_add_u32 v4, v4, v70
v_add_u32 v5, 72704, v4
v_mul_u32_u24 v6, 1152, v69
v_add_u32 v6, v6, v70
v_add_u32 v7, 8192, v6
v_bfe_u32 v40, v1, 2, 2
v_lshlrev_b32 v41, 7, v40
v_lshrrev_b32 v40, 1, v40
v_lshl_add_u32 v41, v40, 6, v41
v_bfe_u32 v40, v1, 4, 1
v_lshl_add_u32 v41, v40, 5, v41
v_add_u32 v41, s41, v41
v_and_b32 v8, 3, v1
v_lshl_add_u32 v8, v8, 3, v41
v_and_b32 v40, 1, v1
v_lshl_add_u32 v41, v40, 4, v41
v_bfe_u32 v40, v1, 1, 1
v_lshl_add_u32 v41, v40, 3, v41
v_lshrrev_b32 v40, 5, v1
v_lshl_add_u32 v8, v40, 10, v8
v_xor_b32 v9, 64, v8
v_lshl_add_u32 v10, v40, 9, v41
v_xor_b32 v11, 64, v10
v_lshlrev_b32 v12, 4, v1
v_add_u32 v28, 155648, v12
v_add_u32 v100, 0x10000, v96
v_add_u32 v101, 0x10000, v97
v_add_u32 v102, 0x10000, v98
v_add_u32 v103, 0x10000, v99
s_add_u32 m0, s41, 0
s_add_u32 s42, s44, s65
buffer_load_dwordx4 v4, s[12:15], s42 offen lds
buffer_load_dwordx4 v5, s[12:15], s42 offen offset:1024 lds
s_add_u32 m0, s41, 2048
s_add_u32 s42, s45, s65
buffer_load_dwordx4 v4, s[12:15], s42 offen lds
buffer_load_dwordx4 v5, s[12:15], s42 offen offset:1024 lds
s_add_u32 m0, s41, 4096
s_add_u32 s42, s46, s65
buffer_load_dwordx4 v4, s[12:15], s42 offen lds
buffer_load_dwordx4 v5, s[12:15], s42 offen offset:1024 lds
s_add_u32 m0, s41, 6144
s_add_u32 s42, s47, s65
buffer_load_dwordx4 v4, s[12:15], s42 offen lds
buffer_load_dwordx4 v5, s[12:15], s42 offen offset:1024 lds
s_waitcnt vmcnt(8)
s_barrier
s_and_b32 s3, s38, 1
s_lshl_b32 s75, s36, 1
s_add_u32 s75, s75, s3
s_mov_b32 s74, s37
s_lshr_b32 s30, s38, 1
s_and_b32 s3, s36, 6
s_lshl_b32 s3, s3, 2
s_add_u32 s3, s3, s38
s_add_u32 s66, s36, 10
s_cmp_eq_u32 s3, 24
s_cselect_b32 s75, s66, s75
s_cselect_b32 s30, 1, s30
s_lshl_b32 s3, s36, 2
s_add_u32 s3, s3, s38
s_cmp_eq_u32 s3, 5
s_cselect_b32 s3, s37, 99
s_cmp_lt_u32 s3, 18
s_cselect_b32 s75, s37, s75
s_cselect_b32 s74, 32, s74
s_cselect_b32 s30, 1, s30
s_and_b32 s21, s21, 0xffff
s_mov_b32 s22, 1183744
s_mov_b32 s23, 0x20000
s_and_b32 s25, s25, 0xffff
s_mov_b32 s26, 1183744
s_mov_b32 s27, 0x20000
s_cmp_eq_u32 s30, 1
s_cbranch_scc0 Lsk_wl_5
v_lshrrev_b32 v104, 1, v1
v_lshl_add_u32 v104, v104, 6, s74
v_sub_u32 v105, 2048, v104
v_and_b32 v105, 2047, v105
v_and_b32 v106, 1, v1
v_lshlrev_b32 v106, 4, v106
s_movk_i32 s67, 578
v_mad_u32_u24 v104, v104, s67, v106
v_mad_u32_u24 v105, v105, s67, v106
s_lshl_b32 s67, s75, 5
buffer_load_dwordx4 v[32:35], v104, s[20:23], s67 offen
buffer_load_dwordx4 v[36:39], v104, s[24:27], s67 offen
buffer_load_dwordx4 v[88:91], v105, s[20:23], s67 offen
buffer_load_dwordx4 v[92:95], v105, s[24:27], s67 offen
s_sub_u32 s3, s30, 1
s_or_b32 s3, s3, s75
s_cbranch_scc1 Lsk_g0l_6
v_and_b32 v104, 31, v1
v_lshlrev_b32 v104, 6, v104
v_add_u32 v104, s74, v104
v_sub_u32 v105, 2048, v104
v_and_b32 v105, 2047, v105
v_mul_u32_u24 v104, 578, v104
v_mul_u32_u24 v105, 578, v105
buffer_load_ushort v128, v104, s[20:23], 0 offen offset:0
buffer_load_ushort v129, v104, s[24:27], 0 offen offset:0
buffer_load_ushort v130, v105, s[20:23], 0 offen offset:0
buffer_load_ushort v131, v105, s[24:27], 0 offen offset:0
buffer_load_ushort v132, v104, s[20:23], 0 offen offset:576
buffer_load_ushort v133, v104, s[24:27], 0 offen offset:576
buffer_load_ushort v134, v105, s[20:23], 0 offen offset:576
buffer_load_ushort v135, v105, s[24:27], 0 offen offset:576
Lsk_g0l_6:
Lsk_wl_5:
s_add_u32 m0, s41, 8192
s_add_u32 s42, s48, s65
buffer_load_dwordx4 v4, s[12:15], s42 offen lds
buffer_load_dwordx4 v5, s[12:15], s42 offen offset:1024 lds
s_add_u32 m0, s41, 10240
s_add_u32 s42, s49, s65
buffer_load_dwordx4 v4, s[12:15], s42 offen lds
buffer_load_dwordx4 v5, s[12:15], s42 offen offset:1024 lds
s_add_u32 m0, s41, 12288
s_add_u32 s42, s50, s65
buffer_load_dwordx4 v4, s[12:15], s42 offen lds
buffer_load_dwordx4 v5, s[12:15], s42 offen offset:1024 lds
s_add_u32 m0, s41, 14336
s_add_u32 s42, s51, s65
buffer_load_dwordx4 v4, s[12:15], s42 offen lds
buffer_load_dwordx4 v5, s[12:15], s42 offen offset:1024 lds
s_add_u32 m0, s41, 16384
s_add_u32 s42, s52, s65
buffer_load_dwordx4 v4, s[12:15], s42 offen lds
buffer_load_dwordx4 v5, s[12:15], s42 offen offset:1024 lds
s_barrier
ds_read_b128 a[0:3], v96 offset:0
ds_read_b128 a[4:7], v96 offset:4096
ds_read_b128 a[8:11], v97 offset:0
ds_read_b128 a[12:15], v97 offset:4096
ds_read_b128 a[16:19], v98 offset:0
ds_read_b128 a[20:23], v98 offset:4096
ds_read_b128 a[24:27], v99 offset:0
ds_read_b128 a[28:31], v99 offset:4096
ds_read_b128 a[32:35], v96 offset:8192
ds_read_b128 a[36:39], v96 offset:12288
ds_read_b128 a[40:43], v97 offset:8192
ds_read_b128 a[44:47], v97 offset:12288
ds_read_b128 a[48:51], v98 offset:8192
ds_read_b128 a[52:55], v98 offset:12288
ds_read_b128 a[56:59], v99 offset:8192
ds_read_b128 a[60:63], v99 offset:12288
ds_read_b128 a[64:67], v96 offset:16384
ds_read_b128 a[68:71], v96 offset:20480
ds_read_b128 a[72:75], v97 offset:16384
ds_read_b128 a[76:79], v97 offset:20480
ds_read_b128 a[80:83], v98 offset:16384
ds_read_b128 a[84:87], v98 offset:20480
ds_read_b128 a[88:91], v99 offset:16384
ds_read_b128 a[92:95], v99 offset:20480
ds_read_b128 a[96:99], v96 offset:24576
ds_read_b128 a[100:103], v96 offset:28672
ds_read_b128 a[104:107], v97 offset:24576
ds_read_b128 a[108:111], v97 offset:28672
ds_read_b128 a[112:115], v98 offset:24576
ds_read_b128 a[116:119], v98 offset:28672
ds_read_b128 a[120:123], v99 offset:24576
ds_read_b128 a[124:127], v99 offset:28672
ds_read_b128 a[128:131], v96 offset:32768
ds_read_b128 a[132:135], v96 offset:36864
ds_read_b128 a[136:139], v97 offset:32768
ds_read_b128 a[140:143], v97 offset:36864
ds_read_b128 a[144:147], v98 offset:32768
ds_read_b128 a[148:151], v98 offset:36864
ds_read_b128 a[152:155], v99 offset:32768
ds_read_b128 a[156:159], v99 offset:36864
ds_read_b128 a[160:163], v96 offset:40960
ds_read_b128 a[164:167], v96 offset:45056
ds_read_b128 a[168:171], v97 offset:40960
ds_read_b128 a[172:175], v97 offset:45056
ds_read_b128 a[176:179], v98 offset:40960
ds_read_b128 a[180:183], v98 offset:45056
ds_read_b128 a[184:187], v99 offset:40960
ds_read_b128 a[188:191], v99 offset:45056
ds_read_b128 a[192:195], v96 offset:49152
ds_read_b128 a[196:199], v96 offset:53248
ds_read_b128 a[200:203], v97 offset:49152
ds_read_b128 a[204:207], v97 offset:53248
ds_read_b128 a[208:211], v98 offset:49152
ds_read_b128 a[212:215], v98 offset:53248
ds_read_b128 a[216:219], v99 offset:49152
ds_read_b128 a[220:223], v99 offset:53248
ds_read_b128 a[224:227], v96 offset:57344
ds_read_b128 a[228:231], v96 offset:61440
ds_read_b128 a[232:235], v97 offset:57344
ds_read_b128 a[236:239], v97 offset:61440
ds_read_b128 a[240:243], v98 offset:57344
ds_read_b128 a[244:247], v98 offset:61440
ds_read_b128 a[248:251], v99 offset:57344
ds_read_b128 a[252:255], v99 offset:61440
ds_read_b128 v[224:227], v100 offset:0
ds_read_b128 v[228:231], v100 offset:4096
ds_read_b128 v[232:235], v101 offset:0
ds_read_b128 v[236:239], v101 offset:4096
ds_read_b128 v[240:243], v102 offset:0
ds_read_b128 v[244:247], v102 offset:4096
ds_read_b128 v[248:251], v103 offset:0
ds_read_b128 v[252:255], v103 offset:4096
s_barrier
Lkf_join0:
s_waitcnt lgkmcnt(0)
s_waitcnt vmcnt(16)
ds_read_b64_tr_b16 v[72:73], v8 offset:0
ds_read_b64_tr_b16 v[74:75], v8 offset:512
ds_read_b64_tr_b16 v[76:77], v9 offset:0
ds_read_b64_tr_b16 v[78:79], v9 offset:512
s_cmp_eq_u32 s38, 1
s_cbranch_scc1 Lq1_1
s_cmp_eq_u32 s38, 2
s_cbranch_scc1 Lq1_2
s_cmp_eq_u32 s38, 3
s_cbranch_scc1 Lq1_3
s_waitcnt lgkmcnt(2)
v_mfma_f32_32x32x16_bf16 v[160:175], v[72:75], a[0:3], 0
s_waitcnt vmcnt(14)
ds_read_b64_tr_b16 v[80:81], v8 offset:2048
ds_read_b64_tr_b16 v[82:83], v8 offset:2560
v_mfma_f32_32x32x16_bf16 v[176:191], v[72:75], a[4:7], 0
s_add_u32 m0, s41, 18432
s_add_u32 s42, s44, s63
buffer_load_dwordx4 v4, s[12:15], s42 offen lds
v_mov_b32 v25, 67108864
s_mul_i32 s3, s28, 1088
s_add_u32 s3, s3, s37
s_lshl_b32 s3, s3, 2
s_add_u32 s3, s3, 25165824
s_cmp_eq_u32 s29, 1
s_cselect_b32 s3, s3, 67108864
v_writelane_b32 v25, s3, 0
s_waitcnt lgkmcnt(2)
v_mfma_f32_32x32x16_bf16 v[192:207], v[76:79], a[0:3], 0
ds_read_b64_tr_b16 v[84:85], v9 offset:2048
ds_read_b64_tr_b16 v[86:87], v9 offset:2560
s_mul_i32 s3, s75, 1088
s_add_u32 s3, s3, s74
s_lshl_b32 s3, s3, 2
v_mfma_f32_32x32x16_bf16 v[208:223], v[76:79], a[4:7], 0
buffer_load_dwordx4 v5, s[12:15], s42 offen offset:1024 lds
s_add_u32 s3, s3, 25247744
s_cmp_eq_u32 s30, 1
s_cselect_b32 s3, s3, 67108864
v_writelane_b32 v25, s3, 1
s_mul_i32 s3, s37, 12
s_waitcnt lgkmcnt(2)
v_mfma_f32_32x32x16_bf16 v[160:175], v[80:83], a[32:35], v[160:175]
s_waitcnt vmcnt(14)
ds_read_b64_tr_b16 v[72:73], v8 offset:4096
ds_read_b64_tr_b16 v[74:75], v8 offset:4608
s_add_u32 s3, s3, s38
v_mfma_f32_32x32x16_bf16 v[176:191], v[80:83], a[36:39], v[176:191]
s_add_u32 m0, s41, 0
s_add_u32 s42, s42, 147456
buffer_load_dwordx4 v4, s[12:15], s42 offen lds
s_mul_i32 s3, s3, 1088
s_add_u32 s3, s3, s36
s_waitcnt lgkmcnt(2)
v_mfma_f32_32x32x16_bf16 v[192:207], v[84:87], a[32:35], v[192:207]
ds_read_b64_tr_b16 v[76:77], v9 offset:4096
ds_read_b64_tr_b16 v[78:79], v9 offset:4608
s_lshl_b32 s3, s3, 2
v_mfma_f32_32x32x16_bf16 v[208:223], v[84:87], a[36:39], v[208:223]
buffer_load_dwordx4 v5, s[12:15], s42 offen offset:1024 lds
s_add_u32 s3, s3, 25329664
v_writelane_b32 v25, s3, 2
s_waitcnt lgkmcnt(2)
v_mfma_f32_32x32x16_bf16 v[160:175], v[72:75], a[64:67], v[160:175]
s_waitcnt vmcnt(14)
ds_read_b64_tr_b16 v[80:81], v8 offset:6144
ds_read_b64_tr_b16 v[82:83], v8 offset:6656
s_add_u32 s3, s3, 17408
v_mfma_f32_32x32x16_bf16 v[176:191], v[72:75], a[68:71], v[176:191]
s_add_u32 m0, s41, 2048
s_add_u32 s42, s42, 147456
buffer_load_dwordx4 v4, s[12:15], s42 offen lds
v_writelane_b32 v25, s3, 3
s_add_u32 s3, s3, 17408
s_waitcnt lgkmcnt(2)
v_mfma_f32_32x32x16_bf16 v[192:207], v[76:79], a[64:67], v[192:207]
ds_read_b64_tr_b16 v[84:85], v9 offset:6144
ds_read_b64_tr_b16 v[86:87], v9 offset:6656
v_writelane_b32 v25, s3, 4
v_mfma_f32_32x32x16_bf16 v[208:223], v[76:79], a[68:71], v[208:223]
buffer_load_dwordx4 v5, s[12:15], s42 offen offset:1024 lds
s_lshl_b32 s3, s38, 13
s_add_u32 s3, s3, 8192
v_add_u32 v14, s3, v12
v_add_u32 v13, 32768, v12
s_lshr_b32 s3, s38, 1
s_lshl_b32 s3, s3, 12
s_and_b32 s43, s38, 1
s_waitcnt lgkmcnt(2)
v_mfma_f32_32x32x16_bf16 v[160:175], v[80:83], a[96:99], v[160:175]
s_waitcnt vmcnt(14)
ds_read_b64_tr_b16 v[72:73], v8 offset:8192
ds_read_b64_tr_b16 v[74:75], v8 offset:8704
s_lshl_b32 s43, s43, 10
s_add_u32 s3, s3, s43
v_add_u32 v15, s3, v12
v_mfma_f32_32x32x16_bf16 v[176:191], v[80:83], a[100:103], v[176:191]
s_add_u32 m0, s41, 4096
s_add_u32 s42, s42, 147456
buffer_load_dwordx4 v4, s[12:15], s42 offen lds
s_add_u32 s3, s38, 1
s_and_b32 s3, s3, 3
s_mul_i32 s3, s3, 12288
s_waitcnt lgkmcnt(2)
v_mfma_f32_32x32x16_bf16 v[192:207], v[84:87], a[96:99], v[192:207]
ds_read_b64_tr_b16 v[76:77], v9 offset:8192
ds_read_b64_tr_b16 v[78:79], v9 offset:8704
s_add_u32 s3, s3, 24576
v_add_u32 v16, s3, v12
s_add_u32 s3, s38, 2
s_and_b32 s3, s3, 3
s_mul_i32 s3, s3, 12288
v_mfma_f32_32x32x16_bf16 v[208:223], v[84:87], a[100:103], v[208:223]
buffer_load_dwordx4 v5, s[12:15], s42 offen offset:1024 lds
s_add_u32 s3, s3, 28672
v_add_u32 v17, s3, v12
s_waitcnt lgkmcnt(2)
v_mfma_f32_32x32x16_bf16 v[160:175], v[72:75], a[128:131], v[160:175]
s_waitcnt vmcnt(14)
ds_read_b64_tr_b16 v[80:81], v8 offset:10240
ds_read_b64_tr_b16 v[82:83], v8 offset:10752
s_add_u32 s3, s38, 3
s_and_b32 s3, s3, 3
s_mul_i32 s3, s3, 12288
s_add_u32 s3, s3, 32768
v_add_u32 v18, s3, v12
v_mfma_f32_32x32x16_bf16 v[176:191], v[72:75], a[132:135], v[176:191]
s_add_u32 m0, s41, 6144
s_add_u32 s42, s45, s63
buffer_load_dwordx4 v4, s[12:15], s42 offen lds
s_mul_i32 s96, s38, 12288
s_waitcnt lgkmcnt(2)
v_mfma_f32_32x32x16_bf16 v[192:207], v[76:79], a[128:131], v[192:207]
ds_read_b64_tr_b16 v[84:85], v9 offset:10240
ds_read_b64_tr_b16 v[86:87], v9 offset:10752
s_add_u32 s96, s96, 24576
v_add_u32 v19, s96, v12
v_mfma_f32_32x32x16_bf16 v[208:223], v[76:79], a[132:135], v[208:223]
buffer_load_dwordx4 v5, s[12:15], s42 offen offset:1024 lds
v_lshrrev_b32 v41, 2, v1
s_waitcnt lgkmcnt(2)
v_mfma_f32_32x32x16_bf16 v[160:175], v[80:83], a[160:163], v[160:175]
s_waitcnt vmcnt(14)
ds_read_b64_tr_b16 v[72:73], v8 offset:12288
ds_read_b64_tr_b16 v[74:75], v8 offset:12800
v_lshlrev_b32 v26, 7, v41
v_and_b32 v41, 1, v1
v_mfma_f32_32x32x16_bf16 v[176:191], v[80:83], a[164:167], v[176:191]
s_add_u32 m0, s41, 8192
s_add_u32 s42, s42, 147456
buffer_load_dwordx4 v4, s[12:15], s42 offen lds
v_lshl_add_u32 v26, v41, 4, v26
s_waitcnt lgkmcnt(2)
v_mfma_f32_32x32x16_bf16 v[192:207], v[84:87], a[160:163], v[192:207]
ds_read_b64_tr_b16 v[76:77], v9 offset:12288
ds_read_b64_tr_b16 v[78:79], v9 offset:12800
v_bfe_u32 v41, v1, 1, 1
v_lshl_add_u32 v26, v41, 3, v26
v_mfma_f32_32x32x16_bf16 v[208:223], v[84:87], a[164:167], v[208:223]
buffer_load_dwordx4 v5, s[12:15], s42 offen offset:1024 lds
v_add_u32 v26, s96, v26
s_waitcnt lgkmcnt(2)
v_mfma_f32_32x32x16_bf16 v[160:175], v[72:75], a[192:195], v[160:175]
s_waitcnt vmcnt(14)
ds_read_b64_tr_b16 v[80:81], v8 offset:14336
ds_read_b64_tr_b16 v[82:83], v8 offset:14848
s_mul_i32 s31, s74, 18
s_add_u32 s31, s31, s75
v_mfma_f32_32x32x16_bf16 v[176:191], v[72:75], a[196:199], v[176:191]
s_add_u32 m0, s41, 10240
s_add_u32 s42, s42, 147456
buffer_load_dwordx4 v4, s[12:15], s42 offen lds
s_lshl_b32 s31, s31, 12
s_waitcnt lgkmcnt(2)
v_mfma_f32_32x32x16_bf16 v[192:207], v[76:79], a[192:195], v[192:207]
ds_read_b64_tr_b16 v[84:85], v9 offset:14336
ds_read_b64_tr_b16 v[86:87], v9 offset:14848
s_add_u32 s31, s31, 18874368
v_mfma_f32_32x32x16_bf16 v[208:223], v[76:79], a[196:199], v[208:223]
buffer_load_dwordx4 v5, s[12:15], s42 offen offset:1024 lds
s_waitcnt vmcnt(14)
s_mov_b64 exec, 1
buffer_store_dword v25, v25, s[4:7], 0 offen sc1
s_mov_b64 exec, -1
s_waitcnt lgkmcnt(2)
v_mfma_f32_32x32x16_bf16 v[160:175], v[80:83], a[224:227], v[160:175]
ds_read_b64_tr_b16 v[72:73], v8 offset:16384
ds_read_b64_tr_b16 v[74:75], v8 offset:16896
v_mfma_f32_32x32x16_bf16 v[176:191], v[80:83], a[228:231], v[176:191]
s_add_u32 m0, s41, 12288
s_add_u32 s42, s42, 147456
buffer_load_dwordx4 v4, s[12:15], s42 offen lds
s_waitcnt lgkmcnt(2)
v_mfma_f32_32x32x16_bf16 v[192:207], v[84:87], a[224:227], v[192:207]
ds_read_b64_tr_b16 v[76:77], v9 offset:16384
ds_read_b64_tr_b16 v[78:79], v9 offset:16896
v_mfma_f32_32x32x16_bf16 v[208:223], v[84:87], a[228:231], v[208:223]
buffer_load_dwordx4 v5, s[12:15], s42 offen offset:1024 lds
s_waitcnt lgkmcnt(2)
v_mfma_f32_32x32x16_bf16 v[160:175], v[72:75], v[224:227], v[160:175]
s_waitcnt vmcnt(15)
ds_read_b64_tr_b16 v[80:81], v8 offset:18432
ds_read_b64_tr_b16 v[82:83], v8 offset:18944
v_mfma_f32_32x32x16_bf16 v[176:191], v[72:75], v[228:231], v[176:191]
s_add_u32 m0, s41, 14336
s_add_u32 s42, s46, s63
buffer_load_dwordx4 v4, s[12:15], s42 offen lds
s_waitcnt lgkmcnt(2)
v_mfma_f32_32x32x16_bf16 v[192:207], v[76:79], v[224:227], v[192:207]
ds_read_b64_tr_b16 v[84:85], v9 offset:18432
ds_read_b64_tr_b16 v[86:87], v9 offset:18944
v_mfma_f32_32x32x16_bf16 v[208:223], v[76:79], v[228:231], v[208:223]
buffer_load_dwordx4 v5, s[12:15], s42 offen offset:1024 lds
s_sub_u32 s3, s30, 1
s_or_b32 s3, s3, s75
s_cbranch_scc1 Lsk_g0c_7
v_lshlrev_b32 v128, 16, v128
v_lshlrev_b32 v129, 16, v129
v_lshlrev_b32 v130, 16, v130
v_lshlrev_b32 v131, 16, v131
v_lshlrev_b32 v132, 16, v132
v_lshlrev_b32 v133, 16, v133
v_lshlrev_b32 v134, 16, v134
v_lshlrev_b32 v135, 16, v135
v_add_f32 v136, v128, v130
v_sub_f32 v137, v129, v131
v_add_f32 v138, v132, v134
v_sub_f32 v139, v133, v135
v_add_f32 v140, v136, v138
v_add_f32 v141, v137, v139
v_sub_f32 v142, v136, v138
v_sub_f32 v143, v137, v139
v_mul_f32 v140, 0.25, v140
v_mul_f32 v141, 0.25, v141
v_mul_f32 v142, 0.25, v142
v_mul_f32 v143, 0.25, v143
ds_write_b128 v28, v[140:143] offset:6144
Lsk_g0c_7:
s_branch Lq1_j
Lq1_1:
s_waitcnt lgkmcnt(2)
v_mfma_f32_32x32x16_bf16 v[208:223], v[72:75], a[8:11], 0
s_waitcnt vmcnt(14)
ds_read_b64_tr_b16 v[80:81], v8 offset:2048
ds_read_b64_tr_b16 v[82:83], v8 offset:2560
v_mfma_f32_32x32x16_bf16 v[160:175], v[72:75], a[12:15], 0
s_add_u32 m0, s41, 18432
s_add_u32 s42, s44, s63
buffer_load_dwordx4 v4, s[12:15], s42 offen lds
v_mov_b32 v25, 67108864
s_mul_i32 s3, s28, 1088
s_add_u32 s3, s3, s37
s_lshl_b32 s3, s3, 2
s_add_u32 s3, s3, 25165824
s_cmp_eq_u32 s29, 1
s_cselect_b32 s3, s3, 67108864
v_writelane_b32 v25, s3, 0
s_waitcnt lgkmcnt(2)
v_mfma_f32_32x32x16_bf16 v[176:191], v[76:79], a[8:11], 0
ds_read_b64_tr_b16 v[84:85], v9 offset:2048
ds_read_b64_tr_b16 v[86:87], v9 offset:2560
s_mul_i32 s3, s75, 1088
s_add_u32 s3, s3, s74
s_lshl_b32 s3, s3, 2
v_mfma_f32_32x32x16_bf16 v[192:207], v[76:79], a[12:15], 0
buffer_load_dwordx4 v5, s[12:15], s42 offen offset:1024 lds
s_add_u32 s3, s3, 25247744
s_cmp_eq_u32 s30, 1
s_cselect_b32 s3, s3, 67108864
v_writelane_b32 v25, s3, 1
s_mul_i32 s3, s37, 12
s_waitcnt lgkmcnt(2)
v_mfma_f32_32x32x16_bf16 v[208:223], v[80:83], a[40:43], v[208:223]
s_waitcnt vmcnt(14)
ds_read_b64_tr_b16 v[72:73], v8 offset:4096
ds_read_b64_tr_b16 v[74:75], v8 offset:4608
s_add_u32 s3, s3, s38
v_mfma_f32_32x32x16_bf16 v[160:175], v[80:83], a[44:47], v[160:175]
s_add_u32 m0, s41, 0
s_add_u32 s42, s42, 147456
buffer_load_dwordx4 v4, s[12:15], s42 offen lds
s_mul_i32 s3, s3, 1088
s_add_u32 s3, s3, s36
s_waitcnt lgkmcnt(2)
v_mfma_f32_32x32x16_bf16 v[176:191], v[84:87], a[40:43], v[176:191]
ds_read_b64_tr_b16 v[76:77], v9 offset:4096
ds_read_b64_tr_b16 v[78:79], v9 offset:4608
s_lshl_b32 s3, s3, 2
v_mfma_f32_32x32x16_bf16 v[192:207], v[84:87], a[44:47], v[192:207]
buffer_load_dwordx4 v5, s[12:15], s42 offen offset:1024 lds
s_add_u32 s3, s3, 25329664
v_writelane_b32 v25, s3, 2
s_waitcnt lgkmcnt(2)
v_mfma_f32_32x32x16_bf16 v[208:223], v[72:75], a[72:75], v[208:223]
s_waitcnt vmcnt(14)
ds_read_b64_tr_b16 v[80:81], v8 offset:6144
ds_read_b64_tr_b16 v[82:83], v8 offset:6656
s_add_u32 s3, s3, 17408
v_mfma_f32_32x32x16_bf16 v[160:175], v[72:75], a[76:79], v[160:175]
s_add_u32 m0, s41, 2048
s_add_u32 s42, s42, 147456
buffer_load_dwordx4 v4, s[12:15], s42 offen lds
v_writelane_b32 v25, s3, 3
s_add_u32 s3, s3, 17408
s_waitcnt lgkmcnt(2)
v_mfma_f32_32x32x16_bf16 v[176:191], v[76:79], a[72:75], v[176:191]
ds_read_b64_tr_b16 v[84:85], v9 offset:6144
ds_read_b64_tr_b16 v[86:87], v9 offset:6656
v_writelane_b32 v25, s3, 4
v_mfma_f32_32x32x16_bf16 v[192:207], v[76:79], a[76:79], v[192:207]
buffer_load_dwordx4 v5, s[12:15], s42 offen offset:1024 lds
s_lshl_b32 s3, s38, 13
s_add_u32 s3, s3, 8192
v_add_u32 v14, s3, v12
v_add_u32 v13, 32768, v12
s_lshr_b32 s3, s38, 1
s_lshl_b32 s3, s3, 12
s_and_b32 s43, s38, 1
s_waitcnt lgkmcnt(2)
v_mfma_f32_32x32x16_bf16 v[208:223], v[80:83], a[104:107], v[208:223]
s_waitcnt vmcnt(14)
ds_read_b64_tr_b16 v[72:73], v8 offset:8192
ds_read_b64_tr_b16 v[74:75], v8 offset:8704
s_lshl_b32 s43, s43, 10
s_add_u32 s3, s3, s43
v_add_u32 v15, s3, v12
v_mfma_f32_32x32x16_bf16 v[160:175], v[80:83], a[108:111], v[160:175]
s_add_u32 m0, s41, 4096
s_add_u32 s42, s42, 147456
buffer_load_dwordx4 v4, s[12:15], s42 offen lds
s_add_u32 s3, s38, 1
s_and_b32 s3, s3, 3
s_mul_i32 s3, s3, 12288
s_waitcnt lgkmcnt(2)
v_mfma_f32_32x32x16_bf16 v[176:191], v[84:87], a[104:107], v[176:191]
ds_read_b64_tr_b16 v[76:77], v9 offset:8192
ds_read_b64_tr_b16 v[78:79], v9 offset:8704
s_add_u32 s3, s3, 24576
v_add_u32 v16, s3, v12
s_add_u32 s3, s38, 2
s_and_b32 s3, s3, 3
s_mul_i32 s3, s3, 12288
v_mfma_f32_32x32x16_bf16 v[192:207], v[84:87], a[108:111], v[192:207]
buffer_load_dwordx4 v5, s[12:15], s42 offen offset:1024 lds
s_add_u32 s3, s3, 28672
v_add_u32 v17, s3, v12
s_waitcnt lgkmcnt(2)
v_mfma_f32_32x32x16_bf16 v[208:223], v[72:75], a[136:139], v[208:223]
s_waitcnt vmcnt(14)
ds_read_b64_tr_b16 v[80:81], v8 offset:10240
ds_read_b64_tr_b16 v[82:83], v8 offset:10752
s_add_u32 s3, s38, 3
s_and_b32 s3, s3, 3
s_mul_i32 s3, s3, 12288
s_add_u32 s3, s3, 32768
v_add_u32 v18, s3, v12
v_mfma_f32_32x32x16_bf16 v[160:175], v[72:75], a[140:143], v[160:175]
s_add_u32 m0, s41, 6144
s_add_u32 s42, s45, s63
buffer_load_dwordx4 v4, s[12:15], s42 offen lds
s_mul_i32 s96, s38, 12288
s_waitcnt lgkmcnt(2)
v_mfma_f32_32x32x16_bf16 v[176:191], v[76:79], a[136:139], v[176:191]
ds_read_b64_tr_b16 v[84:85], v9 offset:10240
ds_read_b64_tr_b16 v[86:87], v9 offset:10752
s_add_u32 s96, s96, 24576
v_add_u32 v19, s96, v12
v_mfma_f32_32x32x16_bf16 v[192:207], v[76:79], a[140:143], v[192:207]
buffer_load_dwordx4 v5, s[12:15], s42 offen offset:1024 lds
v_lshrrev_b32 v41, 2, v1
s_waitcnt lgkmcnt(2)
v_mfma_f32_32x32x16_bf16 v[208:223], v[80:83], a[168:171], v[208:223]
s_waitcnt vmcnt(14)
ds_read_b64_tr_b16 v[72:73], v8 offset:12288
ds_read_b64_tr_b16 v[74:75], v8 offset:12800
v_lshlrev_b32 v26, 7, v41
v_and_b32 v41, 1, v1
v_mfma_f32_32x32x16_bf16 v[160:175], v[80:83], a[172:175], v[160:175]
s_add_u32 m0, s41, 8192
s_add_u32 s42, s42, 147456
buffer_load_dwordx4 v4, s[12:15], s42 offen lds
v_lshl_add_u32 v26, v41, 4, v26
s_waitcnt lgkmcnt(2)
v_mfma_f32_32x32x16_bf16 v[176:191], v[84:87], a[168:171], v[176:191]
ds_read_b64_tr_b16 v[76:77], v9 offset:12288
ds_read_b64_tr_b16 v[78:79], v9 offset:12800
v_bfe_u32 v41, v1, 1, 1
v_lshl_add_u32 v26, v41, 3, v26
v_mfma_f32_32x32x16_bf16 v[192:207], v[84:87], a[172:175], v[192:207]
buffer_load_dwordx4 v5, s[12:15], s42 offen offset:1024 lds
v_add_u32 v26, s96, v26
s_waitcnt lgkmcnt(2)
v_mfma_f32_32x32x16_bf16 v[208:223], v[72:75], a[200:203], v[208:223]
s_waitcnt vmcnt(14)
ds_read_b64_tr_b16 v[80:81], v8 offset:14336
ds_read_b64_tr_b16 v[82:83], v8 offset:14848
s_mul_i32 s31, s74, 18
s_add_u32 s31, s31, s75
v_mfma_f32_32x32x16_bf16 v[160:175], v[72:75], a[204:207], v[160:175]
s_add_u32 m0, s41, 10240
s_add_u32 s42, s42, 147456
buffer_load_dwordx4 v4, s[12:15], s42 offen lds
s_lshl_b32 s31, s31, 12
s_waitcnt lgkmcnt(2)
v_mfma_f32_32x32x16_bf16 v[176:191], v[76:79], a[200:203], v[176:191]
ds_read_b64_tr_b16 v[84:85], v9 offset:14336
ds_read_b64_tr_b16 v[86:87], v9 offset:14848
s_add_u32 s31, s31, 18874368
v_mfma_f32_32x32x16_bf16 v[192:207], v[76:79], a[204:207], v[192:207]
buffer_load_dwordx4 v5, s[12:15], s42 offen offset:1024 lds
s_waitcnt vmcnt(14)
s_mov_b64 exec, 1
buffer_store_dword v25, v25, s[4:7], 0 offen sc1
s_mov_b64 exec, -1
s_waitcnt lgkmcnt(2)
v_mfma_f32_32x32x16_bf16 v[208:223], v[80:83], a[232:235], v[208:223]
ds_read_b64_tr_b16 v[72:73], v8 offset:16384
ds_read_b64_tr_b16 v[74:75], v8 offset:16896
v_mfma_f32_32x32x16_bf16 v[160:175], v[80:83], a[236:239], v[160:175]
s_add_u32 m0, s41, 12288
s_add_u32 s42, s42, 147456
buffer_load_dwordx4 v4, s[12:15], s42 offen lds
s_waitcnt lgkmcnt(2)
v_mfma_f32_32x32x16_bf16 v[176:191], v[84:87], a[232:235], v[176:191]
ds_read_b64_tr_b16 v[76:77], v9 offset:16384
ds_read_b64_tr_b16 v[78:79], v9 offset:16896
v_mfma_f32_32x32x16_bf16 v[192:207], v[84:87], a[236:239], v[192:207]
buffer_load_dwordx4 v5, s[12:15], s42 offen offset:1024 lds
s_waitcnt lgkmcnt(2)
v_mfma_f32_32x32x16_bf16 v[208:223], v[72:75], v[232:235], v[208:223]
s_waitcnt vmcnt(15)
ds_read_b64_tr_b16 v[80:81], v8 offset:18432
ds_read_b64_tr_b16 v[82:83], v8 offset:18944
v_mfma_f32_32x32x16_bf16 v[160:175], v[72:75], v[236:239], v[160:175]
s_add_u32 m0, s41, 14336
s_add_u32 s42, s46, s63
buffer_load_dwordx4 v4, s[12:15], s42 offen lds
s_waitcnt lgkmcnt(2)
v_mfma_f32_32x32x16_bf16 v[176:191], v[76:79], v[232:235], v[176:191]
ds_read_b64_tr_b16 v[84:85], v9 offset:18432
ds_read_b64_tr_b16 v[86:87], v9 offset:18944
v_mfma_f32_32x32x16_bf16 v[192:207], v[76:79], v[236:239], v[192:207]
buffer_load_dwordx4 v5, s[12:15], s42 offen offset:1024 lds
s_sub_u32 s3, s30, 1
s_or_b32 s3, s3, s75
s_cbranch_scc1 Lsk_g0c_8
v_lshlrev_b32 v128, 16, v128
v_lshlrev_b32 v129, 16, v129
v_lshlrev_b32 v130, 16, v130
v_lshlrev_b32 v131, 16, v131
v_lshlrev_b32 v132, 16, v132
v_lshlrev_b32 v133, 16, v133
v_lshlrev_b32 v134, 16, v134
v_lshlrev_b32 v135, 16, v135
v_add_f32 v136, v128, v130
v_sub_f32 v137, v129, v131
v_add_f32 v138, v132, v134
v_sub_f32 v139, v133, v135
v_add_f32 v140, v136, v138
v_add_f32 v141, v137, v139
v_sub_f32 v142, v136, v138
v_sub_f32 v143, v137, v139
v_mul_f32 v140, 0.25, v140
v_mul_f32 v141, 0.25, v141
v_mul_f32 v142, 0.25, v142
v_mul_f32 v143, 0.25, v143
ds_write_b128 v28, v[140:143] offset:6144
Lsk_g0c_8:
s_branch Lq1_j
Lq1_2:
s_waitcnt lgkmcnt(2)
v_mfma_f32_32x32x16_bf16 v[192:207], v[72:75], a[16:19], 0
s_waitcnt vmcnt(14)
ds_read_b64_tr_b16 v[80:81], v8 offset:2048
ds_read_b64_tr_b16 v[82:83], v8 offset:2560
v_mfma_f32_32x32x16_bf16 v[208:223], v[72:75], a[20:23], 0
s_add_u32 m0, s41, 18432
s_add_u32 s42, s44, s63
buffer_load_dwordx4 v4, s[12:15], s42 offen lds
v_mov_b32 v25, 67108864
s_mul_i32 s3, s28, 1088
s_add_u32 s3, s3, s37
s_lshl_b32 s3, s3, 2
s_add_u32 s3, s3, 25165824
s_cmp_eq_u32 s29, 1
s_cselect_b32 s3, s3, 67108864
v_writelane_b32 v25, s3, 0
s_waitcnt lgkmcnt(2)
v_mfma_f32_32x32x16_bf16 v[160:175], v[76:79], a[16:19], 0
ds_read_b64_tr_b16 v[84:85], v9 offset:2048
ds_read_b64_tr_b16 v[86:87], v9 offset:2560
s_mul_i32 s3, s75, 1088
s_add_u32 s3, s3, s74
s_lshl_b32 s3, s3, 2
v_mfma_f32_32x32x16_bf16 v[176:191], v[76:79], a[20:23], 0
buffer_load_dwordx4 v5, s[12:15], s42 offen offset:1024 lds
s_add_u32 s3, s3, 25247744
s_cmp_eq_u32 s30, 1
s_cselect_b32 s3, s3, 67108864
v_writelane_b32 v25, s3, 1
s_mul_i32 s3, s37, 12
s_waitcnt lgkmcnt(2)
v_mfma_f32_32x32x16_bf16 v[192:207], v[80:83], a[48:51], v[192:207]
s_waitcnt vmcnt(14)
ds_read_b64_tr_b16 v[72:73], v8 offset:4096
ds_read_b64_tr_b16 v[74:75], v8 offset:4608
s_add_u32 s3, s3, s38
v_mfma_f32_32x32x16_bf16 v[208:223], v[80:83], a[52:55], v[208:223]
s_add_u32 m0, s41, 0
s_add_u32 s42, s42, 147456
buffer_load_dwordx4 v4, s[12:15], s42 offen lds
s_mul_i32 s3, s3, 1088
s_add_u32 s3, s3, s36
s_waitcnt lgkmcnt(2)
v_mfma_f32_32x32x16_bf16 v[160:175], v[84:87], a[48:51], v[160:175]
ds_read_b64_tr_b16 v[76:77], v9 offset:4096
ds_read_b64_tr_b16 v[78:79], v9 offset:4608
s_lshl_b32 s3, s3, 2
v_mfma_f32_32x32x16_bf16 v[176:191], v[84:87], a[52:55], v[176:191]
buffer_load_dwordx4 v5, s[12:15], s42 offen offset:1024 lds
s_add_u32 s3, s3, 25329664
v_writelane_b32 v25, s3, 2
s_waitcnt lgkmcnt(2)
v_mfma_f32_32x32x16_bf16 v[192:207], v[72:75], a[80:83], v[192:207]
s_waitcnt vmcnt(14)
ds_read_b64_tr_b16 v[80:81], v8 offset:6144
ds_read_b64_tr_b16 v[82:83], v8 offset:6656
s_add_u32 s3, s3, 17408
v_mfma_f32_32x32x16_bf16 v[208:223], v[72:75], a[84:87], v[208:223]
s_add_u32 m0, s41, 2048
s_add_u32 s42, s42, 147456
buffer_load_dwordx4 v4, s[12:15], s42 offen lds
v_writelane_b32 v25, s3, 3
s_add_u32 s3, s3, 17408
s_waitcnt lgkmcnt(2)
v_mfma_f32_32x32x16_bf16 v[160:175], v[76:79], a[80:83], v[160:175]
ds_read_b64_tr_b16 v[84:85], v9 offset:6144
ds_read_b64_tr_b16 v[86:87], v9 offset:6656
v_writelane_b32 v25, s3, 4
v_mfma_f32_32x32x16_bf16 v[176:191], v[76:79], a[84:87], v[176:191]
buffer_load_dwordx4 v5, s[12:15], s42 offen offset:1024 lds
s_lshl_b32 s3, s38, 13
s_add_u32 s3, s3, 8192
v_add_u32 v14, s3, v12
v_add_u32 v13, 32768, v12
s_lshr_b32 s3, s38, 1
s_lshl_b32 s3, s3, 12
s_and_b32 s43, s38, 1
s_waitcnt lgkmcnt(2)
v_mfma_f32_32x32x16_bf16 v[192:207], v[80:83], a[112:115], v[192:207]
s_waitcnt vmcnt(14)
ds_read_b64_tr_b16 v[72:73], v8 offset:8192
ds_read_b64_tr_b16 v[74:75], v8 offset:8704
s_lshl_b32 s43, s43, 10
s_add_u32 s3, s3, s43
v_add_u32 v15, s3, v12
v_mfma_f32_32x32x16_bf16 v[208:223], v[80:83], a[116:119], v[208:223]
s_add_u32 m0, s41, 4096
s_add_u32 s42, s42, 147456
buffer_load_dwordx4 v4, s[12:15], s42 offen lds
s_add_u32 s3, s38, 1
s_and_b32 s3, s3, 3
s_mul_i32 s3, s3, 12288
s_waitcnt lgkmcnt(2)
v_mfma_f32_32x32x16_bf16 v[160:175], v[84:87], a[112:115], v[160:175]
ds_read_b64_tr_b16 v[76:77], v9 offset:8192
ds_read_b64_tr_b16 v[78:79], v9 offset:8704
s_add_u32 s3, s3, 24576
v_add_u32 v16, s3, v12
s_add_u32 s3, s38, 2
s_and_b32 s3, s3, 3
s_mul_i32 s3, s3, 12288
v_mfma_f32_32x32x16_bf16 v[176:191], v[84:87], a[116:119], v[176:191]
buffer_load_dwordx4 v5, s[12:15], s42 offen offset:1024 lds
s_add_u32 s3, s3, 28672
v_add_u32 v17, s3, v12
s_waitcnt lgkmcnt(2)
v_mfma_f32_32x32x16_bf16 v[192:207], v[72:75], a[144:147], v[192:207]
s_waitcnt vmcnt(14)
ds_read_b64_tr_b16 v[80:81], v8 offset:10240
ds_read_b64_tr_b16 v[82:83], v8 offset:10752
s_add_u32 s3, s38, 3
s_and_b32 s3, s3, 3
s_mul_i32 s3, s3, 12288
s_add_u32 s3, s3, 32768
v_add_u32 v18, s3, v12
v_mfma_f32_32x32x16_bf16 v[208:223], v[72:75], a[148:151], v[208:223]
s_add_u32 m0, s41, 6144
s_add_u32 s42, s45, s63
buffer_load_dwordx4 v4, s[12:15], s42 offen lds
s_mul_i32 s96, s38, 12288
s_waitcnt lgkmcnt(2)
v_mfma_f32_32x32x16_bf16 v[160:175], v[76:79], a[144:147], v[160:175]
ds_read_b64_tr_b16 v[84:85], v9 offset:10240
ds_read_b64_tr_b16 v[86:87], v9 offset:10752
s_add_u32 s96, s96, 24576
v_add_u32 v19, s96, v12
v_mfma_f32_32x32x16_bf16 v[176:191], v[76:79], a[148:151], v[176:191]
buffer_load_dwordx4 v5, s[12:15], s42 offen offset:1024 lds
v_lshrrev_b32 v41, 2, v1
s_waitcnt lgkmcnt(2)
v_mfma_f32_32x32x16_bf16 v[192:207], v[80:83], a[176:179], v[192:207]
s_waitcnt vmcnt(14)
ds_read_b64_tr_b16 v[72:73], v8 offset:12288
ds_read_b64_tr_b16 v[74:75], v8 offset:12800
v_lshlrev_b32 v26, 7, v41
v_and_b32 v41, 1, v1
v_mfma_f32_32x32x16_bf16 v[208:223], v[80:83], a[180:183], v[208:223]
s_add_u32 m0, s41, 8192
s_add_u32 s42, s42, 147456
buffer_load_dwordx4 v4, s[12:15], s42 offen lds
v_lshl_add_u32 v26, v41, 4, v26
s_waitcnt lgkmcnt(2)
v_mfma_f32_32x32x16_bf16 v[160:175], v[84:87], a[176:179], v[160:175]
ds_read_b64_tr_b16 v[76:77], v9 offset:12288
ds_read_b64_tr_b16 v[78:79], v9 offset:12800
v_bfe_u32 v41, v1, 1, 1
v_lshl_add_u32 v26, v41, 3, v26
v_mfma_f32_32x32x16_bf16 v[176:191], v[84:87], a[180:183], v[176:191]
buffer_load_dwordx4 v5, s[12:15], s42 offen offset:1024 lds
v_add_u32 v26, s96, v26
s_waitcnt lgkmcnt(2)
v_mfma_f32_32x32x16_bf16 v[192:207], v[72:75], a[208:211], v[192:207]
s_waitcnt vmcnt(14)
ds_read_b64_tr_b16 v[80:81], v8 offset:14336
ds_read_b64_tr_b16 v[82:83], v8 offset:14848
s_mul_i32 s31, s74, 18
s_add_u32 s31, s31, s75
v_mfma_f32_32x32x16_bf16 v[208:223], v[72:75], a[212:215], v[208:223]
s_add_u32 m0, s41, 10240
s_add_u32 s42, s42, 147456
buffer_load_dwordx4 v4, s[12:15], s42 offen lds
s_lshl_b32 s31, s31, 12
s_waitcnt lgkmcnt(2)
v_mfma_f32_32x32x16_bf16 v[160:175], v[76:79], a[208:211], v[160:175]
ds_read_b64_tr_b16 v[84:85], v9 offset:14336
ds_read_b64_tr_b16 v[86:87], v9 offset:14848
s_add_u32 s31, s31, 18874368
v_mfma_f32_32x32x16_bf16 v[176:191], v[76:79], a[212:215], v[176:191]
buffer_load_dwordx4 v5, s[12:15], s42 offen offset:1024 lds
s_waitcnt vmcnt(14)
s_mov_b64 exec, 1
buffer_store_dword v25, v25, s[4:7], 0 offen sc1
s_mov_b64 exec, -1
s_waitcnt lgkmcnt(2)
v_mfma_f32_32x32x16_bf16 v[192:207], v[80:83], a[240:243], v[192:207]
ds_read_b64_tr_b16 v[72:73], v8 offset:16384
ds_read_b64_tr_b16 v[74:75], v8 offset:16896
v_mfma_f32_32x32x16_bf16 v[208:223], v[80:83], a[244:247], v[208:223]
s_add_u32 m0, s41, 12288
s_add_u32 s42, s42, 147456
buffer_load_dwordx4 v4, s[12:15], s42 offen lds
s_waitcnt lgkmcnt(2)
v_mfma_f32_32x32x16_bf16 v[160:175], v[84:87], a[240:243], v[160:175]
ds_read_b64_tr_b16 v[76:77], v9 offset:16384
ds_read_b64_tr_b16 v[78:79], v9 offset:16896
v_mfma_f32_32x32x16_bf16 v[176:191], v[84:87], a[244:247], v[176:191]
buffer_load_dwordx4 v5, s[12:15], s42 offen offset:1024 lds
s_waitcnt lgkmcnt(2)
v_mfma_f32_32x32x16_bf16 v[192:207], v[72:75], v[240:243], v[192:207]
s_waitcnt vmcnt(15)
ds_read_b64_tr_b16 v[80:81], v8 offset:18432
ds_read_b64_tr_b16 v[82:83], v8 offset:18944
v_mfma_f32_32x32x16_bf16 v[208:223], v[72:75], v[244:247], v[208:223]
s_add_u32 m0, s41, 14336
s_add_u32 s42, s46, s63
buffer_load_dwordx4 v4, s[12:15], s42 offen lds
s_waitcnt lgkmcnt(2)
v_mfma_f32_32x32x16_bf16 v[160:175], v[76:79], v[240:243], v[160:175]
ds_read_b64_tr_b16 v[84:85], v9 offset:18432
ds_read_b64_tr_b16 v[86:87], v9 offset:18944
v_mfma_f32_32x32x16_bf16 v[176:191], v[76:79], v[244:247], v[176:191]
buffer_load_dwordx4 v5, s[12:15], s42 offen offset:1024 lds
s_sub_u32 s3, s30, 1
s_or_b32 s3, s3, s75
s_cbranch_scc1 Lsk_g0c_9
v_lshlrev_b32 v128, 16, v128
v_lshlrev_b32 v129, 16, v129
v_lshlrev_b32 v130, 16, v130
v_lshlrev_b32 v131, 16, v131
v_lshlrev_b32 v132, 16, v132
v_lshlrev_b32 v133, 16, v133
v_lshlrev_b32 v134, 16, v134
v_lshlrev_b32 v135, 16, v135
v_add_f32 v136, v128, v130
v_sub_f32 v137, v129, v131
v_add_f32 v138, v132, v134
v_sub_f32 v139, v133, v135
v_add_f32 v140, v136, v138
v_add_f32 v141, v137, v139
v_sub_f32 v142, v136, v138
v_sub_f32 v143, v137, v139
v_mul_f32 v140, 0.25, v140
v_mul_f32 v141, 0.25, v141
v_mul_f32 v142, 0.25, v142
v_mul_f32 v143, 0.25, v143
ds_write_b128 v28, v[140:143] offset:6144
Lsk_g0c_9:
s_branch Lq1_j
Lq1_3:
s_waitcnt lgkmcnt(2)
v_mfma_f32_32x32x16_bf16 v[176:191], v[72:75], a[24:27], 0
s_waitcnt vmcnt(14)
ds_read_b64_tr_b16 v[80:81], v8 offset:2048
ds_read_b64_tr_b16 v[82:83], v8 offset:2560
v_mfma_f32_32x32x16_bf16 v[192:207], v[72:75], a[28:31], 0
s_add_u32 m0, s41, 18432
s_add_u32 s42, s44, s63
buffer_load_dwordx4 v4, s[12:15], s42 offen lds
v_mov_b32 v25, 67108864
s_mul_i32 s3, s28, 1088
s_add_u32 s3, s3, s37
s_lshl_b32 s3, s3, 2
s_add_u32 s3, s3, 25165824
s_cmp_eq_u32 s29, 1
s_cselect_b32 s3, s3, 67108864
v_writelane_b32 v25, s3, 0
s_waitcnt lgkmcnt(2)
v_mfma_f32_32x32x16_bf16 v[208:223], v[76:79], a[24:27], 0
ds_read_b64_tr_b16 v[84:85], v9 offset:2048
ds_read_b64_tr_b16 v[86:87], v9 offset:2560
s_mul_i32 s3, s75, 1088
s_add_u32 s3, s3, s74
s_lshl_b32 s3, s3, 2
v_mfma_f32_32x32x16_bf16 v[160:175], v[76:79], a[28:31], 0
buffer_load_dwordx4 v5, s[12:15], s42 offen offset:1024 lds
s_add_u32 s3, s3, 25247744
s_cmp_eq_u32 s30, 1
s_cselect_b32 s3, s3, 67108864
v_writelane_b32 v25, s3, 1
s_mul_i32 s3, s37, 12
s_waitcnt lgkmcnt(2)
v_mfma_f32_32x32x16_bf16 v[176:191], v[80:83], a[56:59], v[176:191]
s_waitcnt vmcnt(14)
ds_read_b64_tr_b16 v[72:73], v8 offset:4096
ds_read_b64_tr_b16 v[74:75], v8 offset:4608
s_add_u32 s3, s3, s38
v_mfma_f32_32x32x16_bf16 v[192:207], v[80:83], a[60:63], v[192:207]
s_add_u32 m0, s41, 0
s_add_u32 s42, s42, 147456
buffer_load_dwordx4 v4, s[12:15], s42 offen lds
s_mul_i32 s3, s3, 1088
s_add_u32 s3, s3, s36
s_waitcnt lgkmcnt(2)
v_mfma_f32_32x32x16_bf16 v[208:223], v[84:87], a[56:59], v[208:223]
ds_read_b64_tr_b16 v[76:77], v9 offset:4096
ds_read_b64_tr_b16 v[78:79], v9 offset:4608
s_lshl_b32 s3, s3, 2
v_mfma_f32_32x32x16_bf16 v[160:175], v[84:87], a[60:63], v[160:175]
buffer_load_dwordx4 v5, s[12:15], s42 offen offset:1024 lds
s_add_u32 s3, s3, 25329664
v_writelane_b32 v25, s3, 2
s_waitcnt lgkmcnt(2)
v_mfma_f32_32x32x16_bf16 v[176:191], v[72:75], a[88:91], v[176:191]
s_waitcnt vmcnt(14)
ds_read_b64_tr_b16 v[80:81], v8 offset:6144
ds_read_b64_tr_b16 v[82:83], v8 offset:6656
s_add_u32 s3, s3, 17408
v_mfma_f32_32x32x16_bf16 v[192:207], v[72:75], a[92:95], v[192:207]
s_add_u32 m0, s41, 2048
s_add_u32 s42, s42, 147456
buffer_load_dwordx4 v4, s[12:15], s42 offen lds
v_writelane_b32 v25, s3, 3
s_add_u32 s3, s3, 17408
s_waitcnt lgkmcnt(2)
v_mfma_f32_32x32x16_bf16 v[208:223], v[76:79], a[88:91], v[208:223]
ds_read_b64_tr_b16 v[84:85], v9 offset:6144
ds_read_b64_tr_b16 v[86:87], v9 offset:6656
v_writelane_b32 v25, s3, 4
v_mfma_f32_32x32x16_bf16 v[160:175], v[76:79], a[92:95], v[160:175]
buffer_load_dwordx4 v5, s[12:15], s42 offen offset:1024 lds
s_lshl_b32 s3, s38, 13
s_add_u32 s3, s3, 8192
v_add_u32 v14, s3, v12
v_add_u32 v13, 32768, v12
s_lshr_b32 s3, s38, 1
s_lshl_b32 s3, s3, 12
s_and_b32 s43, s38, 1
s_waitcnt lgkmcnt(2)
v_mfma_f32_32x32x16_bf16 v[176:191], v[80:83], a[120:123], v[176:191]
s_waitcnt vmcnt(14)
ds_read_b64_tr_b16 v[72:73], v8 offset:8192
ds_read_b64_tr_b16 v[74:75], v8 offset:8704
s_lshl_b32 s43, s43, 10
s_add_u32 s3, s3, s43
v_add_u32 v15, s3, v12
v_mfma_f32_32x32x16_bf16 v[192:207], v[80:83], a[124:127], v[192:207]
s_add_u32 m0, s41, 4096
s_add_u32 s42, s42, 147456
buffer_load_dwordx4 v4, s[12:15], s42 offen lds
s_add_u32 s3, s38, 1
s_and_b32 s3, s3, 3
s_mul_i32 s3, s3, 12288
s_waitcnt lgkmcnt(2)
v_mfma_f32_32x32x16_bf16 v[208:223], v[84:87], a[120:123], v[208:223]
ds_read_b64_tr_b16 v[76:77], v9 offset:8192
ds_read_b64_tr_b16 v[78:79], v9 offset:8704
s_add_u32 s3, s3, 24576
v_add_u32 v16, s3, v12
s_add_u32 s3, s38, 2
s_and_b32 s3, s3, 3
s_mul_i32 s3, s3, 12288
v_mfma_f32_32x32x16_bf16 v[160:175], v[84:87], a[124:127], v[160:175]
buffer_load_dwordx4 v5, s[12:15], s42 offen offset:1024 lds
s_add_u32 s3, s3, 28672
v_add_u32 v17, s3, v12
s_waitcnt lgkmcnt(2)
v_mfma_f32_32x32x16_bf16 v[176:191], v[72:75], a[152:155], v[176:191]
s_waitcnt vmcnt(14)
ds_read_b64_tr_b16 v[80:81], v8 offset:10240
ds_read_b64_tr_b16 v[82:83], v8 offset:10752
s_add_u32 s3, s38, 3
s_and_b32 s3, s3, 3
s_mul_i32 s3, s3, 12288
s_add_u32 s3, s3, 32768
v_add_u32 v18, s3, v12
v_mfma_f32_32x32x16_bf16 v[192:207], v[72:75], a[156:159], v[192:207]
s_add_u32 m0, s41, 6144
s_add_u32 s42, s45, s63
buffer_load_dwordx4 v4, s[12:15], s42 offen lds
s_mul_i32 s96, s38, 12288
s_waitcnt lgkmcnt(2)
v_mfma_f32_32x32x16_bf16 v[208:223], v[76:79], a[152:155], v[208:223]
ds_read_b64_tr_b16 v[84:85], v9 offset:10240
ds_read_b64_tr_b16 v[86:87], v9 offset:10752
s_add_u32 s96, s96, 24576
v_add_u32 v19, s96, v12
v_mfma_f32_32x32x16_bf16 v[160:175], v[76:79], a[156:159], v[160:175]
buffer_load_dwordx4 v5, s[12:15], s42 offen offset:1024 lds
v_lshrrev_b32 v41, 2, v1
s_waitcnt lgkmcnt(2)
v_mfma_f32_32x32x16_bf16 v[176:191], v[80:83], a[184:187], v[176:191]
s_waitcnt vmcnt(14)
ds_read_b64_tr_b16 v[72:73], v8 offset:12288
ds_read_b64_tr_b16 v[74:75], v8 offset:12800
v_lshlrev_b32 v26, 7, v41
v_and_b32 v41, 1, v1
v_mfma_f32_32x32x16_bf16 v[192:207], v[80:83], a[188:191], v[192:207]
s_add_u32 m0, s41, 8192
s_add_u32 s42, s42, 147456
buffer_load_dwordx4 v4, s[12:15], s42 offen lds
v_lshl_add_u32 v26, v41, 4, v26
s_waitcnt lgkmcnt(2)
v_mfma_f32_32x32x16_bf16 v[208:223], v[84:87], a[184:187], v[208:223]
ds_read_b64_tr_b16 v[76:77], v9 offset:12288
ds_read_b64_tr_b16 v[78:79], v9 offset:12800
v_bfe_u32 v41, v1, 1, 1
v_lshl_add_u32 v26, v41, 3, v26
v_mfma_f32_32x32x16_bf16 v[160:175], v[84:87], a[188:191], v[160:175]
buffer_load_dwordx4 v5, s[12:15], s42 offen offset:1024 lds
v_add_u32 v26, s96, v26
s_waitcnt lgkmcnt(2)
v_mfma_f32_32x32x16_bf16 v[176:191], v[72:75], a[216:219], v[176:191]
s_waitcnt vmcnt(14)
ds_read_b64_tr_b16 v[80:81], v8 offset:14336
ds_read_b64_tr_b16 v[82:83], v8 offset:14848
s_mul_i32 s31, s74, 18
s_add_u32 s31, s31, s75
v_mfma_f32_32x32x16_bf16 v[192:207], v[72:75], a[220:223], v[192:207]
s_add_u32 m0, s41, 10240
s_add_u32 s42, s42, 147456
buffer_load_dwordx4 v4, s[12:15], s42 offen lds
s_lshl_b32 s31, s31, 12
s_waitcnt lgkmcnt(2)
v_mfma_f32_32x32x16_bf16 v[208:223], v[76:79], a[216:219], v[208:223]
ds_read_b64_tr_b16 v[84:85], v9 offset:14336
ds_read_b64_tr_b16 v[86:87], v9 offset:14848
s_add_u32 s31, s31, 18874368
v_mfma_f32_32x32x16_bf16 v[160:175], v[76:79], a[220:223], v[160:175]
buffer_load_dwordx4 v5, s[12:15], s42 offen offset:1024 lds
s_waitcnt vmcnt(14)
s_mov_b64 exec, 1
buffer_store_dword v25, v25, s[4:7], 0 offen sc1
s_mov_b64 exec, -1
s_waitcnt lgkmcnt(2)
v_mfma_f32_32x32x16_bf16 v[176:191], v[80:83], a[248:251], v[176:191]
ds_read_b64_tr_b16 v[72:73], v8 offset:16384
ds_read_b64_tr_b16 v[74:75], v8 offset:16896
v_mfma_f32_32x32x16_bf16 v[192:207], v[80:83], a[252:255], v[192:207]
s_add_u32 m0, s41, 12288
s_add_u32 s42, s42, 147456
buffer_load_dwordx4 v4, s[12:15], s42 offen lds
s_waitcnt lgkmcnt(2)
v_mfma_f32_32x32x16_bf16 v[208:223], v[84:87], a[248:251], v[208:223]
ds_read_b64_tr_b16 v[76:77], v9 offset:16384
ds_read_b64_tr_b16 v[78:79], v9 offset:16896
v_mfma_f32_32x32x16_bf16 v[160:175], v[84:87], a[252:255], v[160:175]
buffer_load_dwordx4 v5, s[12:15], s42 offen offset:1024 lds
s_waitcnt lgkmcnt(2)
v_mfma_f32_32x32x16_bf16 v[176:191], v[72:75], v[248:251], v[176:191]
s_waitcnt vmcnt(15)
ds_read_b64_tr_b16 v[80:81], v8 offset:18432
ds_read_b64_tr_b16 v[82:83], v8 offset:18944
v_mfma_f32_32x32x16_bf16 v[192:207], v[72:75], v[252:255], v[192:207]
s_add_u32 m0, s41, 14336
s_add_u32 s42, s46, s63
buffer_load_dwordx4 v4, s[12:15], s42 offen lds
s_waitcnt lgkmcnt(2)
v_mfma_f32_32x32x16_bf16 v[208:223], v[76:79], v[248:251], v[208:223]
ds_read_b64_tr_b16 v[84:85], v9 offset:18432
ds_read_b64_tr_b16 v[86:87], v9 offset:18944
v_mfma_f32_32x32x16_bf16 v[160:175], v[76:79], v[252:255], v[160:175]
buffer_load_dwordx4 v5, s[12:15], s42 offen offset:1024 lds
s_sub_u32 s3, s30, 1
s_or_b32 s3, s3, s75
s_cbranch_scc1 Lsk_g0c_10
v_lshlrev_b32 v128, 16, v128
v_lshlrev_b32 v129, 16, v129
v_lshlrev_b32 v130, 16, v130
v_lshlrev_b32 v131, 16, v131
v_lshlrev_b32 v132, 16, v132
v_lshlrev_b32 v133, 16, v133
v_lshlrev_b32 v134, 16, v134
v_lshlrev_b32 v135, 16, v135
v_add_f32 v136, v128, v130
v_sub_f32 v137, v129, v131
v_add_f32 v138, v132, v134
v_sub_f32 v139, v133, v135
v_add_f32 v140, v136, v138
v_add_f32 v141, v137, v139
v_sub_f32 v142, v136, v138
v_sub_f32 v143, v137, v139
v_mul_f32 v140, 0.25, v140
v_mul_f32 v141, 0.25, v141
v_mul_f32 v142, 0.25, v142
v_mul_f32 v143, 0.25, v143
ds_write_b128 v28, v[140:143] offset:6144
Lsk_g0c_10:
Lq1_j:
s_mov_b32 s20, 0x3f80
s_mov_b32 s21, 0x3f800000
s_waitcnt lgkmcnt(2)
v_mfma_f32_32x32x16_bf16 v[96:111], v[80:83], a[0:3], 0
s_waitcnt vmcnt(15)
ds_read_b64_tr_b16 v[72:73], v8 offset:0
ds_read_b64_tr_b16 v[74:75], v8 offset:512
v_mfma_f32_32x32x16_bf16 v[112:127], v[80:83], a[4:7], 0
s_add_u32 m0, s41, 16384
s_add_u32 s42, s42, 147456
buffer_load_dwordx4 v4, s[12:15], s42 offen lds
v_and_b32 v66, 7, v1
v_lshlrev_b32 v66, 5, v66
s_cmp_eq_u32 s38, 3
s_cbranch_scc0 Lsk_pc_11
global_load_dword v68, v66, s[72:73] sc1
Lsk_pc_11:
s_waitcnt lgkmcnt(2)
v_mfma_f32_32x32x16_bf16 v[128:143], v[84:87], a[0:3], 0
ds_read_b64_tr_b16 v[76:77], v9 offset:0
ds_read_b64_tr_b16 v[78:79], v9 offset:512
v_mfma_f32_32x32x16_bf16 v[144:159], v[84:87], a[4:7], 0
buffer_load_dwordx4 v5, s[12:15], s42 offen offset:1024 lds
s_waitcnt lgkmcnt(2)
v_mfma_f32_32x32x16_bf16 v[96:111], v[72:75], a[8:11], v[96:111]
s_waitcnt vmcnt(15)
ds_read_b64_tr_b16 v[80:81], v8 offset:2048
ds_read_b64_tr_b16 v[82:83], v8 offset:2560
s_barrier
ds_write_b128 v16, v[176:179] offset:0
v_mfma_f32_32x32x16_bf16 v[112:127], v[72:75], a[12:15], v[112:127]
s_add_u32 m0, s41, 18432
s_add_u32 s42, s42, 147456
buffer_load_dwordx4 v4, s[12:15], s42 offen lds
ds_write_b128 v16, v[180:183] offset:1024
s_lshl_b32 s8, s74, 7
s_cmp_eq_u32 s74, 32
s_cselect_b32 s8, 64, s8
s_lshl_b32 s26, s75, 12
s_waitcnt lgkmcnt(4)
v_mfma_f32_32x32x16_bf16 v[128:143], v[76:79], a[8:11], v[128:143]
ds_read_b64_tr_b16 v[84:85], v9 offset:2048
ds_read_b64_tr_b16 v[86:87], v9 offset:2560
ds_write_b128 v16, v[184:187] offset:2048
ds_write_b128 v16, v[188:191] offset:3072
s_add_u32 s8, s8, s26
s_add_u32 s8, s8, 21495808
v_mfma_f32_32x32x16_bf16 v[144:159], v[76:79], a[12:15], v[144:159]
buffer_load_dwordx4 v5, s[12:15], s42 offen offset:1024 lds
ds_write_b128 v17, v[192:195] offset:0
s_cmp_eq_u32 s30, 1
s_cselect_b32 s8, s8, 67108864
s_add_u32 s9, s8, 1179648
s_waitcnt lgkmcnt(7)
v_mfma_f32_32x32x16_bf16 v[96:111], v[80:83], a[16:19], v[96:111]
s_waitcnt vmcnt(15)
ds_read_b64_tr_b16 v[72:73], v8 offset:4096
ds_read_b64_tr_b16 v[74:75], v8 offset:4608
ds_write_b128 v17, v[196:199] offset:1024
s_and_b32 s26, s74, 31
s_cmp_eq_u32 s26, 0
s_cselect_b32 s10, 67108864, s8
v_mfma_f32_32x32x16_bf16 v[112:127], v[80:83], a[20:23], v[112:127]
s_add_u32 m0, s41, 0
s_add_u32 s42, s42, 147456
buffer_load_dwordx4 v4, s[12:15], s42 offen lds
ds_write_b128 v17, v[200:203] offset:2048
ds_write_b128 v17, v[204:207] offset:3072
s_add_u32 s11, s10, 1179648
s_mov_b32 s66, s63
s_waitcnt lgkmcnt(8)
v_mfma_f32_32x32x16_bf16 v[128:143], v[84:87], a[16:19], v[128:143]
ds_read_b64_tr_b16 v[76:77], v9 offset:4096
ds_read_b64_tr_b16 v[78:79], v9 offset:4608
ds_write_b128 v18, v[208:211] offset:0
s_mov_b32 s67, s64
s_mul_i32 s26, s37, 589824
v_mfma_f32_32x32x16_bf16 v[144:159], v[84:87], a[20:23], v[144:159]
buffer_load_dwordx4 v5, s[12:15], s42 offen offset:1024 lds
ds_write_b128 v18, v[212:215] offset:1024
s_mul_i32 s27, s36, 9216
s_add_u32 s27, s27, s26
s_waitcnt lgkmcnt(7)
v_mfma_f32_32x32x16_bf16 v[96:111], v[72:75], a[24:27], v[96:111]
s_waitcnt vmcnt(15)
ds_read_b64_tr_b16 v[80:81], v8 offset:6144
ds_read_b64_tr_b16 v[82:83], v8 offset:6656
ds_write_b128 v18, v[216:219] offset:2048
ds_write_b128 v18, v[220:223] offset:3072
s_lshl_b32 s69, s66, 3
s_add_u32 s69, s69, s27
v_mfma_f32_32x32x16_bf16 v[112:127], v[72:75], a[28:31], v[112:127]
s_add_u32 m0, s41, 2048
s_add_u32 s42, s47, s63
buffer_load_dwordx4 v4, s[12:15], s42 offen lds
v_and_b32 v64, 31, v1
s_lshl_b32 s70, s67, 3
s_add_u32 s70, s70, s27
s_waitcnt lgkmcnt(6)
v_mfma_f32_32x32x16_bf16 v[128:143], v[76:79], a[24:27], v[128:143]
ds_read_b64_tr_b16 v[84:85], v9 offset:6144
ds_read_b64_tr_b16 v[86:87], v9 offset:6656
v_lshlrev_b32 v64, 2, v64
v_add_u32 v64, 162816, v64
s_lshl_b32 s71, s97, 3
s_add_u32 s71, s71, s27
v_mfma_f32_32x32x16_bf16 v[144:159], v[76:79], a[28:31], v[144:159]
buffer_load_dwordx4 v5, s[12:15], s42 offen offset:1024 lds
s_and_b32 s3, s38, 1
s_lshr_b32 s26, s38, 1
s_lshl_b32 s26, s26, 9
s_waitcnt lgkmcnt(4)
v_mfma_f32_32x32x16_bf16 v[96:111], v[80:83], a[32:35], v[96:111]
s_waitcnt vmcnt(15)
ds_read_b64_tr_b16 v[72:73], v8 offset:8192
ds_read_b64_tr_b16 v[74:75], v8 offset:8704
s_lshl_b32 s3, s3, 7
s_add_u32 s71, s71, s26
s_and_b32 s26, s38, 1
v_mfma_f32_32x32x16_bf16 v[112:127], v[80:83], a[36:39], v[112:127]
s_add_u32 m0, s41, 4096
s_add_u32 s42, s42, 147456
buffer_load_dwordx4 v4, s[12:15], s42 offen lds
v_add_u32 v65, s3, v64
ds_read_b32 v3, v64
s_mul_i32 s26, s26, 294912
s_waitcnt lgkmcnt(3)
v_mfma_f32_32x32x16_bf16 v[128:143], v[84:87], a[32:35], v[128:143]
ds_read_b64_tr_b16 v[76:77], v9 offset:8192
ds_read_b64_tr_b16 v[78:79], v9 offset:8704
ds_read_b32 v31, v64 offset:128
s_add_u32 s71, s71, s26
s_mul_i32 s26, s38, 18432
v_mfma_f32_32x32x16_bf16 v[144:159], v[84:87], a[36:39], v[144:159]
buffer_load_dwordx4 v5, s[12:15], s42 offen offset:1024 lds
ds_read_b32 v2, v65
s_add_u32 s68, s97, s26
s_mul_i32 s26, s36, 663552
s_waitcnt lgkmcnt(5)
v_mfma_f32_32x32x16_bf16 v[96:111], v[72:75], a[40:43], v[96:111]
s_waitcnt vmcnt(15)
ds_read_b64_tr_b16 v[80:81], v8 offset:10240
ds_read_b64_tr_b16 v[82:83], v8 offset:10752
s_add_u32 s16, s16, s26
s_addc_u32 s17, s17, 0
s_and_b32 s17, s17, 0xffff
v_mfma_f32_32x32x16_bf16 v[112:127], v[72:75], a[44:47], v[112:127]
s_add_u32 m0, s41, 6144
s_add_u32 s42, s42, 147456
buffer_load_dwordx4 v4, s[12:15], s42 offen lds
s_mov_b32 s18, 663552
s_mov_b32 s19, 0x20000
s_waitcnt lgkmcnt(4)
v_mfma_f32_32x32x16_bf16 v[128:143], v[76:79], a[40:43], v[128:143]
ds_read_b64_tr_b16 v[84:85], v9 offset:10240
ds_read_b64_tr_b16 v[86:87], v9 offset:10752
s_and_b32 s33, s33, 0xffff
s_mov_b32 s34, 2359296
v_mfma_f32_32x32x16_bf16 v[144:159], v[76:79], a[44:47], v[144:159]
buffer_load_dwordx4 v5, s[12:15], s42 offen offset:1024 lds
s_cmp_eq_u32 s38, 3
s_cbranch_scc0 Lsk_cc_12
s_waitcnt vmcnt(11)
v_cmp_gt_u32 vcc, 32, v68
s_or_b64 vcc, vcc, vcc
s_cbranch_scc1 Lsp_C
Lbk_C:
Lsk_cc_12:
s_mov_b32 s35, 0x20000
v_lshrrev_b32 v60, 5, v1
s_waitcnt lgkmcnt(2)
v_mfma_f32_32x32x16_bf16 v[96:111], v[80:83], a[48:51], v[96:111]
s_waitcnt vmcnt(14)
ds_read_b64_tr_b16 v[72:73], v8 offset:12288
ds_read_b64_tr_b16 v[74:75], v8 offset:12800
v_bfe_u32 v61, v1, 3, 2
v_mul_u32_u24 v30, 73728, v61
v_mfma_f32_32x32x16_bf16 v[112:127], v[80:83], a[52:55], v[112:127]
s_add_u32 m0, s41, 8192
s_add_u32 s42, s42, 147456
buffer_load_dwordx4 v4, s[12:15], s42 offen lds
v_and_b32 v61, 7, v1
v_lshl_add_u32 v30, v61, 4, v30
s_barrier
s_waitcnt lgkmcnt(2)
v_mfma_f32_32x32x16_bf16 v[128:143], v[84:87], a[48:51], v[128:143]
ds_read_b64_tr_b16 v[76:77], v9 offset:12288
ds_read_b64_tr_b16 v[78:79], v9 offset:12800
v_lshl_add_u32 v30, v60, 7, v30
v_add_u32 v29, 294912, v30
ds_read_b128 v[176:179], v19 offset:0
v_mfma_f32_32x32x16_bf16 v[144:159], v[84:87], a[52:55], v[144:159]
buffer_load_dwordx4 v5, s[12:15], s42 offen offset:1024 lds
v_and_b32 v61, 15, v1
v_mul_u32_u24 v27, 73728, v61
ds_read_b128 v[180:183], v19 offset:1024
s_waitcnt lgkmcnt(4)
v_mfma_f32_32x32x16_bf16 v[96:111], v[72:75], a[56:59], v[96:111]
s_waitcnt vmcnt(14)
ds_read_b64_tr_b16 v[80:81], v8 offset:14336
ds_read_b64_tr_b16 v[82:83], v8 offset:14848
v_lshrrev_b32 v61, 4, v1
v_lshl_add_u32 v27, v61, 4, v27
ds_read_b128 v[184:187], v19 offset:2048
v_mfma_f32_32x32x16_bf16 v[112:127], v[72:75], a[60:63], v[112:127]
s_add_u32 m0, s41, 10240
s_add_u32 s42, s48, s63
buffer_load_dwordx4 v4, s[12:15], s42 offen lds
v_and_b32 v22, 19, v1
v_bfe_u32 v61, v1, 2, 1
ds_read_b128 v[188:191], v19 offset:3072
s_waitcnt lgkmcnt(6)
v_mfma_f32_32x32x16_bf16 v[128:143], v[76:79], a[56:59], v[128:143]
ds_read_b64_tr_b16 v[84:85], v9 offset:14336
ds_read_b64_tr_b16 v[86:87], v9 offset:14848
v_lshl_add_u32 v22, v61, 3, v22
ds_read_b128 v[192:195], v19 offset:4096
v_mfma_f32_32x32x16_bf16 v[144:159], v[76:79], a[60:63], v[144:159]
buffer_load_dwordx4 v5, s[12:15], s42 offen offset:1024 lds
v_bfe_u32 v61, v1, 3, 1
v_lshl_add_u32 v22, v61, 2, v22
s_waitcnt lgkmcnt(5)
v_mfma_f32_32x32x16_bf16 v[96:111], v[80:83], a[64:67], v[96:111]
s_waitcnt vmcnt(14)
ds_read_b64_tr_b16 v[72:73], v8 offset:16384
ds_read_b64_tr_b16 v[74:75], v8 offset:16896
v_cvt_f32_u32 v23, v60
v_mul_f32 v23, 0.25, v23
ds_read_b128 v[196:199], v19 offset:5120
v_mfma_f32_32x32x16_bf16 v[112:127], v[80:83], a[68:71], v[112:127]
s_add_u32 m0, s41, 12288
s_add_u32 s42, s42, 147456
buffer_load_dwordx4 v4, s[12:15], s42 offen lds
v_and_b32 v24, v60, v1
v_lshlrev_b32 v24, 31, v24
ds_read_b128 v[200:203], v19 offset:6144
s_waitcnt lgkmcnt(5)
v_mfma_f32_32x32x16_bf16 v[128:143], v[84:87], a[64:67], v[128:143]
ds_read_b64_tr_b16 v[76:77], v9 offset:16384
ds_read_b64_tr_b16 v[78:79], v9 offset:16896
v_or_b32 v24, 0.5, v24
s_add_u32 s54, 8, s40
s_sub_u32 s26, s54, 9
s_cmp_ge_u32 s54, 9
s_cselect_b32 s54, s26, s54
ds_read_b128 v[204:207], v19 offset:7168
v_mfma_f32_32x32x16_bf16 v[144:159], v[84:87], a[68:71], v[144:159]
buffer_load_dwordx4 v5, s[12:15], s42 offen offset:1024 lds
s_mul_i32 s54, s54, 73728
s_add_u32 s55, 0, s40
s_sub_u32 s26, s55, 9
s_cmp_ge_u32 s55, 9
s_cselect_b32 s55, s26, s55
ds_read_b128 v[208:211], v19 offset:8192
s_waitcnt lgkmcnt(6)
v_mfma_f32_32x32x16_bf16 v[96:111], v[72:75], a[72:75], v[96:111]
s_waitcnt vmcnt(14)
ds_read_b64_tr_b16 v[80:81], v8 offset:18432
ds_read_b64_tr_b16 v[82:83], v8 offset:18944
s_mul_i32 s55, s55, 73728
s_add_u32 s56, 2, s40
s_sub_u32 s26, s56, 9
s_cmp_ge_u32 s56, 9
s_cselect_b32 s56, s26, s56
ds_read_b128 v[212:215], v19 offset:9216
v_mfma_f32_32x32x16_bf16 v[112:127], v[72:75], a[76:79], v[112:127]
s_add_u32 m0, s41, 14336
s_add_u32 s42, s42, 147456
buffer_load_dwordx4 v4, s[12:15], s42 offen lds
s_mul_i32 s56, s56, 73728
s_add_u32 s57, 4, s40
s_sub_u32 s26, s57, 9
s_cmp_ge_u32 s57, 9
s_cselect_b32 s57, s26, s57
ds_read_b128 v[216:219], v19 offset:10240
s_waitcnt lgkmcnt(6)
v_mfma_f32_32x32x16_bf16 v[128:143], v[76:79], a[72:75], v[128:143]
ds_read_b64_tr_b16 v[84:85], v9 offset:18432
ds_read_b64_tr_b16 v[86:87], v9 offset:18944
s_mul_i32 s57, s57, 73728
s_add_u32 s58, 6, s40
s_sub_u32 s26, s58, 9
s_cmp_ge_u32 s58, 9
s_cselect_b32 s58, s26, s58
ds_read_b128 v[220:223], v19 offset:11264
v_mfma_f32_32x32x16_bf16 v[144:159], v[76:79], a[76:79], v[144:159]
buffer_load_dwordx4 v5, s[12:15], s42 offen offset:1024 lds
s_mul_i32 s58, s58, 73728
s_add_u32 s59, 1, s40
s_sub_u32 s26, s59, 9
s_cmp_ge_u32 s59, 9
s_cselect_b32 s59, s26, s59
s_waitcnt lgkmcnt(5)
v_mfma_f32_32x32x16_bf16 v[96:111], v[80:83], a[80:83], v[96:111]
s_waitcnt vmcnt(14)
ds_read_b64_tr_b16 v[72:73], v8 offset:0
ds_read_b64_tr_b16 v[74:75], v8 offset:512
s_mul_i32 s59, s59, 73728
s_add_u32 s60, 3, s40
s_sub_u32 s26, s60, 9
s_cmp_ge_u32 s60, 9
s_cselect_b32 s60, s26, s60
v_add_f32 v160, v160, v176
v_add_f32 v161, v161, v177
v_mfma_f32_32x32x16_bf16 v[112:127], v[80:83], a[84:87], v[112:127]
s_add_u32 m0, s41, 16384
s_add_u32 s42, s42, 147456
buffer_load_dwordx4 v4, s[12:15], s42 offen lds
s_mul_i32 s60, s60, 73728
s_add_u32 s61, 5, s40
s_sub_u32 s26, s61, 9
s_cmp_ge_u32 s61, 9
s_cselect_b32 s61, s26, s61
v_add_f32 v162, v162, v178
v_add_f32 v163, v163, v179
v_add_f32 v164, v164, v180
s_waitcnt lgkmcnt(3)
v_mfma_f32_32x32x16_bf16 v[128:143], v[84:87], a[80:83], v[128:143]
ds_read_b64_tr_b16 v[76:77], v9 offset:0
ds_read_b64_tr_b16 v[78:79], v9 offset:512
s_mul_i32 s61, s61, 73728
s_add_u32 s62, 7, s40
s_sub_u32 s26, s62, 9
s_cmp_ge_u32 s62, 9
s_cselect_b32 s62, s26, s62
v_add_f32 v165, v165, v181
v_add_f32 v166, v166, v182
v_add_f32 v167, v167, v183
v_mfma_f32_32x32x16_bf16 v[144:159], v[84:87], a[84:87], v[144:159]
buffer_load_dwordx4 v5, s[12:15], s42 offen offset:1024 lds
s_mul_i32 s62, s62, 73728
v_add_f32 v168, v168, v184
v_add_f32 v169, v169, v185
v_add_f32 v170, v170, v186
s_waitcnt lgkmcnt(2)
v_mfma_f32_32x32x16_bf16 v[96:111], v[72:75], a[88:91], v[96:111]
s_waitcnt vmcnt(14)
ds_read_b64_tr_b16 v[80:81], v8 offset:2048
ds_read_b64_tr_b16 v[82:83], v8 offset:2560
v_add_f32 v171, v171, v187
v_add_f32 v172, v172, v188
v_add_f32 v173, v173, v189
v_mfma_f32_32x32x16_bf16 v[112:127], v[72:75], a[92:95], v[112:127]
s_add_u32 m0, s41, 18432
s_add_u32 s42, s49, s63
buffer_load_dwordx4 v4, s[12:15], s42 offen lds
v_add_f32 v174, v174, v190
v_add_f32 v175, v175, v191
s_waitcnt lgkmcnt(2)
v_mfma_f32_32x32x16_bf16 v[128:143], v[76:79], a[88:91], v[128:143]
ds_read_b64_tr_b16 v[84:85], v9 offset:2048
ds_read_b64_tr_b16 v[86:87], v9 offset:2560
v_add_f32 v160, v160, v192
v_add_f32 v161, v161, v193
v_mfma_f32_32x32x16_bf16 v[144:159], v[76:79], a[92:95], v[144:159]
buffer_load_dwordx4 v5, s[12:15], s42 offen offset:1024 lds
v_add_f32 v162, v162, v194
v_add_f32 v163, v163, v195
v_add_f32 v164, v164, v196
s_waitcnt lgkmcnt(2)
v_mfma_f32_32x32x16_bf16 v[96:111], v[80:83], a[96:99], v[96:111]
s_waitcnt vmcnt(14)
ds_read_b64_tr_b16 v[72:73], v8 offset:4096
ds_read_b64_tr_b16 v[74:75], v8 offset:4608
v_add_f32 v165, v165, v197
v_add_f32 v166, v166, v198
v_add_f32 v167, v167, v199
v_mfma_f32_32x32x16_bf16 v[112:127], v[80:83], a[100:103], v[112:127]
s_add_u32 m0, s41, 0
s_add_u32 s42, s42, 147456
buffer_load_dwordx4 v4, s[12:15], s42 offen lds
v_add_f32 v168, v168, v200
v_add_f32 v169, v169, v201
v_add_f32 v170, v170, v202
s_waitcnt lgkmcnt(2)
v_mfma_f32_32x32x16_bf16 v[128:143], v[84:87], a[96:99], v[128:143]
ds_read_b64_tr_b16 v[76:77], v9 offset:4096
ds_read_b64_tr_b16 v[78:79], v9 offset:4608
v_add_f32 v171, v171, v203
v_add_f32 v172, v172, v204
v_add_f32 v173, v173, v205
v_mfma_f32_32x32x16_bf16 v[144:159], v[84:87], a[100:103], v[144:159]
buffer_load_dwordx4 v5, s[12:15], s42 offen offset:1024 lds
v_add_f32 v174, v174, v206
v_add_f32 v175, v175, v207
s_waitcnt lgkmcnt(2)
v_mfma_f32_32x32x16_bf16 v[96:111], v[72:75], a[104:107], v[96:111]
s_waitcnt vmcnt(14)
ds_read_b64_tr_b16 v[80:81], v8 offset:6144
ds_read_b64_tr_b16 v[82:83], v8 offset:6656
v_add_f32 v160, v160, v208
v_add_f32 v161, v161, v209
v_mfma_f32_32x32x16_bf16 v[112:127], v[72:75], a[108:111], v[112:127]
s_add_u32 m0, s41, 2048
s_add_u32 s42, s42, 147456
buffer_load_dwordx4 v4, s[12:15], s42 offen lds
v_add_f32 v162, v162, v210
v_add_f32 v163, v163, v211
v_add_f32 v164, v164, v212
s_waitcnt lgkmcnt(2)
v_mfma_f32_32x32x16_bf16 v[128:143], v[76:79], a[104:107], v[128:143]
ds_read_b64_tr_b16 v[84:85], v9 offset:6144
ds_read_b64_tr_b16 v[86:87], v9 offset:6656
v_add_f32 v165, v165, v213
v_add_f32 v166, v166, v214
v_add_f32 v167, v167, v215
v_mfma_f32_32x32x16_bf16 v[144:159], v[76:79], a[108:111], v[144:159]
buffer_load_dwordx4 v5, s[12:15], s42 offen offset:1024 lds
v_add_f32 v168, v168, v216
v_add_f32 v169, v169, v217
v_add_f32 v170, v170, v218
s_waitcnt lgkmcnt(2)
v_mfma_f32_32x32x16_bf16 v[96:111], v[80:83], a[112:115], v[96:111]
s_waitcnt vmcnt(14)
ds_read_b64_tr_b16 v[72:73], v8 offset:8192
ds_read_b64_tr_b16 v[74:75], v8 offset:8704
v_add_f32 v171, v171, v219
v_add_f32 v172, v172, v220
v_add_f32 v173, v173, v221
v_and_b32 v67, 31, v1
v_mfma_f32_32x32x16_bf16 v[112:127], v[80:83], a[116:119], v[112:127]
s_add_u32 m0, s41, 4096
s_add_u32 s42, s42, 147456
buffer_load_dwordx4 v4, s[12:15], s42 offen lds
v_add_f32 v174, v174, v222
v_add_f32 v175, v175, v223
v_lshlrev_b32 v67, 2, v67
s_waitcnt lgkmcnt(2)
v_mfma_f32_32x32x16_bf16 v[128:143], v[84:87], a[112:115], v[128:143]
ds_read_b64_tr_b16 v[76:77], v9 offset:8192
ds_read_b64_tr_b16 v[78:79], v9 offset:8704
v_add_u32 v62, 4096, v19
s_mul_i32 s22, s75, 4352
v_mul_f32 v40, 0xbfb8aa3b, v160
v_mul_f32 v41, 0xbfb8aa3b, v161
v_mul_f32 v42, 0xbfb8aa3b, v162
v_mfma_f32_32x32x16_bf16 v[144:159], v[84:87], a[116:119], v[144:159]
buffer_load_dwordx4 v5, s[12:15], s42 offen offset:1024 lds
ds_write_b128 v62, v[32:35] offset:0
ds_write_b128 v62, v[36:39] offset:1024
s_add_u32 s22, s22, 25165824
v_mul_f32 v43, 0xbfb8aa3b, v163
v_exp_f32 v40, v40
s_waitcnt lgkmcnt(4)
v_mfma_f32_32x32x16_bf16 v[96:111], v[72:75], a[120:123], v[96:111]
s_waitcnt vmcnt(14)
ds_read_b64_tr_b16 v[80:81], v8 offset:10240
ds_read_b64_tr_b16 v[82:83], v8 offset:10752
ds_write_b128 v62, v[88:91] offset:2048
s_cmp_eq_u32 s30, 1
s_cbranch_scc0 Lsk_pr_13
buffer_load_dword v69, v67, s[4:7], s22 offen sc1
Lsk_pr_13:
v_exp_f32 v41, v41
v_exp_f32 v42, v42
v_mfma_f32_32x32x16_bf16 v[112:127], v[72:75], a[124:127], v[112:127]
s_add_u32 m0, s41, 6144
s_add_u32 s42, s50, s63
buffer_load_dwordx4 v4, s[12:15], s42 offen lds
ds_write_b128 v62, v[92:95] offset:3072
v_lshlrev_b32 v63, 3, v1
v_exp_f32 v43, v43
v_fma_f32 v40, v40, v2, v2
s_waitcnt lgkmcnt(6)
v_mfma_f32_32x32x16_bf16 v[128:143], v[76:79], a[120:123], v[128:143]
ds_read_b64_tr_b16 v[84:85], v9 offset:10240
ds_read_b64_tr_b16 v[86:87], v9 offset:10752
v_add_u32 v63, s96, v63
v_fma_f32 v41, v41, v2, v2
v_fma_f32 v42, v42, v2, v2
v_mfma_f32_32x32x16_bf16 v[144:159], v[76:79], a[124:127], v[144:159]
buffer_load_dwordx4 v5, s[12:15], s42 offen offset:1024 lds
ds_read_b64_tr_b16 v[32:33], v63 offset:4096
ds_read_b64_tr_b16 v[34:35], v63 offset:4608
v_fma_f32 v43, v43, v2, v2
v_rcp_f32 v40, v40
s_waitcnt lgkmcnt(6)
v_mfma_f32_32x32x16_bf16 v[96:111], v[80:83], a[128:131], v[96:111]
s_waitcnt vmcnt(14)
ds_read_b64_tr_b16 v[72:73], v8 offset:12288
ds_read_b64_tr_b16 v[74:75], v8 offset:12800
ds_read_b64_tr_b16 v[36:37], v63 offset:5120
ds_read_b64_tr_b16 v[38:39], v63 offset:5632
v_rcp_f32 v41, v41
v_rcp_f32 v42, v42
v_mfma_f32_32x32x16_bf16 v[112:127], v[80:83], a[132:135], v[112:127]
s_add_u32 m0, s41, 8192
s_add_u32 s42, s42, 147456
buffer_load_dwordx4 v4, s[12:15], s42 offen lds
ds_read_b64_tr_b16 v[88:89], v63 offset:6144
v_rcp_f32 v43, v43
v_mul_f32 v160, v160, v40
v_mul_f32 v161, v161, v41
s_waitcnt lgkmcnt(7)
v_mfma_f32_32x32x16_bf16 v[128:143], v[84:87], a[128:131], v[128:143]
ds_read_b64_tr_b16 v[76:77], v9 offset:12288
ds_read_b64_tr_b16 v[78:79], v9 offset:12800
ds_read_b64_tr_b16 v[90:91], v63 offset:6656
ds_read_b64_tr_b16 v[92:93], v63 offset:7168
v_mul_f32 v162, v162, v42
v_mul_f32 v163, v163, v43
v_mfma_f32_32x32x16_bf16 v[144:159], v[84:87], a[132:135], v[144:159]
buffer_load_dwordx4 v5, s[12:15], s42 offen offset:1024 lds
ds_read_b64_tr_b16 v[94:95], v63 offset:7680
v_cvt_pk_bf16_f32 v48, v160, v161
v_cvt_pk_bf16_f32 v49, v162, v163
s_waitcnt lgkmcnt(8)
v_mfma_f32_32x32x16_bf16 v[96:111], v[72:75], a[136:139], v[96:111]
s_waitcnt vmcnt(14)
ds_read_b64_tr_b16 v[80:81], v8 offset:14336
ds_read_b64_tr_b16 v[82:83], v8 offset:14848
v_mul_f32 v44, 0xbfb8aa3b, v164
v_mul_f32 v45, 0xbfb8aa3b, v165
v_mfma_f32_32x32x16_bf16 v[112:127], v[72:75], a[140:143], v[112:127]
s_add_u32 m0, s41, 10240
s_add_u32 s42, s42, 147456
buffer_load_dwordx4 v4, s[12:15], s42 offen lds
v_mul_f32 v46, 0xbfb8aa3b, v166
v_mul_f32 v47, 0xbfb8aa3b, v167
s_waitcnt lgkmcnt(5)
v_mfma_f32_32x32x16_bf16 v[128:143], v[76:79], a[136:139], v[128:143]
ds_read_b64_tr_b16 v[84:85], v9 offset:14336
ds_read_b64_tr_b16 v[86:87], v9 offset:14848
v_exp_f32 v44, v44
v_exp_f32 v45, v45
v_mfma_f32_32x32x16_bf16 v[144:159], v[76:79], a[140:143], v[144:159]
buffer_load_dwordx4 v5, s[12:15], s42 offen offset:1024 lds
v_exp_f32 v46, v46
v_exp_f32 v47, v47
s_waitcnt lgkmcnt(2)
v_mfma_f32_32x32x16_bf16 v[96:111], v[80:83], a[144:147], v[96:111]
s_waitcnt vmcnt(14)
ds_read_b64_tr_b16 v[72:73], v8 offset:16384
ds_read_b64_tr_b16 v[74:75], v8 offset:16896
v_fma_f32 v44, v44, v2, v2
v_fma_f32 v45, v45, v2, v2
v_fma_f32 v46, v46, v2, v2
v_mfma_f32_32x32x16_bf16 v[112:127], v[80:83], a[148:151], v[112:127]
s_add_u32 m0, s41, 12288
s_add_u32 s42, s42, 147456
buffer_load_dwordx4 v4, s[12:15], s42 offen lds
v_fma_f32 v47, v47, v2, v2
v_rcp_f32 v44, v44
s_waitcnt lgkmcnt(2)
v_mfma_f32_32x32x16_bf16 v[128:143], v[84:87], a[144:147], v[128:143]
ds_read_b64_tr_b16 v[76:77], v9 offset:16384
ds_read_b64_tr_b16 v[78:79], v9 offset:16896
v_rcp_f32 v45, v45
v_rcp_f32 v46, v46
v_mfma_f32_32x32x16_bf16 v[144:159], v[84:87], a[148:151], v[144:159]
buffer_load_dwordx4 v5, s[12:15], s42 offen offset:1024 lds
v_rcp_f32 v47, v47
v_mul_f32 v164, v164, v44
s_cmp_eq_u32 s30, 1
s_cbranch_scc0 Lsk_cr_14
s_waitcnt vmcnt(8)
v_cmp_eq_u32 vcc, 0, v69
s_or_b64 vcc, vcc, vcc
s_cbranch_scc1 Lsp_R
Lbk_R:
s_mov_b32 m0, s96
s_nop 0
buffer_load_dwordx4 v12, s[4:7], s31 offen offset:0 sc1 lds
buffer_load_dwordx4 v12, s[4:7], s31 offen offset:1024 sc1 lds
buffer_load_dwordx4 v12, s[4:7], s31 offen offset:2048 sc1 lds
buffer_load_dwordx4 v12, s[4:7], s31 offen offset:3072 sc1 lds
Lsk_cr_14:
s_waitcnt lgkmcnt(2)
v_mfma_f32_32x32x16_bf16 v[96:111], v[72:75], a[152:155], v[96:111]
s_waitcnt vmcnt(14)
ds_read_b64_tr_b16 v[80:81], v8 offset:18432
ds_read_b64_tr_b16 v[82:83], v8 offset:18944
v_mul_f32 v165, v165, v45
v_mul_f32 v166, v166, v46
v_mfma_f32_32x32x16_bf16 v[112:127], v[72:75], a[156:159], v[112:127]
s_add_u32 m0, s41, 14336
s_add_u32 s42, s51, s63
buffer_load_dwordx4 v4, s[12:15], s42 offen lds
v_mul_f32 v167, v167, v47
v_cvt_pk_bf16_f32 v50, v164, v165
s_waitcnt lgkmcnt(2)
v_mfma_f32_32x32x16_bf16 v[128:143], v[76:79], a[152:155], v[128:143]
ds_read_b64_tr_b16 v[84:85], v9 offset:18432
ds_read_b64_tr_b16 v[86:87], v9 offset:18944
v_cvt_pk_bf16_f32 v51, v166, v167
v_mul_f32 v40, 0xbfb8aa3b, v168
v_mfma_f32_32x32x16_bf16 v[144:159], v[76:79], a[156:159], v[144:159]
buffer_load_dwordx4 v5, s[12:15], s42 offen offset:1024 lds
v_mul_f32 v41, 0xbfb8aa3b, v169
v_mul_f32 v42, 0xbfb8aa3b, v170
v_mul_f32 v43, 0xbfb8aa3b, v171
s_waitcnt lgkmcnt(2)
v_mfma_f32_32x32x16_bf16 v[96:111], v[80:83], a[160:163], v[96:111]
s_waitcnt vmcnt(14)
ds_read_b64_tr_b16 v[72:73], v8 offset:0
ds_read_b64_tr_b16 v[74:75], v8 offset:512
v_exp_f32 v40, v40
v_exp_f32 v41, v41
v_mfma_f32_32x32x16_bf16 v[112:127], v[80:83], a[164:167], v[112:127]
s_add_u32 m0, s41, 16384
s_add_u32 s42, s42, 147456
buffer_load_dwordx4 v4, s[12:15], s42 offen lds
v_exp_f32 v42, v42
v_exp_f32 v43, v43
s_waitcnt lgkmcnt(2)
v_mfma_f32_32x32x16_bf16 v[128:143], v[84:87], a[160:163], v[128:143]
ds_read_b64_tr_b16 v[76:77], v9 offset:0
ds_read_b64_tr_b16 v[78:79], v9 offset:512
v_fma_f32 v40, v40, v2, v2
v_fma_f32 v41, v41, v2, v2
v_mfma_f32_32x32x16_bf16 v[144:159], v[84:87], a[164:167], v[144:159]
buffer_load_dwordx4 v5, s[12:15], s42 offen offset:1024 lds
v_fma_f32 v42, v42, v2, v2
v_fma_f32 v43, v43, v2, v2
s_waitcnt lgkmcnt(2)
v_mfma_f32_32x32x16_bf16 v[96:111], v[72:75], a[168:171], v[96:111]
s_waitcnt vmcnt(14)
ds_read_b64_tr_b16 v[80:81], v8 offset:2048
ds_read_b64_tr_b16 v[82:83], v8 offset:2560
v_rcp_f32 v40, v40
v_rcp_f32 v41, v41
v_mfma_f32_32x32x16_bf16 v[112:127], v[72:75], a[172:175], v[112:127]
s_add_u32 m0, s41, 18432
s_add_u32 s42, s42, 147456
buffer_load_dwordx4 v4, s[12:15], s42 offen lds
v_rcp_f32 v42, v42
v_rcp_f32 v43, v43
s_waitcnt lgkmcnt(2)
v_mfma_f32_32x32x16_bf16 v[128:143], v[76:79], a[168:171], v[128:143]
ds_read_b64_tr_b16 v[84:85], v9 offset:2048
ds_read_b64_tr_b16 v[86:87], v9 offset:2560
v_mul_f32 v168, v168, v40
v_mul_f32 v169, v169, v41
v_mul_f32 v170, v170, v42
v_mfma_f32_32x32x16_bf16 v[144:159], v[76:79], a[172:175], v[144:159]
buffer_load_dwordx4 v5, s[12:15], s42 offen offset:1024 lds
v_mul_f32 v171, v171, v43
v_cvt_pk_bf16_f32 v52, v168, v169
s_waitcnt lgkmcnt(2)
v_mfma_f32_32x32x16_bf16 v[96:111], v[80:83], a[176:179], v[96:111]
s_waitcnt vmcnt(14)
ds_read_b64_tr_b16 v[72:73], v8 offset:4096
ds_read_b64_tr_b16 v[74:75], v8 offset:4608
v_cvt_pk_bf16_f32 v53, v170, v171
v_mul_f32 v44, 0xbfb8aa3b, v172
v_mfma_f32_32x32x16_bf16 v[112:127], v[80:83], a[180:183], v[112:127]
s_add_u32 m0, s41, 0
s_add_u32 s42, s42, 147456
buffer_load_dwordx4 v4, s[12:15], s42 offen lds
v_mul_f32 v45, 0xbfb8aa3b, v173
v_mul_f32 v46, 0xbfb8aa3b, v174
s_waitcnt lgkmcnt(2)
v_mfma_f32_32x32x16_bf16 v[128:143], v[84:87], a[176:179], v[128:143]
ds_read_b64_tr_b16 v[76:77], v9 offset:4096
ds_read_b64_tr_b16 v[78:79], v9 offset:4608
v_mul_f32 v47, 0xbfb8aa3b, v175
v_exp_f32 v44, v44
v_mfma_f32_32x32x16_bf16 v[144:159], v[84:87], a[180:183], v[144:159]
buffer_load_dwordx4 v5, s[12:15], s42 offen offset:1024 lds
v_exp_f32 v45, v45
v_exp_f32 v46, v46
s_waitcnt lgkmcnt(2)
v_mfma_f32_32x32x16_bf16 v[96:111], v[72:75], a[184:187], v[96:111]
s_waitcnt vmcnt(14)
ds_read_b64_tr_b16 v[80:81], v8 offset:6144
ds_read_b64_tr_b16 v[82:83], v8 offset:6656
v_exp_f32 v47, v47
v_fma_f32 v44, v44, v2, v2
v_mfma_f32_32x32x16_bf16 v[112:127], v[72:75], a[188:191], v[112:127]
s_add_u32 m0, s41, 2048
s_add_u32 s42, s52, s63
buffer_load_dwordx4 v4, s[12:15], s42 offen lds
v_fma_f32 v45, v45, v2, v2
v_fma_f32 v46, v46, v2, v2
v_fma_f32 v47, v47, v2, v2
s_waitcnt lgkmcnt(2)
v_mfma_f32_32x32x16_bf16 v[128:143], v[76:79], a[184:187], v[128:143]
ds_read_b64_tr_b16 v[84:85], v9 offset:6144
ds_read_b64_tr_b16 v[86:87], v9 offset:6656
v_rcp_f32 v44, v44
v_rcp_f32 v45, v45
v_mfma_f32_32x32x16_bf16 v[144:159], v[76:79], a[188:191], v[144:159]
buffer_load_dwordx4 v5, s[12:15], s42 offen offset:1024 lds
v_rcp_f32 v46, v46
v_rcp_f32 v47, v47
s_waitcnt lgkmcnt(2)
v_mfma_f32_32x32x16_bf16 v[96:111], v[80:83], a[192:195], v[96:111]
s_waitcnt vmcnt(14)
ds_read_b64_tr_b16 v[72:73], v8 offset:8192
ds_read_b64_tr_b16 v[74:75], v8 offset:8704
v_mul_f32 v172, v172, v44
v_mul_f32 v173, v173, v45
v_mfma_f32_32x32x16_bf16 v[112:127], v[80:83], a[196:199], v[112:127]
s_add_u32 m0, s41, 4096
s_add_u32 s42, s42, 147456
buffer_load_dwordx4 v4, s[12:15], s42 offen lds
v_mul_f32 v174, v174, v46
v_mul_f32 v175, v175, v47
s_waitcnt lgkmcnt(2)
v_mfma_f32_32x32x16_bf16 v[128:143], v[84:87], a[192:195], v[128:143]
ds_read_b64_tr_b16 v[76:77], v9 offset:8192
ds_read_b64_tr_b16 v[78:79], v9 offset:8704
v_cvt_pk_bf16_f32 v54, v172, v173
v_cvt_pk_bf16_f32 v55, v174, v175
v_mfma_f32_32x32x16_bf16 v[144:159], v[84:87], a[196:199], v[144:159]
buffer_load_dwordx4 v5, s[12:15], s42 offen offset:1024 lds
ds_write_b128 v15, v[48:51]
ds_write_b128 v15, v[52:55] offset:2048
s_waitcnt lgkmcnt(4)
v_mfma_f32_32x32x16_bf16 v[96:111], v[72:75], a[200:203], v[96:111]
s_waitcnt vmcnt(14)
ds_read_b64_tr_b16 v[80:81], v8 offset:10240
ds_read_b64_tr_b16 v[82:83], v8 offset:10752
ds_read_b128 v[160:163], v28 offset:0
ds_read_b128 v[164:167], v28 offset:1024
ds_read_b128 v[168:171], v28 offset:2048
ds_read_b128 v[172:175], v28 offset:3072
ds_read_b128 v[176:179], v28 offset:4096
v_mfma_f32_32x32x16_bf16 v[112:127], v[72:75], a[204:207], v[112:127]
s_add_u32 m0, s41, 6144
s_add_u32 s42, s42, 147456
buffer_load_dwordx4 v4, s[12:15], s42 offen lds
ds_read_b128 v[180:183], v28 offset:5120
s_waitcnt vmcnt(13)
ds_read_b64_tr_b16 v[184:185], v26 offset:0
ds_read_b64_tr_b16 v[186:187], v26 offset:2048
ds_read_b64_tr_b16 v[188:189], v26 offset:32
s_waitcnt lgkmcnt(13)
v_mfma_f32_32x32x16_bf16 v[128:143], v[76:79], a[200:203], v[128:143]
ds_read_b64_tr_b16 v[84:85], v9 offset:10240
ds_read_b64_tr_b16 v[86:87], v9 offset:10752
ds_read_b64_tr_b16 v[190:191], v26 offset:2080
ds_read_b64_tr_b16 v[192:193], v26 offset:64
ds_read_b64_tr_b16 v[194:195], v26 offset:2112
ds_read_b64_tr_b16 v[196:197], v26 offset:96
ds_read_b64_tr_b16 v[198:199], v26 offset:2144
v_mfma_f32_32x32x16_bf16 v[144:159], v[76:79], a[204:207], v[144:159]
buffer_load_dwordx4 v5, s[12:15], s42 offen offset:1024 lds
s_waitcnt lgkmcnt(0)
v_mfma_f32_16x16x32_bf16 v[200:203], v[160:163], v[184:187], 0
v_mfma_f32_16x16x32_bf16 v[208:211], v[160:163], v[196:199], 0
v_mfma_f32_16x16x32_bf16 v[216:219], v[160:163], v[188:191], 0
v_mfma_f32_16x16x32_bf16 v[40:43], v[160:163], v[192:195], 0
v_mfma_f32_32x32x16_bf16 v[96:111], v[80:83], a[208:211], v[96:111]
ds_read_b64_tr_b16 v[72:73], v8 offset:12288
ds_read_b64_tr_b16 v[74:75], v8 offset:12800
v_mfma_f32_16x16x32_bf16 v[200:203], v[176:179], v[192:195], v[200:203]
v_mfma_f32_16x16x32_bf16 v[208:211], v[168:171], v[188:191], v[208:211]
v_mfma_f32_16x16x32_bf16 v[216:219], v[176:179], v[196:199], v[216:219]
v_mfma_f32_16x16x32_bf16 v[40:43], v[168:171], v[184:187], v[40:43]
v_mfma_f32_16x16x32_bf16 v[204:207], v[164:167], v[184:187], 0
v_mfma_f32_32x32x16_bf16 v[112:127], v[80:83], a[212:215], v[112:127]
s_add_u32 m0, s41, 8192
s_add_u32 s42, s42, 147456
buffer_load_dwordx4 v4, s[12:15], s42 offen lds
v_mfma_f32_16x16x32_bf16 v[212:215], v[164:167], v[196:199], 0
v_mfma_f32_16x16x32_bf16 v[220:223], v[164:167], v[188:191], 0
v_mfma_f32_16x16x32_bf16 v[44:47], v[164:167], v[192:195], 0
v_mfma_f32_16x16x32_bf16 v[204:207], v[180:183], v[192:195], v[204:207]
v_mfma_f32_16x16x32_bf16 v[212:215], v[172:175], v[188:191], v[212:215]
v_mfma_f32_32x32x16_bf16 v[128:143], v[84:87], a[208:211], v[128:143]
ds_read_b64_tr_b16 v[76:77], v9 offset:12288
ds_read_b64_tr_b16 v[78:79], v9 offset:12800
v_mfma_f32_16x16x32_bf16 v[220:223], v[180:183], v[196:199], v[220:223]
v_mfma_f32_16x16x32_bf16 v[44:47], v[172:175], v[184:187], v[44:47]
v_sub_f32 v48, v200, v208
v_add_f32 v200, v200, v208
v_sub_f32 v56, v216, v40
v_mfma_f32_32x32x16_bf16 v[144:159], v[84:87], a[212:215], v[144:159]
buffer_load_dwordx4 v5, s[12:15], s42 offen offset:1024 lds
v_add_f32 v216, v216, v40
v_sub_f32 v49, v201, v209
v_add_f32 v201, v201, v209
v_sub_f32 v57, v217, v41
v_add_f32 v217, v217, v41
s_waitcnt lgkmcnt(2)
v_mfma_f32_32x32x16_bf16 v[96:111], v[72:75], a[216:219], v[96:111]
s_waitcnt vmcnt(14)
ds_read_b64_tr_b16 v[80:81], v8 offset:14336
ds_read_b64_tr_b16 v[82:83], v8 offset:14848
v_sub_f32 v50, v202, v210
v_add_f32 v202, v202, v210
v_sub_f32 v58, v218, v42
v_add_f32 v218, v218, v42
v_sub_f32 v51, v203, v211
v_mfma_f32_32x32x16_bf16 v[112:127], v[72:75], a[220:223], v[112:127]
s_add_u32 m0, s41, 10240
s_add_u32 s42, s44, s64
buffer_load_dwordx4 v4, s[12:15], s42 offen lds
v_add_f32 v203, v203, v211
v_sub_f32 v59, v219, v43
v_add_f32 v219, v219, v43
v_sub_f32 v52, v204, v212
v_add_f32 v204, v204, v212
s_waitcnt lgkmcnt(2)
v_mfma_f32_32x32x16_bf16 v[128:143], v[76:79], a[216:219], v[128:143]
ds_read_b64_tr_b16 v[84:85], v9 offset:14336
ds_read_b64_tr_b16 v[86:87], v9 offset:14848
v_sub_f32 v60, v220, v44
v_add_f32 v220, v220, v44
v_sub_f32 v53, v205, v213
v_add_f32 v205, v205, v213
v_sub_f32 v61, v221, v45
v_mfma_f32_32x32x16_bf16 v[144:159], v[76:79], a[220:223], v[144:159]
buffer_load_dwordx4 v5, s[12:15], s42 offen offset:1024 lds
v_add_f32 v221, v221, v45
v_sub_f32 v54, v206, v214
v_add_f32 v206, v206, v214
v_sub_f32 v62, v222, v46
v_add_f32 v222, v222, v46
s_waitcnt lgkmcnt(2)
v_mfma_f32_32x32x16_bf16 v[96:111], v[80:83], a[224:227], v[96:111]
s_waitcnt vmcnt(14)
ds_read_b64_tr_b16 v[72:73], v8 offset:16384
ds_read_b64_tr_b16 v[74:75], v8 offset:16896
v_sub_f32 v55, v207, v215
v_add_f32 v207, v207, v215
v_sub_f32 v63, v223, v47
v_add_f32 v223, v223, v47
s_sub_u32 s3, s30, 1
s_or_b32 s3, s3, s75
s_cbranch_scc1 Lsk_sp1_15
v_lshrrev_b32 v64, 4, v1
v_lshlrev_b32 v64, 4, v64
v_add_u32 v64, s96, v64
v_and_b32 v65, 31, v1
v_lshlrev_b32 v65, 2, v65
v_add_u32 v65, s96, v65
s_mov_b32 exec_lo, 0x10001
s_mov_b32 exec_hi, 0x10001
ds_write_b128 v64, v[200:203] offset:0
ds_write_b128 v64, v[204:207] offset:64
ds_write_b128 v64, v[56:59] offset:128
ds_write_b128 v64, v[60:63] offset:192
ds_write_b128 v64, v[48:51] offset:256
ds_write_b128 v64, v[52:55] offset:320
ds_write_b128 v64, v[216:219] offset:384
ds_write_b128 v64, v[220:223] offset:448
s_mov_b64 exec, -1
s_waitcnt lgkmcnt(0)
ds_read_b32 v184, v65 offset:0
ds_read_b32 v185, v65 offset:128
ds_read_b32 v186, v65 offset:256
ds_read_b32 v187, v65 offset:384
ds_read_b128 v[188:191], v28 offset:6144
s_waitcnt lgkmcnt(0)
v_mul_f32 v192, v184, v188
v_fma_f32 v192, -v185, v189, v192
v_fma_f32 v192, v186, v190, v192
v_fma_f32 v192, v187, v191, v192
v_mul_f32 v193, v184, v189
v_fma_f32 v193, v185, v188, v193
v_fma_f32 v193, v186, v191, v193
v_fma_f32 v193, -v187, v190, v193
v_mul_f32 v194, v186, v188
v_fma_f32 v194, v187, v189, v194
v_fma_f32 v194, v184, v190, v194
v_fma_f32 v194, -v185, v191, v194
v_mul_f32 v195, v187, v188
v_fma_f32 v195, -v186, v189, v195
v_fma_f32 v195, -v184, v191, v195
v_fma_f32 v195, -v185, v190, v195
ds_write_b32 v65, v192 offset:0
ds_write_b32 v65, v193 offset:128
ds_write_b32 v65, v194 offset:256
ds_write_b32 v65, v195 offset:384
s_waitcnt lgkmcnt(0)
Lsk_sp1_15:
v_mfma_f32_32x32x16_bf16 v[112:127], v[80:83], a[228:231], v[112:127]
s_add_u32 m0, s41, 12288
s_add_u32 s42, s42, 147456
buffer_load_dwordx4 v4, s[12:15], s42 offen lds
v_lshlrev_b32 v64, 16, v32
v_lshlrev_b32 v65, 16, v36
v_lshlrev_b32 v184, 16, v88
v_lshlrev_b32 v185, 16, v92
v_mul_f32 v66, v200, v65
s_waitcnt lgkmcnt(2)
v_mfma_f32_32x32x16_bf16 v[128:143], v[84:87], a[224:227], v[128:143]
ds_read_b64_tr_b16 v[76:77], v9 offset:16384
ds_read_b64_tr_b16 v[78:79], v9 offset:16896
v_mul_f32 v200, v200, v64
v_fma_f32 v200, -v56, v65, v200
v_fma_f32 v56, v56, v64, v66
v_mul_f32 v186, v48, v185
v_mul_f32 v48, v48, v184
v_mfma_f32_32x32x16_bf16 v[144:159], v[84:87], a[228:231], v[144:159]
buffer_load_dwordx4 v5, s[12:15], s42 offen offset:1024 lds
v_fma_f32 v48, -v216, v185, v48
v_fma_f32 v216, v216, v184, v186
v_and_b32 v68, 0xffff0000, v32
v_and_b32 v69, 0xffff0000, v36
v_and_b32 v188, 0xffff0000, v88
s_waitcnt lgkmcnt(2)
v_mfma_f32_32x32x16_bf16 v[96:111], v[72:75], a[232:235], v[96:111]
s_waitcnt vmcnt(14)
ds_read_b64_tr_b16 v[80:81], v8 offset:18432
ds_read_b64_tr_b16 v[82:83], v8 offset:18944
v_and_b32 v189, 0xffff0000, v92
v_mul_f32 v70, v201, v69
v_mul_f32 v201, v201, v68
v_fma_f32 v201, -v57, v69, v201
v_fma_f32 v57, v57, v68, v70
v_mfma_f32_32x32x16_bf16 v[112:127], v[72:75], a[236:239], v[112:127]
s_add_u32 m0, s41, 14336
s_add_u32 s42, s42, 147456
buffer_load_dwordx4 v4, s[12:15], s42 offen lds
v_mul_f32 v190, v49, v189
v_mul_f32 v49, v49, v188
v_fma_f32 v49, -v217, v189, v49
v_fma_f32 v217, v217, v188, v190
v_lshlrev_b32 v64, 16, v33
s_waitcnt lgkmcnt(2)
v_mfma_f32_32x32x16_bf16 v[128:143], v[76:79], a[232:235], v[128:143]
ds_read_b64_tr_b16 v[84:85], v9 offset:18432
ds_read_b64_tr_b16 v[86:87], v9 offset:18944
v_lshlrev_b32 v65, 16, v37
v_lshlrev_b32 v184, 16, v89
v_lshlrev_b32 v185, 16, v93
v_mul_f32 v66, v202, v65
v_mul_f32 v202, v202, v64
v_mfma_f32_32x32x16_bf16 v[144:159], v[76:79], a[236:239], v[144:159]
buffer_load_dwordx4 v5, s[12:15], s42 offen offset:1024 lds
v_fma_f32 v202, -v58, v65, v202
v_fma_f32 v58, v58, v64, v66
v_mul_f32 v186, v50, v185
v_mul_f32 v50, v50, v184
v_fma_f32 v50, -v218, v185, v50
s_waitcnt lgkmcnt(2)
v_mfma_f32_32x32x16_bf16 v[96:111], v[80:83], a[240:243], v[96:111]
s_waitcnt vmcnt(14)
ds_read_b64_tr_b16 v[72:73], v8 offset:0
ds_read_b64_tr_b16 v[74:75], v8 offset:512
v_fma_f32 v218, v218, v184, v186
v_and_b32 v68, 0xffff0000, v33
v_and_b32 v69, 0xffff0000, v37
v_and_b32 v188, 0xffff0000, v89
v_and_b32 v189, 0xffff0000, v93
v_mfma_f32_32x32x16_bf16 v[112:127], v[80:83], a[244:247], v[112:127]
s_add_u32 m0, s41, 16384
s_add_u32 s42, s42, 147456
buffer_load_dwordx4 v4, s[12:15], s42 offen lds
v_mul_f32 v70, v203, v69
v_mul_f32 v203, v203, v68
v_fma_f32 v203, -v59, v69, v203
v_fma_f32 v59, v59, v68, v70
v_mul_f32 v190, v51, v189
s_waitcnt lgkmcnt(2)
v_mfma_f32_32x32x16_bf16 v[128:143], v[84:87], a[240:243], v[128:143]
ds_read_b64_tr_b16 v[76:77], v9 offset:0
ds_read_b64_tr_b16 v[78:79], v9 offset:512
v_mul_f32 v51, v51, v188
v_fma_f32 v51, -v219, v189, v51
v_fma_f32 v219, v219, v188, v190
v_lshlrev_b32 v64, 16, v34
v_lshlrev_b32 v65, 16, v38
v_mfma_f32_32x32x16_bf16 v[144:159], v[84:87], a[244:247], v[144:159]
buffer_load_dwordx4 v5, s[12:15], s42 offen offset:1024 lds
v_lshlrev_b32 v184, 16, v90
v_lshlrev_b32 v185, 16, v94
v_mul_f32 v66, v204, v65
v_mul_f32 v204, v204, v64
v_fma_f32 v204, -v60, v65, v204
s_waitcnt lgkmcnt(2)
v_mfma_f32_32x32x16_bf16 v[96:111], v[72:75], a[248:251], v[96:111]
s_waitcnt vmcnt(14)
ds_read_b64_tr_b16 v[80:81], v8 offset:2048
ds_read_b64_tr_b16 v[82:83], v8 offset:2560
v_fma_f32 v60, v60, v64, v66
v_mul_f32 v186, v52, v185
v_mul_f32 v52, v52, v184
v_fma_f32 v52, -v220, v185, v52
v_fma_f32 v220, v220, v184, v186
v_mfma_f32_32x32x16_bf16 v[112:127], v[72:75], a[252:255], v[112:127]
s_add_u32 m0, s41, 18432
s_add_u32 s42, s45, s64
buffer_load_dwordx4 v4, s[12:15], s42 offen lds
v_and_b32 v68, 0xffff0000, v34
v_and_b32 v69, 0xffff0000, v38
v_and_b32 v188, 0xffff0000, v90
v_and_b32 v189, 0xffff0000, v94
v_mul_f32 v70, v205, v69
s_waitcnt lgkmcnt(2)
v_mfma_f32_32x32x16_bf16 v[128:143], v[76:79], a[248:251], v[128:143]
ds_read_b64_tr_b16 v[84:85], v9 offset:2048
ds_read_b64_tr_b16 v[86:87], v9 offset:2560
v_mul_f32 v205, v205, v68
v_fma_f32 v205, -v61, v69, v205
v_fma_f32 v61, v61, v68, v70
v_mul_f32 v190, v53, v189
v_mul_f32 v53, v53, v188
v_mfma_f32_32x32x16_bf16 v[144:159], v[76:79], a[252:255], v[144:159]
buffer_load_dwordx4 v5, s[12:15], s42 offen offset:1024 lds
v_fma_f32 v53, -v221, v189, v53
v_fma_f32 v221, v221, v188, v190
v_lshlrev_b32 v64, 16, v35
v_lshlrev_b32 v65, 16, v39
v_lshlrev_b32 v184, 16, v91
s_waitcnt lgkmcnt(2)
v_mfma_f32_32x32x16_bf16 v[96:111], v[80:83], v[224:227], v[96:111]
s_waitcnt vmcnt(14)
ds_read_b64_tr_b16 v[72:73], v8 offset:4096
ds_read_b64_tr_b16 v[74:75], v8 offset:4608
v_lshlrev_b32 v185, 16, v95
v_mul_f32 v66, v206, v65
v_mul_f32 v206, v206, v64
v_fma_f32 v206, -v62, v65, v206
v_fma_f32 v62, v62, v64, v66
v_mfma_f32_32x32x16_bf16 v[112:127], v[80:83], v[228:231], v[112:127]
s_add_u32 m0, s41, 0
s_add_u32 s42, s42, 147456
buffer_load_dwordx4 v4, s[12:15], s42 offen lds
v_mul_f32 v186, v54, v185
v_mul_f32 v54, v54, v184
v_fma_f32 v54, -v222, v185, v54
v_fma_f32 v222, v222, v184, v186
v_and_b32 v68, 0xffff0000, v35
s_waitcnt lgkmcnt(2)
v_mfma_f32_32x32x16_bf16 v[128:143], v[84:87], v[224:227], v[128:143]
ds_read_b64_tr_b16 v[76:77], v9 offset:4096
ds_read_b64_tr_b16 v[78:79], v9 offset:4608
v_and_b32 v69, 0xffff0000, v39
v_and_b32 v188, 0xffff0000, v91
v_and_b32 v189, 0xffff0000, v95
v_mul_f32 v70, v207, v69
v_mul_f32 v207, v207, v68
v_mfma_f32_32x32x16_bf16 v[144:159], v[84:87], v[228:231], v[144:159]
buffer_load_dwordx4 v5, s[12:15], s42 offen offset:1024 lds
v_fma_f32 v207, -v63, v69, v207
v_fma_f32 v63, v63, v68, v70
v_mul_f32 v190, v55, v189
v_mul_f32 v55, v55, v188
v_fma_f32 v55, -v223, v189, v55
s_waitcnt lgkmcnt(2)
v_mfma_f32_32x32x16_bf16 v[96:111], v[72:75], v[232:235], v[96:111]
s_waitcnt vmcnt(14)
ds_read_b64_tr_b16 v[80:81], v8 offset:6144
ds_read_b64_tr_b16 v[82:83], v8 offset:6656
v_fma_f32 v223, v223, v188, v190
s_sub_u32 s3, s30, 1
s_or_b32 s3, s3, s75
s_cbranch_scc1 Lsk_sp2_16
v_lshrrev_b32 v64, 4, v1
v_lshlrev_b32 v64, 4, v64
v_add_u32 v64, s96, v64
s_mov_b32 exec_lo, 0x10001
s_mov_b32 exec_hi, 0x10001
ds_read_b128 v[200:203], v64 offset:0
ds_read_b128 v[204:207], v64 offset:64
ds_read_b128 v[56:59], v64 offset:128
ds_read_b128 v[60:63], v64 offset:192
ds_read_b128 v[48:51], v64 offset:256
ds_read_b128 v[52:55], v64 offset:320
ds_read_b128 v[216:219], v64 offset:384
ds_read_b128 v[220:223], v64 offset:448
s_waitcnt lgkmcnt(0)
s_mov_b64 exec, -1
Lsk_sp2_16:
v_sub_f32 v208, v200, v48
v_add_f32 v200, v200, v48
v_sub_f32 v40, v56, v216
v_mfma_f32_32x32x16_bf16 v[112:127], v[72:75], v[236:239], v[112:127]
s_add_u32 m0, s41, 2048
s_add_u32 s42, s42, 147456
buffer_load_dwordx4 v4, s[12:15], s42 offen lds
v_add_f32 v56, v56, v216
v_sub_f32 v209, v201, v49
v_add_f32 v201, v201, v49
v_sub_f32 v41, v57, v217
v_add_f32 v57, v57, v217
s_waitcnt lgkmcnt(2)
v_mfma_f32_32x32x16_bf16 v[128:143], v[76:79], v[232:235], v[128:143]
ds_read_b64_tr_b16 v[84:85], v9 offset:6144
ds_read_b64_tr_b16 v[86:87], v9 offset:6656
v_cvt_pk_bf16_f32 v32, v200, v201
v_cvt_pk_bf16_f32 v36, v40, v41
v_cvt_pk_bf16_f32 v88, v56, v57
v_cvt_pk_bf16_f32 v92, v208, v209
v_sub_f32 v210, v202, v50
v_mfma_f32_32x32x16_bf16 v[144:159], v[76:79], v[236:239], v[144:159]
buffer_load_dwordx4 v5, s[12:15], s42 offen offset:1024 lds
v_add_f32 v202, v202, v50
v_sub_f32 v42, v58, v218
v_add_f32 v58, v58, v218
v_sub_f32 v211, v203, v51
v_add_f32 v203, v203, v51
s_waitcnt lgkmcnt(2)
v_mfma_f32_32x32x16_bf16 v[96:111], v[80:83], v[240:243], v[96:111]
s_waitcnt vmcnt(14)
ds_read_b64_tr_b16 v[72:73], v8 offset:8192
ds_read_b64_tr_b16 v[74:75], v8 offset:8704
v_sub_f32 v43, v59, v219
v_add_f32 v59, v59, v219
v_cvt_pk_bf16_f32 v33, v202, v203
v_cvt_pk_bf16_f32 v37, v42, v43
v_cvt_pk_bf16_f32 v89, v58, v59
v_mfma_f32_32x32x16_bf16 v[112:127], v[80:83], v[244:247], v[112:127]
s_add_u32 m0, s41, 4096
s_add_u32 s42, s42, 147456
buffer_load_dwordx4 v4, s[12:15], s42 offen lds
v_cvt_pk_bf16_f32 v93, v210, v211
v_sub_f32 v212, v204, v52
v_add_f32 v204, v204, v52
v_sub_f32 v44, v60, v220
v_add_f32 v60, v60, v220
s_waitcnt lgkmcnt(2)
v_mfma_f32_32x32x16_bf16 v[128:143], v[84:87], v[240:243], v[128:143]
ds_read_b64_tr_b16 v[76:77], v9 offset:8192
ds_read_b64_tr_b16 v[78:79], v9 offset:8704
v_sub_f32 v213, v205, v53
v_add_f32 v205, v205, v53
v_sub_f32 v45, v61, v221
v_add_f32 v61, v61, v221
v_cvt_pk_bf16_f32 v34, v204, v205
v_mfma_f32_32x32x16_bf16 v[144:159], v[84:87], v[244:247], v[144:159]
buffer_load_dwordx4 v5, s[12:15], s42 offen offset:1024 lds
v_cvt_pk_bf16_f32 v38, v44, v45
v_cvt_pk_bf16_f32 v90, v60, v61
v_cvt_pk_bf16_f32 v94, v212, v213
v_sub_f32 v214, v206, v54
v_add_f32 v206, v206, v54
s_waitcnt lgkmcnt(2)
v_mfma_f32_32x32x16_bf16 v[96:111], v[72:75], v[248:251], v[96:111]
s_waitcnt vmcnt(14)
ds_read_b64_tr_b16 v[80:81], v8 offset:10240
ds_read_b64_tr_b16 v[82:83], v8 offset:10752
v_sub_f32 v46, v62, v222
v_add_f32 v62, v62, v222
v_sub_f32 v215, v207, v55
v_add_f32 v207, v207, v55
v_sub_f32 v47, v63, v223
v_mfma_f32_32x32x16_bf16 v[112:127], v[72:75], v[252:255], v[112:127]
s_add_u32 m0, s41, 6144
s_add_u32 s42, s46, s64
buffer_load_dwordx4 v4, s[12:15], s42 offen lds
v_add_f32 v63, v63, v223
v_cvt_pk_bf16_f32 v35, v206, v207
v_cvt_pk_bf16_f32 v39, v46, v47
v_cvt_pk_bf16_f32 v91, v62, v63
v_cvt_pk_bf16_f32 v95, v214, v215
s_waitcnt lgkmcnt(2)
v_mfma_f32_32x32x16_bf16 v[128:143], v[76:79], v[248:251], v[128:143]
ds_read_b64_tr_b16 v[84:85], v9 offset:10240
ds_read_b64_tr_b16 v[86:87], v9 offset:10752
v_mfma_f32_32x32x16_bf16 v[144:159], v[76:79], v[252:255], v[144:159]
buffer_load_dwordx4 v5, s[12:15], s42 offen offset:1024 lds
s_barrier
s_waitcnt lgkmcnt(2)
v_mfma_f32_32x32x16_bf16 v[160:175], v[80:83], a[0:3], 0
s_waitcnt vmcnt(14)
ds_read_b64_tr_b16 v[72:73], v8 offset:12288
ds_read_b64_tr_b16 v[74:75], v8 offset:12800
v_mfma_f32_32x32x16_bf16 v[176:191], v[80:83], a[4:7], 0
s_add_u32 m0, s41, 8192
s_add_u32 s42, s42, 147456
buffer_load_dwordx4 v4, s[12:15], s42 offen lds
s_waitcnt lgkmcnt(2)
v_mfma_f32_32x32x16_bf16 v[192:207], v[84:87], a[0:3], 0
ds_read_b64_tr_b16 v[76:77], v9 offset:12288
ds_read_b64_tr_b16 v[78:79], v9 offset:12800
v_mfma_f32_32x32x16_bf16 v[208:223], v[84:87], a[4:7], 0
buffer_load_dwordx4 v5, s[12:15], s42 offen offset:1024 lds
v_mul_f32 v40, 0xbfb8aa3b, v96
v_mul_f32 v41, 0xbfb8aa3b, v97
v_mul_f32 v42, 0xbfb8aa3b, v98
s_waitcnt lgkmcnt(2)
v_mfma_f32_32x32x16_bf16 v[160:175], v[72:75], a[8:11], v[160:175]
s_waitcnt vmcnt(14)
ds_read_b64_tr_b16 v[80:81], v8 offset:14336
ds_read_b64_tr_b16 v[82:83], v8 offset:14848
v_mul_f32 v43, 0xbfb8aa3b, v99
v_exp_f32 v40, v40
v_exp_f32 v41, v41
v_mfma_f32_32x32x16_bf16 v[176:191], v[72:75], a[12:15], v[176:191]
s_add_u32 m0, s41, 10240
s_add_u32 s42, s42, 147456
buffer_load_dwordx4 v4, s[12:15], s42 offen lds
v_exp_f32 v42, v42
v_exp_f32 v43, v43
v_fma_f32 v40, v40, v3, v3
s_waitcnt lgkmcnt(2)
v_mfma_f32_32x32x16_bf16 v[192:207], v[76:79], a[8:11], v[192:207]
ds_read_b64_tr_b16 v[84:85], v9 offset:14336
ds_read_b64_tr_b16 v[86:87], v9 offset:14848
v_fma_f32 v41, v41, v3, v3
v_fma_f32 v42, v42, v3, v3
v_fma_f32 v43, v43, v3, v3
v_mfma_f32_32x32x16_bf16 v[208:223], v[76:79], a[12:15], v[208:223]
buffer_load_dwordx4 v5, s[12:15], s42 offen offset:1024 lds
v_rcp_f32 v40, v40
v_rcp_f32 v41, v41
v_rcp_f32 v42, v42
s_waitcnt lgkmcnt(2)
v_mfma_f32_32x32x16_bf16 v[160:175], v[80:83], a[16:19], v[160:175]
s_waitcnt vmcnt(14)
ds_read_b64_tr_b16 v[72:73], v8 offset:16384
ds_read_b64_tr_b16 v[74:75], v8 offset:16896
v_rcp_f32 v43, v43
v_mul_f32 v96, v96, v40
v_mul_f32 v97, v97, v41
v_mfma_f32_32x32x16_bf16 v[176:191], v[80:83], a[20:23], v[176:191]
s_add_u32 m0, s41, 12288
s_add_u32 s42, s42, 147456
buffer_load_dwordx4 v4, s[12:15], s42 offen lds
v_mul_f32 v98, v98, v42
v_mul_f32 v99, v99, v43
v_cvt_pk_bf16_f32 v48, v96, v97
s_waitcnt lgkmcnt(2)
v_mfma_f32_32x32x16_bf16 v[192:207], v[84:87], a[16:19], v[192:207]
ds_read_b64_tr_b16 v[76:77], v9 offset:16384
ds_read_b64_tr_b16 v[78:79], v9 offset:16896
v_cvt_pk_bf16_f32 v49, v98, v99
v_mul_f32 v44, 0xbfb8aa3b, v100
v_mul_f32 v45, 0xbfb8aa3b, v101
v_mfma_f32_32x32x16_bf16 v[208:223], v[84:87], a[20:23], v[208:223]
buffer_load_dwordx4 v5, s[12:15], s42 offen offset:1024 lds
v_mul_f32 v46, 0xbfb8aa3b, v102
v_mul_f32 v47, 0xbfb8aa3b, v103
v_exp_f32 v44, v44
s_waitcnt lgkmcnt(2)
v_mfma_f32_32x32x16_bf16 v[160:175], v[72:75], a[24:27], v[160:175]
s_waitcnt vmcnt(14)
ds_read_b64_tr_b16 v[80:81], v8 offset:18432
ds_read_b64_tr_b16 v[82:83], v8 offset:18944
v_exp_f32 v45, v45
v_exp_f32 v46, v46
v_mfma_f32_32x32x16_bf16 v[176:191], v[72:75], a[28:31], v[176:191]
s_add_u32 m0, s41, 14336
s_add_u32 s42, s47, s64
buffer_load_dwordx4 v4, s[12:15], s42 offen lds
v_exp_f32 v47, v47
v_fma_f32 v44, v44, v3, v3
v_fma_f32 v45, v45, v3, v3
s_waitcnt lgkmcnt(2)
v_mfma_f32_32x32x16_bf16 v[192:207], v[76:79], a[24:27], v[192:207]
ds_read_b64_tr_b16 v[84:85], v9 offset:18432
ds_read_b64_tr_b16 v[86:87], v9 offset:18944
v_fma_f32 v46, v46, v3, v3
v_fma_f32 v47, v47, v3, v3
v_rcp_f32 v44, v44
v_mfma_f32_32x32x16_bf16 v[208:223], v[76:79], a[28:31], v[208:223]
buffer_load_dwordx4 v5, s[12:15], s42 offen offset:1024 lds
v_rcp_f32 v45, v45
v_rcp_f32 v46, v46
v_rcp_f32 v47, v47
s_waitcnt lgkmcnt(2)
v_mfma_f32_32x32x16_bf16 v[160:175], v[80:83], a[32:35], v[160:175]
s_waitcnt vmcnt(14)
ds_read_b64_tr_b16 v[72:73], v8 offset:0
ds_read_b64_tr_b16 v[74:75], v8 offset:512
v_mul_f32 v100, v100, v44
v_mul_f32 v101, v101, v45
v_mul_f32 v102, v102, v46
v_mfma_f32_32x32x16_bf16 v[176:191], v[80:83], a[36:39], v[176:191]
s_add_u32 m0, s41, 16384
s_add_u32 s42, s42, 147456
buffer_load_dwordx4 v4, s[12:15], s42 offen lds
v_mul_f32 v103, v103, v47
v_cvt_pk_bf16_f32 v50, v100, v101
v_cvt_pk_bf16_f32 v51, v102, v103
s_waitcnt lgkmcnt(2)
v_mfma_f32_32x32x16_bf16 v[192:207], v[84:87], a[32:35], v[192:207]
ds_read_b64_tr_b16 v[76:77], v9 offset:0
ds_read_b64_tr_b16 v[78:79], v9 offset:512
ds_write_b128 v14, v[48:51] offset:0
v_mul_f32 v40, 0xbfb8aa3b, v104
v_mul_f32 v41, 0xbfb8aa3b, v105
v_mfma_f32_32x32x16_bf16 v[208:223], v[84:87], a[36:39], v[208:223]
buffer_load_dwordx4 v5, s[12:15], s42 offen offset:1024 lds
v_mul_f32 v42, 0xbfb8aa3b, v106
v_mul_f32 v43, 0xbfb8aa3b, v107
v_exp_f32 v40, v40
s_waitcnt lgkmcnt(3)
v_mfma_f32_32x32x16_bf16 v[160:175], v[72:75], a[40:43], v[160:175]
s_waitcnt vmcnt(14)
ds_read_b64_tr_b16 v[80:81], v8 offset:2048
ds_read_b64_tr_b16 v[82:83], v8 offset:2560
v_exp_f32 v41, v41
v_exp_f32 v42, v42
v_exp_f32 v43, v43
v_mfma_f32_32x32x16_bf16 v[176:191], v[72:75], a[44:47], v[176:191]
s_add_u32 m0, s41, 18432
s_add_u32 s42, s42, 147456
buffer_load_dwordx4 v4, s[12:15], s42 offen lds
v_fma_f32 v40, v40, v3, v3
v_fma_f32 v41, v41, v3, v3
v_fma_f32 v42, v42, v3, v3
s_waitcnt lgkmcnt(3)
v_mfma_f32_32x32x16_bf16 v[192:207], v[76:79], a[40:43], v[192:207]
ds_read_b64_tr_b16 v[84:85], v9 offset:2048
ds_read_b64_tr_b16 v[86:87], v9 offset:2560
v_fma_f32 v43, v43, v3, v3
v_rcp_f32 v40, v40
v_mfma_f32_32x32x16_bf16 v[208:223], v[76:79], a[44:47], v[208:223]
buffer_load_dwordx4 v5, s[12:15], s42 offen offset:1024 lds
v_rcp_f32 v41, v41
v_rcp_f32 v42, v42
v_rcp_f32 v43, v43
s_waitcnt lgkmcnt(2)
v_mfma_f32_32x32x16_bf16 v[160:175], v[80:83], a[48:51], v[160:175]
s_waitcnt vmcnt(14)
ds_read_b64_tr_b16 v[72:73], v8 offset:4096
ds_read_b64_tr_b16 v[74:75], v8 offset:4608
v_mul_f32 v104, v104, v40
v_mul_f32 v105, v105, v41
v_mul_f32 v106, v106, v42
v_mfma_f32_32x32x16_bf16 v[176:191], v[80:83], a[52:55], v[176:191]
s_add_u32 m0, s41, 0
s_add_u32 s42, s42, 147456
buffer_load_dwordx4 v4, s[12:15], s42 offen lds
v_mul_f32 v107, v107, v43
v_cvt_pk_bf16_f32 v52, v104, v105
v_cvt_pk_bf16_f32 v53, v106, v107
s_waitcnt lgkmcnt(2)
v_mfma_f32_32x32x16_bf16 v[192:207], v[84:87], a[48:51], v[192:207]
ds_read_b64_tr_b16 v[76:77], v9 offset:4096
ds_read_b64_tr_b16 v[78:79], v9 offset:4608
v_mul_f32 v44, 0xbfb8aa3b, v108
v_mul_f32 v45, 0xbfb8aa3b, v109
v_mul_f32 v46, 0xbfb8aa3b, v110
v_mfma_f32_32x32x16_bf16 v[208:223], v[84:87], a[52:55], v[208:223]
buffer_load_dwordx4 v5, s[12:15], s42 offen offset:1024 lds
v_mul_f32 v47, 0xbfb8aa3b, v111
v_exp_f32 v44, v44
v_exp_f32 v45, v45
s_waitcnt lgkmcnt(2)
v_mfma_f32_32x32x16_bf16 v[160:175], v[72:75], a[56:59], v[160:175]
s_waitcnt vmcnt(14)
ds_read_b64_tr_b16 v[80:81], v8 offset:6144
ds_read_b64_tr_b16 v[82:83], v8 offset:6656
v_exp_f32 v46, v46
v_exp_f32 v47, v47
v_fma_f32 v44, v44, v3, v3
v_mfma_f32_32x32x16_bf16 v[176:191], v[72:75], a[60:63], v[176:191]
s_add_u32 m0, s41, 2048
s_add_u32 s42, s48, s64
buffer_load_dwordx4 v4, s[12:15], s42 offen lds
v_fma_f32 v45, v45, v3, v3
v_fma_f32 v46, v46, v3, v3
v_fma_f32 v47, v47, v3, v3
s_waitcnt lgkmcnt(2)
v_mfma_f32_32x32x16_bf16 v[192:207], v[76:79], a[56:59], v[192:207]
ds_read_b64_tr_b16 v[84:85], v9 offset:6144
ds_read_b64_tr_b16 v[86:87], v9 offset:6656
v_rcp_f32 v44, v44
v_rcp_f32 v45, v45
v_rcp_f32 v46, v46
v_mfma_f32_32x32x16_bf16 v[208:223], v[76:79], a[60:63], v[208:223]
buffer_load_dwordx4 v5, s[12:15], s42 offen offset:1024 lds
v_rcp_f32 v47, v47
v_mul_f32 v108, v108, v44
s_waitcnt lgkmcnt(2)
v_mfma_f32_32x32x16_bf16 v[160:175], v[80:83], a[64:67], v[160:175]
s_waitcnt vmcnt(14)
ds_read_b64_tr_b16 v[72:73], v8 offset:8192
ds_read_b64_tr_b16 v[74:75], v8 offset:8704
v_mul_f32 v109, v109, v45
v_mul_f32 v110, v110, v46
v_mul_f32 v111, v111, v47
v_mfma_f32_32x32x16_bf16 v[176:191], v[80:83], a[68:71], v[176:191]
s_add_u32 m0, s41, 4096
s_add_u32 s42, s42, 147456
buffer_load_dwordx4 v4, s[12:15], s42 offen lds
v_cvt_pk_bf16_f32 v54, v108, v109
v_cvt_pk_bf16_f32 v55, v110, v111
ds_write_b128 v14, v[52:55] offset:2048
s_waitcnt lgkmcnt(3)
v_mfma_f32_32x32x16_bf16 v[192:207], v[84:87], a[64:67], v[192:207]
ds_read_b64_tr_b16 v[76:77], v9 offset:8192
ds_read_b64_tr_b16 v[78:79], v9 offset:8704
v_mul_f32 v40, 0xbfb8aa3b, v112
v_mul_f32 v41, 0xbfb8aa3b, v113
v_mul_f32 v42, 0xbfb8aa3b, v114
v_mfma_f32_32x32x16_bf16 v[208:223], v[84:87], a[68:71], v[208:223]
buffer_load_dwordx4 v5, s[12:15], s42 offen offset:1024 lds
v_mul_f32 v43, 0xbfb8aa3b, v115
v_exp_f32 v40, v40
v_exp_f32 v41, v41
s_waitcnt lgkmcnt(3)
v_mfma_f32_32x32x16_bf16 v[160:175], v[72:75], a[72:75], v[160:175]
s_waitcnt vmcnt(14)
ds_read_b64_tr_b16 v[80:81], v8 offset:10240
ds_read_b64_tr_b16 v[82:83], v8 offset:10752
v_exp_f32 v42, v42
v_exp_f32 v43, v43
v_fma_f32 v40, v40, v31, v31
v_mfma_f32_32x32x16_bf16 v[176:191], v[72:75], a[76:79], v[176:191]
s_add_u32 m0, s41, 6144
s_add_u32 s42, s42, 147456
buffer_load_dwordx4 v4, s[12:15], s42 offen lds
v_fma_f32 v41, v41, v31, v31
v_fma_f32 v42, v42, v31, v31
v_fma_f32 v43, v43, v31, v31
s_waitcnt lgkmcnt(2)
v_mfma_f32_32x32x16_bf16 v[192:207], v[76:79], a[72:75], v[192:207]
ds_read_b64_tr_b16 v[84:85], v9 offset:10240
ds_read_b64_tr_b16 v[86:87], v9 offset:10752
v_rcp_f32 v40, v40
v_rcp_f32 v41, v41
v_rcp_f32 v42, v42
v_mfma_f32_32x32x16_bf16 v[208:223], v[76:79], a[76:79], v[208:223]
buffer_load_dwordx4 v5, s[12:15], s42 offen offset:1024 lds
v_rcp_f32 v43, v43
v_mul_f32 v112, v112, v40
v_mul_f32 v113, v113, v41
s_waitcnt lgkmcnt(2)
v_mfma_f32_32x32x16_bf16 v[160:175], v[80:83], a[80:83], v[160:175]
s_waitcnt vmcnt(14)
ds_read_b64_tr_b16 v[72:73], v8 offset:12288
ds_read_b64_tr_b16 v[74:75], v8 offset:12800
v_mul_f32 v114, v114, v42
v_mul_f32 v115, v115, v43
v_cvt_pk_bf16_f32 v56, v112, v113
v_mfma_f32_32x32x16_bf16 v[176:191], v[80:83], a[84:87], v[176:191]
s_add_u32 m0, s41, 8192
s_add_u32 s42, s42, 147456
buffer_load_dwordx4 v4, s[12:15], s42 offen lds
v_cvt_pk_bf16_f32 v57, v114, v115
v_mul_f32 v44, 0xbfb8aa3b, v116
s_waitcnt lgkmcnt(2)
v_mfma_f32_32x32x16_bf16 v[192:207], v[84:87], a[80:83], v[192:207]
ds_read_b64_tr_b16 v[76:77], v9 offset:12288
ds_read_b64_tr_b16 v[78:79], v9 offset:12800
v_mul_f32 v45, 0xbfb8aa3b, v117
v_mul_f32 v46, 0xbfb8aa3b, v118
v_mul_f32 v47, 0xbfb8aa3b, v119
v_mfma_f32_32x32x16_bf16 v[208:223], v[84:87], a[84:87], v[208:223]
buffer_load_dwordx4 v5, s[12:15], s42 offen offset:1024 lds
v_exp_f32 v44, v44
v_exp_f32 v45, v45
v_exp_f32 v46, v46
s_waitcnt lgkmcnt(2)
v_mfma_f32_32x32x16_bf16 v[160:175], v[72:75], a[88:91], v[160:175]
s_waitcnt vmcnt(14)
ds_read_b64_tr_b16 v[80:81], v8 offset:14336
ds_read_b64_tr_b16 v[82:83], v8 offset:14848
v_exp_f32 v47, v47
v_fma_f32 v44, v44, v31, v31
v_fma_f32 v45, v45, v31, v31
v_mfma_f32_32x32x16_bf16 v[176:191], v[72:75], a[92:95], v[176:191]
s_add_u32 m0, s41, 10240
s_add_u32 s42, s49, s64
buffer_load_dwordx4 v4, s[12:15], s42 offen lds
v_fma_f32 v46, v46, v31, v31
v_fma_f32 v47, v47, v31, v31
v_rcp_f32 v44, v44
s_waitcnt lgkmcnt(2)
v_mfma_f32_32x32x16_bf16 v[192:207], v[76:79], a[88:91], v[192:207]
ds_read_b64_tr_b16 v[84:85], v9 offset:14336
ds_read_b64_tr_b16 v[86:87], v9 offset:14848
v_rcp_f32 v45, v45
v_rcp_f32 v46, v46
v_rcp_f32 v47, v47
v_mfma_f32_32x32x16_bf16 v[208:223], v[76:79], a[92:95], v[208:223]
buffer_load_dwordx4 v5, s[12:15], s42 offen offset:1024 lds
v_mul_f32 v116, v116, v44
v_mul_f32 v117, v117, v45
v_mul_f32 v118, v118, v46
s_waitcnt lgkmcnt(2)
v_mfma_f32_32x32x16_bf16 v[160:175], v[80:83], a[96:99], v[160:175]
s_waitcnt vmcnt(14)
ds_read_b64_tr_b16 v[72:73], v8 offset:16384
ds_read_b64_tr_b16 v[74:75], v8 offset:16896
v_mul_f32 v119, v119, v47
v_cvt_pk_bf16_f32 v58, v116, v117
v_cvt_pk_bf16_f32 v59, v118, v119
v_mfma_f32_32x32x16_bf16 v[176:191], v[80:83], a[100:103], v[176:191]
s_add_u32 m0, s41, 12288
s_add_u32 s42, s42, 147456
buffer_load_dwordx4 v4, s[12:15], s42 offen lds
ds_write_b128 v14, v[56:59] offset:1024
v_mul_f32 v40, 0xbfb8aa3b, v120
v_mul_f32 v41, 0xbfb8aa3b, v121
s_waitcnt lgkmcnt(3)
v_mfma_f32_32x32x16_bf16 v[192:207], v[84:87], a[96:99], v[192:207]
ds_read_b64_tr_b16 v[76:77], v9 offset:16384
ds_read_b64_tr_b16 v[78:79], v9 offset:16896
v_mul_f32 v42, 0xbfb8aa3b, v122
v_mul_f32 v43, 0xbfb8aa3b, v123
v_exp_f32 v40, v40
v_mfma_f32_32x32x16_bf16 v[208:223], v[84:87], a[100:103], v[208:223]
buffer_load_dwordx4 v5, s[12:15], s42 offen offset:1024 lds
v_exp_f32 v41, v41
v_exp_f32 v42, v42
s_waitcnt lgkmcnt(3)
v_mfma_f32_32x32x16_bf16 v[160:175], v[72:75], a[104:107], v[160:175]
s_waitcnt vmcnt(14)
ds_read_b64_tr_b16 v[80:81], v8 offset:18432
ds_read_b64_tr_b16 v[82:83], v8 offset:18944
v_exp_f32 v43, v43
v_fma_f32 v40, v40, v31, v31
v_fma_f32 v41, v41, v31, v31
v_mfma_f32_32x32x16_bf16 v[176:191], v[72:75], a[108:111], v[176:191]
s_add_u32 m0, s41, 14336
s_add_u32 s42, s42, 147456
buffer_load_dwordx4 v4, s[12:15], s42 offen lds
v_fma_f32 v42, v42, v31, v31
v_fma_f32 v43, v43, v31, v31
v_rcp_f32 v40, v40
s_waitcnt lgkmcnt(2)
v_mfma_f32_32x32x16_bf16 v[192:207], v[76:79], a[104:107], v[192:207]
ds_read_b64_tr_b16 v[84:85], v9 offset:18432
ds_read_b64_tr_b16 v[86:87], v9 offset:18944
v_rcp_f32 v41, v41
v_rcp_f32 v42, v42
v_rcp_f32 v43, v43
v_mfma_f32_32x32x16_bf16 v[208:223], v[76:79], a[108:111], v[208:223]
buffer_load_dwordx4 v5, s[12:15], s42 offen offset:1024 lds
v_mul_f32 v120, v120, v40
v_mul_f32 v121, v121, v41
v_mul_f32 v122, v122, v42
s_waitcnt lgkmcnt(2)
v_mfma_f32_32x32x16_bf16 v[160:175], v[80:83], a[112:115], v[160:175]
s_waitcnt vmcnt(14)
ds_read_b64_tr_b16 v[72:73], v8 offset:0
ds_read_b64_tr_b16 v[74:75], v8 offset:512
v_mul_f32 v123, v123, v43
v_cvt_pk_bf16_f32 v60, v120, v121
v_cvt_pk_bf16_f32 v61, v122, v123
v_mfma_f32_32x32x16_bf16 v[176:191], v[80:83], a[116:119], v[176:191]
s_add_u32 m0, s41, 16384
s_add_u32 s42, s42, 147456
buffer_load_dwordx4 v4, s[12:15], s42 offen lds
v_mul_f32 v44, 0xbfb8aa3b, v124
v_mul_f32 v45, 0xbfb8aa3b, v125
v_mul_f32 v46, 0xbfb8aa3b, v126
s_waitcnt lgkmcnt(2)
v_mfma_f32_32x32x16_bf16 v[192:207], v[84:87], a[112:115], v[192:207]
ds_read_b64_tr_b16 v[76:77], v9 offset:0
ds_read_b64_tr_b16 v[78:79], v9 offset:512
v_mul_f32 v47, 0xbfb8aa3b, v127
v_exp_f32 v44, v44
v_exp_f32 v45, v45
v_mfma_f32_32x32x16_bf16 v[208:223], v[84:87], a[116:119], v[208:223]
buffer_load_dwordx4 v5, s[12:15], s42 offen offset:1024 lds
v_exp_f32 v46, v46
v_exp_f32 v47, v47
v_fma_f32 v44, v44, v31, v31
s_waitcnt lgkmcnt(2)
v_mfma_f32_32x32x16_bf16 v[160:175], v[72:75], a[120:123], v[160:175]
s_waitcnt vmcnt(14)
ds_read_b64_tr_b16 v[80:81], v8 offset:2048
ds_read_b64_tr_b16 v[82:83], v8 offset:2560
v_fma_f32 v45, v45, v31, v31
v_fma_f32 v46, v46, v31, v31
v_mfma_f32_32x32x16_bf16 v[176:191], v[72:75], a[124:127], v[176:191]
s_add_u32 m0, s41, 18432
s_add_u32 s42, s50, s64
buffer_load_dwordx4 v4, s[12:15], s42 offen lds
v_fma_f32 v47, v47, v31, v31
v_rcp_f32 v44, v44
v_rcp_f32 v45, v45
s_waitcnt lgkmcnt(2)
v_mfma_f32_32x32x16_bf16 v[192:207], v[76:79], a[120:123], v[192:207]
ds_read_b64_tr_b16 v[84:85], v9 offset:2048
ds_read_b64_tr_b16 v[86:87], v9 offset:2560
v_rcp_f32 v46, v46
v_rcp_f32 v47, v47
v_mul_f32 v124, v124, v44
v_mfma_f32_32x32x16_bf16 v[208:223], v[76:79], a[124:127], v[208:223]
buffer_load_dwordx4 v5, s[12:15], s42 offen offset:1024 lds
v_mul_f32 v125, v125, v45
v_mul_f32 v126, v126, v46
v_mul_f32 v127, v127, v47
s_waitcnt lgkmcnt(2)
v_mfma_f32_32x32x16_bf16 v[160:175], v[80:83], a[128:131], v[160:175]
s_waitcnt vmcnt(14)
ds_read_b64_tr_b16 v[72:73], v8 offset:4096
ds_read_b64_tr_b16 v[74:75], v8 offset:4608
v_cvt_pk_bf16_f32 v62, v124, v125
v_cvt_pk_bf16_f32 v63, v126, v127
ds_write_b128 v14, v[60:63] offset:3072
v_mfma_f32_32x32x16_bf16 v[176:191], v[80:83], a[132:135], v[176:191]
s_add_u32 m0, s41, 0
s_add_u32 s42, s42, 147456
buffer_load_dwordx4 v4, s[12:15], s42 offen lds
v_mul_f32 v40, 0xbfb8aa3b, v128
v_mul_f32 v41, 0xbfb8aa3b, v129
s_waitcnt lgkmcnt(3)
v_mfma_f32_32x32x16_bf16 v[192:207], v[84:87], a[128:131], v[192:207]
ds_read_b64_tr_b16 v[76:77], v9 offset:4096
ds_read_b64_tr_b16 v[78:79], v9 offset:4608
v_mul_f32 v42, 0xbfb8aa3b, v130
v_mul_f32 v43, 0xbfb8aa3b, v131
v_exp_f32 v40, v40
v_mfma_f32_32x32x16_bf16 v[208:223], v[84:87], a[132:135], v[208:223]
buffer_load_dwordx4 v5, s[12:15], s42 offen offset:1024 lds
v_exp_f32 v41, v41
v_exp_f32 v42, v42
v_exp_f32 v43, v43
s_waitcnt lgkmcnt(3)
v_mfma_f32_32x32x16_bf16 v[160:175], v[72:75], a[136:139], v[160:175]
s_waitcnt vmcnt(14)
ds_read_b64_tr_b16 v[80:81], v8 offset:6144
ds_read_b64_tr_b16 v[82:83], v8 offset:6656
v_fma_f32 v40, v40, v3, v3
v_fma_f32 v41, v41, v3, v3
v_fma_f32 v42, v42, v3, v3
v_mfma_f32_32x32x16_bf16 v[176:191], v[72:75], a[140:143], v[176:191]
s_add_u32 m0, s41, 2048
s_add_u32 s42, s42, 147456
buffer_load_dwordx4 v4, s[12:15], s42 offen lds
v_fma_f32 v43, v43, v3, v3
v_rcp_f32 v40, v40
v_rcp_f32 v41, v41
s_waitcnt lgkmcnt(2)
v_mfma_f32_32x32x16_bf16 v[192:207], v[76:79], a[136:139], v[192:207]
ds_read_b64_tr_b16 v[84:85], v9 offset:6144
ds_read_b64_tr_b16 v[86:87], v9 offset:6656
v_rcp_f32 v42, v42
v_rcp_f32 v43, v43
v_mfma_f32_32x32x16_bf16 v[208:223], v[76:79], a[140:143], v[208:223]
buffer_load_dwordx4 v5, s[12:15], s42 offen offset:1024 lds
v_mul_f32 v128, v128, v40
v_mul_f32 v129, v129, v41
v_mul_f32 v130, v130, v42
s_waitcnt lgkmcnt(2)
v_mfma_f32_32x32x16_bf16 v[160:175], v[80:83], a[144:147], v[160:175]
s_waitcnt vmcnt(14)
ds_read_b64_tr_b16 v[72:73], v8 offset:8192
ds_read_b64_tr_b16 v[74:75], v8 offset:8704
v_mul_f32 v131, v131, v43
v_cvt_pk_bf16_f32 v48, v128, v129
v_cvt_pk_bf16_f32 v49, v130, v131
ds_read_b128 a[0:3], v28 offset:0
ds_read_b128 a[4:7], v28 offset:1024
v_mfma_f32_32x32x16_bf16 v[176:191], v[80:83], a[148:151], v[176:191]
s_add_u32 m0, s41, 4096
s_add_u32 s42, s42, 147456
buffer_load_dwordx4 v4, s[12:15], s42 offen lds
v_mul_f32 v44, 0xbfb8aa3b, v132
v_mul_f32 v45, 0xbfb8aa3b, v133
v_mul_f32 v46, 0xbfb8aa3b, v134
ds_read_b128 a[8:11], v28 offset:2048
ds_read_b128 a[12:15], v28 offset:3072
s_waitcnt lgkmcnt(6)
v_mfma_f32_32x32x16_bf16 v[192:207], v[84:87], a[144:147], v[192:207]
ds_read_b64_tr_b16 v[76:77], v9 offset:8192
ds_read_b64_tr_b16 v[78:79], v9 offset:8704
v_mul_f32 v47, 0xbfb8aa3b, v135
v_exp_f32 v44, v44
v_exp_f32 v45, v45
ds_read_b128 a[16:19], v28 offset:4096
ds_read_b128 a[20:23], v28 offset:5120
v_mfma_f32_32x32x16_bf16 v[208:223], v[84:87], a[148:151], v[208:223]
buffer_load_dwordx4 v5, s[12:15], s42 offen offset:1024 lds
v_exp_f32 v46, v46
v_exp_f32 v47, v47
v_fma_f32 v44, v44, v3, v3
s_waitcnt lgkmcnt(0)
v_mfma_f32_16x16x32_bf16 v[96:99], v[32:35], a[0:3], 0
v_mfma_f32_32x32x16_bf16 v[160:175], v[72:75], a[152:155], v[160:175]
s_waitcnt vmcnt(14)
ds_read_b64_tr_b16 v[80:81], v8 offset:10240
ds_read_b64_tr_b16 v[82:83], v8 offset:10752
v_fma_f32 v45, v45, v3, v3
v_fma_f32 v46, v46, v3, v3
v_fma_f32 v47, v47, v3, v3
v_mfma_f32_16x16x32_bf16 v[100:103], v[88:91], a[0:3], 0
v_mfma_f32_16x16x32_bf16 v[104:107], v[36:39], a[0:3], 0
v_mfma_f32_32x32x16_bf16 v[176:191], v[72:75], a[156:159], v[176:191]
s_add_u32 m0, s41, 6144
s_add_u32 s42, s51, s64
buffer_load_dwordx4 v4, s[12:15], s42 offen lds
v_rcp_f32 v44, v44
v_rcp_f32 v45, v45
v_rcp_f32 v46, v46
v_mfma_f32_16x16x32_bf16 v[108:111], v[92:95], a[0:3], 0
v_mfma_f32_32x32x16_bf16 v[192:207], v[76:79], a[152:155], v[192:207]
ds_read_b64_tr_b16 v[84:85], v9 offset:10240
ds_read_b64_tr_b16 v[86:87], v9 offset:10752
v_rcp_f32 v47, v47
v_mul_f32 v132, v132, v44
v_mul_f32 v133, v133, v45
v_mfma_f32_16x16x32_bf16 v[96:99], v[36:39], a[16:19], v[96:99]
v_mfma_f32_16x16x32_bf16 v[100:103], v[92:95], a[8:11], v[100:103]
v_mfma_f32_32x32x16_bf16 v[208:223], v[76:79], a[156:159], v[208:223]
buffer_load_dwordx4 v5, s[12:15], s42 offen offset:1024 lds
v_mul_f32 v134, v134, v46
v_mul_f32 v135, v135, v47
v_mfma_f32_16x16x32_bf16 v[104:107], v[32:35], a[8:11], v[104:107]
v_mfma_f32_16x16x32_bf16 v[108:111], v[88:91], a[16:19], v[108:111]
s_waitcnt lgkmcnt(2)
v_mfma_f32_32x32x16_bf16 v[160:175], v[80:83], a[160:163], v[160:175]
s_waitcnt vmcnt(14)
ds_read_b64_tr_b16 v[72:73], v8 offset:12288
ds_read_b64_tr_b16 v[74:75], v8 offset:12800
v_cvt_pk_bf16_f32 v50, v132, v133
v_cvt_pk_bf16_f32 v51, v134, v135
ds_write_b128 v14, v[48:51] offset:4096
v_mfma_f32_16x16x32_bf16 v[112:115], v[32:35], a[4:7], 0
v_mfma_f32_16x16x32_bf16 v[116:119], v[88:91], a[4:7], 0
v_mfma_f32_32x32x16_bf16 v[176:191], v[80:83], a[164:167], v[176:191]
s_add_u32 m0, s41, 8192
s_add_u32 s42, s42, 147456
buffer_load_dwordx4 v4, s[12:15], s42 offen lds
v_mul_f32 v40, 0xbfb8aa3b, v136
v_mul_f32 v41, 0xbfb8aa3b, v137
v_mul_f32 v42, 0xbfb8aa3b, v138
v_mfma_f32_16x16x32_bf16 v[120:123], v[36:39], a[4:7], 0
v_mfma_f32_16x16x32_bf16 v[124:127], v[92:95], a[4:7], 0
s_waitcnt lgkmcnt(3)
v_mfma_f32_32x32x16_bf16 v[192:207], v[84:87], a[160:163], v[192:207]
ds_read_b64_tr_b16 v[76:77], v9 offset:12288
ds_read_b64_tr_b16 v[78:79], v9 offset:12800
v_mul_f32 v43, 0xbfb8aa3b, v139
v_exp_f32 v40, v40
v_exp_f32 v41, v41
v_mfma_f32_16x16x32_bf16 v[112:115], v[36:39], a[20:23], v[112:115]
v_mfma_f32_16x16x32_bf16 v[116:119], v[92:95], a[12:15], v[116:119]
v_mfma_f32_32x32x16_bf16 v[208:223], v[84:87], a[164:167], v[208:223]
buffer_load_dwordx4 v5, s[12:15], s42 offen offset:1024 lds
v_exp_f32 v42, v42
v_exp_f32 v43, v43
v_fma_f32 v40, v40, v3, v3
v_mfma_f32_16x16x32_bf16 v[120:123], v[32:35], a[12:15], v[120:123]
s_waitcnt lgkmcnt(3)
v_mfma_f32_32x32x16_bf16 v[160:175], v[72:75], a[168:171], v[160:175]
s_waitcnt vmcnt(14)
ds_read_b64_tr_b16 v[80:81], v8 offset:14336
ds_read_b64_tr_b16 v[82:83], v8 offset:14848
v_fma_f32 v41, v41, v3, v3
v_fma_f32 v42, v42, v3, v3
v_fma_f32 v43, v43, v3, v3
v_mfma_f32_16x16x32_bf16 v[124:127], v[88:91], a[20:23], v[124:127]
s_cmp_eq_u32 s74, 32
s_cbranch_scc0 Lsk_k32_17
v_and_b32 v64, 15, v1
v_cvt_f32_u32 v64, v64
v_mul_f32 v64, 0x3c800000, v64
v_add_f32 v65, 0.25, v64
v_cos_f32 v66, v64
v_sin_f32 v67, v64
v_mul_f32 v96, v66, v96
v_mul_f32 v97, v66, v97
v_mul_f32 v98, v66, v98
v_mul_f32 v99, v66, v99
v_mul_f32 v100, v66, v100
v_mul_f32 v101, v66, v101
v_mul_f32 v102, v66, v102
v_mul_f32 v103, v66, v103
v_fma_f32 v96, -v67, v104, v96
v_fma_f32 v100, v67, v108, v100
v_fma_f32 v97, -v67, v105, v97
v_fma_f32 v101, v67, v109, v101
v_fma_f32 v98, -v67, v106, v98
v_fma_f32 v102, v67, v110, v102
v_fma_f32 v99, -v67, v107, v99
v_fma_f32 v103, v67, v111, v103
v_cos_f32 v66, v65
v_sin_f32 v67, v65
v_mul_f32 v112, v66, v112
v_mul_f32 v113, v66, v113
v_mul_f32 v114, v66, v114
v_mul_f32 v115, v66, v115
v_mul_f32 v116, v66, v116
v_mul_f32 v117, v66, v117
v_mul_f32 v118, v66, v118
v_mul_f32 v119, v66, v119
v_fma_f32 v112, -v67, v120, v112
v_fma_f32 v116, v67, v124, v116
v_fma_f32 v113, -v67, v121, v113
v_fma_f32 v117, v67, v125, v117
v_fma_f32 v114, -v67, v122, v114
v_fma_f32 v118, v67, v126, v118
v_fma_f32 v115, -v67, v123, v115
v_fma_f32 v119, v67, v127, v119
Lsk_k32_17:
v_mfma_f32_32x32x16_bf16 v[176:191], v[72:75], a[172:175], v[176:191]
s_add_u32 m0, s41, 10240
s_add_u32 s42, s42, 147456
buffer_load_dwordx4 v4, s[12:15], s42 offen lds
v_rcp_f32 v40, v40
v_rcp_f32 v41, v41
v_rcp_f32 v42, v42
v_cvt_pk_bf16_f32 v32, v96, v97
v_cvt_pk_bf16_f32 v33, v98, v99
s_waitcnt lgkmcnt(2)
v_mfma_f32_32x32x16_bf16 v[192:207], v[76:79], a[168:171], v[192:207]
ds_read_b64_tr_b16 v[84:85], v9 offset:14336
ds_read_b64_tr_b16 v[86:87], v9 offset:14848
v_rcp_f32 v43, v43
v_mul_f32 v136, v136, v40
v_mul_f32 v137, v137, v41
v_cvt_pk_bf16_f32 v34, v100, v101
v_cvt_pk_bf16_f32 v35, v102, v103
v_mfma_f32_32x32x16_bf16 v[208:223], v[76:79], a[172:175], v[208:223]
buffer_load_dwordx4 v5, s[12:15], s42 offen offset:1024 lds
v_mul_f32 v138, v138, v42
v_mul_f32 v139, v139, v43
v_cvt_pk_bf16_f32 v52, v136, v137
buffer_store_dwordx4 v[32:35], v27, s[4:7], s8 offen offset:0 sc1
v_cvt_pk_bf16_f32 v88, v104, v105
s_waitcnt lgkmcnt(2)
v_mfma_f32_32x32x16_bf16 v[160:175], v[80:83], a[176:179], v[160:175]
s_waitcnt vmcnt(15)
ds_read_b64_tr_b16 v[72:73], v8 offset:16384
ds_read_b64_tr_b16 v[74:75], v8 offset:16896
v_cvt_pk_bf16_f32 v53, v138, v139
v_mul_f32 v44, 0xbfb8aa3b, v140
v_mul_f32 v45, 0xbfb8aa3b, v141
v_cvt_pk_bf16_f32 v89, v106, v107
v_cvt_pk_bf16_f32 v90, -v108, -v109
v_mfma_f32_32x32x16_bf16 v[176:191], v[80:83], a[180:183], v[176:191]
s_add_u32 m0, s41, 12288
s_add_u32 s42, s42, 147456
buffer_load_dwordx4 v4, s[12:15], s42 offen lds
v_mul_f32 v46, 0xbfb8aa3b, v142
v_mul_f32 v47, 0xbfb8aa3b, v143
v_cvt_pk_bf16_f32 v91, -v110, -v111
s_waitcnt lgkmcnt(2)
v_mfma_f32_32x32x16_bf16 v[192:207], v[84:87], a[176:179], v[192:207]
ds_read_b64_tr_b16 v[76:77], v9 offset:16384
ds_read_b64_tr_b16 v[78:79], v9 offset:16896
v_exp_f32 v44, v44
v_exp_f32 v45, v45
v_exp_f32 v46, v46
buffer_store_dwordx4 v[88:91], v27, s[4:7], s10 offen offset:64 sc1
v_cvt_pk_bf16_f32 v36, v112, v113
v_mfma_f32_32x32x16_bf16 v[208:223], v[84:87], a[180:183], v[208:223]
buffer_load_dwordx4 v5, s[12:15], s42 offen offset:1024 lds
v_exp_f32 v47, v47
v_fma_f32 v44, v44, v3, v3
v_fma_f32 v45, v45, v3, v3
v_cvt_pk_bf16_f32 v37, v114, v115
v_cvt_pk_bf16_f32 v38, v116, v117
s_waitcnt lgkmcnt(2)
v_mfma_f32_32x32x16_bf16 v[160:175], v[72:75], a[184:187], v[160:175]
s_waitcnt vmcnt(16)
ds_read_b64_tr_b16 v[80:81], v8 offset:18432
ds_read_b64_tr_b16 v[82:83], v8 offset:18944
v_fma_f32 v46, v46, v3, v3
v_fma_f32 v47, v47, v3, v3
v_rcp_f32 v44, v44
v_cvt_pk_bf16_f32 v39, v118, v119
buffer_store_dwordx4 v[36:39], v27, s[4:7], s9 offen offset:0 sc1
v_mfma_f32_32x32x16_bf16 v[176:191], v[72:75], a[188:191], v[176:191]
s_add_u32 m0, s41, 14336
s_add_u32 s42, s52, s64
buffer_load_dwordx4 v4, s[12:15], s42 offen lds
v_rcp_f32 v45, v45
v_rcp_f32 v46, v46
v_rcp_f32 v47, v47
v_cvt_pk_bf16_f32 v92, v120, v121
v_cvt_pk_bf16_f32 v93, v122, v123
s_waitcnt lgkmcnt(2)
v_mfma_f32_32x32x16_bf16 v[192:207], v[76:79], a[184:187], v[192:207]
ds_read_b64_tr_b16 v[84:85], v9 offset:18432
ds_read_b64_tr_b16 v[86:87], v9 offset:18944
v_mul_f32 v140, v140, v44
v_mul_f32 v141, v141, v45
v_mul_f32 v142, v142, v46
v_cvt_pk_bf16_f32 v94, -v124, -v125
v_cvt_pk_bf16_f32 v95, -v126, -v127
v_mfma_f32_32x32x16_bf16 v[208:223], v[76:79], a[188:191], v[208:223]
buffer_load_dwordx4 v5, s[12:15], s42 offen offset:1024 lds
v_mul_f32 v143, v143, v47
v_cvt_pk_bf16_f32 v54, v140, v141
v_cvt_pk_bf16_f32 v55, v142, v143
buffer_store_dwordx4 v[92:95], v27, s[4:7], s11 offen offset:64 sc1
s_waitcnt lgkmcnt(2)
v_mfma_f32_32x32x16_bf16 v[160:175], v[80:83], a[192:195], v[160:175]
s_waitcnt vmcnt(18)
ds_read_b64_tr_b16 v[72:73], v8 offset:0
ds_read_b64_tr_b16 v[74:75], v8 offset:512
ds_write_b128 v14, v[52:55] offset:6144
v_mul_f32 v40, 0xbfb8aa3b, v144
v_mfma_f32_32x32x16_bf16 v[176:191], v[80:83], a[196:199], v[176:191]
s_add_u32 m0, s41, 16384
s_add_u32 s42, s42, 147456
buffer_load_dwordx4 v4, s[12:15], s42 offen lds
v_mul_f32 v41, 0xbfb8aa3b, v145
v_mul_f32 v42, 0xbfb8aa3b, v146
v_mul_f32 v43, 0xbfb8aa3b, v147
s_waitcnt lgkmcnt(3)
v_mfma_f32_32x32x16_bf16 v[192:207], v[84:87], a[192:195], v[192:207]
ds_read_b64_tr_b16 v[76:77], v9 offset:0
ds_read_b64_tr_b16 v[78:79], v9 offset:512
v_exp_f32 v40, v40
v_exp_f32 v41, v41
v_exp_f32 v42, v42
v_mfma_f32_32x32x16_bf16 v[208:223], v[84:87], a[196:199], v[208:223]
buffer_load_dwordx4 v5, s[12:15], s42 offen offset:1024 lds
v_exp_f32 v43, v43
v_fma_f32 v40, v40, v31, v31
s_waitcnt lgkmcnt(3)
v_mfma_f32_32x32x16_bf16 v[160:175], v[72:75], a[200:203], v[160:175]
s_waitcnt vmcnt(18)
ds_read_b64_tr_b16 v[80:81], v8 offset:2048
ds_read_b64_tr_b16 v[82:83], v8 offset:2560
v_fma_f32 v41, v41, v31, v31
v_fma_f32 v42, v42, v31, v31
v_fma_f32 v43, v43, v31, v31
v_mfma_f32_32x32x16_bf16 v[176:191], v[72:75], a[204:207], v[176:191]
s_add_u32 m0, s41, 18432
s_add_u32 s42, s42, 147456
buffer_load_dwordx4 v4, s[12:15], s42 offen lds
v_rcp_f32 v40, v40
v_rcp_f32 v41, v41
v_rcp_f32 v42, v42
s_waitcnt lgkmcnt(2)
v_mfma_f32_32x32x16_bf16 v[192:207], v[76:79], a[200:203], v[192:207]
ds_read_b64_tr_b16 v[84:85], v9 offset:2048
ds_read_b64_tr_b16 v[86:87], v9 offset:2560
v_rcp_f32 v43, v43
v_mul_f32 v144, v144, v40
v_mul_f32 v145, v145, v41
v_mfma_f32_32x32x16_bf16 v[208:223], v[76:79], a[204:207], v[208:223]
buffer_load_dwordx4 v5, s[12:15], s42 offen offset:1024 lds
v_mul_f32 v146, v146, v42
v_mul_f32 v147, v147, v43
v_cvt_pk_bf16_f32 v56, v144, v145
s_waitcnt lgkmcnt(2)
v_mfma_f32_32x32x16_bf16 v[160:175], v[80:83], a[208:211], v[160:175]
s_waitcnt vmcnt(18)
ds_read_b64_tr_b16 v[72:73], v8 offset:4096
ds_read_b64_tr_b16 v[74:75], v8 offset:4608
v_cvt_pk_bf16_f32 v57, v146, v147
v_mul_f32 v44, 0xbfb8aa3b, v148
v_mul_f32 v45, 0xbfb8aa3b, v149
v_mfma_f32_32x32x16_bf16 v[176:191], v[80:83], a[212:215], v[176:191]
s_add_u32 m0, s41, 0
s_add_u32 s42, s42, 147456
buffer_load_dwordx4 v4, s[12:15], s42 offen lds
v_mul_f32 v46, 0xbfb8aa3b, v150
v_mul_f32 v47, 0xbfb8aa3b, v151
v_exp_f32 v44, v44
s_waitcnt lgkmcnt(2)
v_mfma_f32_32x32x16_bf16 v[192:207], v[84:87], a[208:211], v[192:207]
ds_read_b64_tr_b16 v[76:77], v9 offset:4096
ds_read_b64_tr_b16 v[78:79], v9 offset:4608
v_exp_f32 v45, v45
v_exp_f32 v46, v46
v_exp_f32 v47, v47
v_mfma_f32_32x32x16_bf16 v[208:223], v[84:87], a[212:215], v[208:223]
buffer_load_dwordx4 v5, s[12:15], s42 offen offset:1024 lds
v_fma_f32 v44, v44, v31, v31
v_fma_f32 v45, v45, v31, v31
v_fma_f32 v46, v46, v31, v31
s_waitcnt lgkmcnt(2)
v_mfma_f32_32x32x16_bf16 v[160:175], v[72:75], a[216:219], v[160:175]
s_waitcnt vmcnt(18)
ds_read_b64_tr_b16 v[80:81], v8 offset:6144
ds_read_b64_tr_b16 v[82:83], v8 offset:6656
v_fma_f32 v47, v47, v31, v31
v_rcp_f32 v44, v44
v_mfma_f32_32x32x16_bf16 v[176:191], v[72:75], a[220:223], v[176:191]
s_add_u32 m0, s41, 2048
s_add_u32 s42, s54, s66
buffer_load_dwordx4 v6, s[16:19], s42 offen lds
v_rcp_f32 v45, v45
v_rcp_f32 v46, v46
v_rcp_f32 v47, v47
s_waitcnt lgkmcnt(2)
v_mfma_f32_32x32x16_bf16 v[192:207], v[76:79], a[216:219], v[192:207]
ds_read_b64_tr_b16 v[84:85], v9 offset:6144
ds_read_b64_tr_b16 v[86:87], v9 offset:6656
v_mul_f32 v148, v148, v44
v_mul_f32 v149, v149, v45
v_mul_f32 v150, v150, v46
v_mfma_f32_32x32x16_bf16 v[208:223], v[76:79], a[220:223], v[208:223]
buffer_load_dwordx4 v7, s[16:19], s42 offen offset:1024 lds
v_mul_f32 v151, v151, v47
v_cvt_pk_bf16_f32 v58, v148, v149
v_cvt_pk_bf16_f32 v59, v150, v151
s_waitcnt lgkmcnt(2)
v_mfma_f32_32x32x16_bf16 v[160:175], v[80:83], a[224:227], v[160:175]
s_waitcnt vmcnt(18)
ds_read_b64_tr_b16 v[72:73], v8 offset:8192
ds_read_b64_tr_b16 v[74:75], v8 offset:8704
ds_write_b128 v14, v[56:59] offset:5120
v_mul_f32 v40, 0xbfb8aa3b, v152
v_mul_f32 v41, 0xbfb8aa3b, v153
v_mfma_f32_32x32x16_bf16 v[176:191], v[80:83], a[228:231], v[176:191]
s_add_u32 m0, s41, 4096
s_add_u32 s42, s42, 18432
buffer_load_dwordx4 v6, s[16:19], s42 offen lds
v_mul_f32 v42, 0xbfb8aa3b, v154
v_mul_f32 v43, 0xbfb8aa3b, v155
v_exp_f32 v40, v40
s_waitcnt lgkmcnt(3)
v_mfma_f32_32x32x16_bf16 v[192:207], v[84:87], a[224:227], v[192:207]
ds_read_b64_tr_b16 v[76:77], v9 offset:8192
ds_read_b64_tr_b16 v[78:79], v9 offset:8704
v_exp_f32 v41, v41
v_exp_f32 v42, v42
v_exp_f32 v43, v43
v_mfma_f32_32x32x16_bf16 v[208:223], v[84:87], a[228:231], v[208:223]
buffer_load_dwordx4 v7, s[16:19], s42 offen offset:1024 lds
v_fma_f32 v40, v40, v31, v31
v_fma_f32 v41, v41, v31, v31
v_fma_f32 v42, v42, v31, v31
s_waitcnt lgkmcnt(3)
v_mfma_f32_32x32x16_bf16 v[160:175], v[72:75], a[232:235], v[160:175]
s_waitcnt vmcnt(18)
ds_read_b64_tr_b16 v[80:81], v8 offset:10240
ds_read_b64_tr_b16 v[82:83], v8 offset:10752
v_fma_f32 v43, v43, v31, v31
v_rcp_f32 v40, v40
v_rcp_f32 v41, v41
v_mfma_f32_32x32x16_bf16 v[176:191], v[72:75], a[236:239], v[176:191]
s_add_u32 m0, s41, 6144
s_add_u32 s42, s42, 18432
buffer_load_dwordx4 v6, s[16:19], s42 offen lds
v_rcp_f32 v42, v42
v_rcp_f32 v43, v43
v_mul_f32 v152, v152, v40
s_waitcnt lgkmcnt(2)
v_mfma_f32_32x32x16_bf16 v[192:207], v[76:79], a[232:235], v[192:207]
ds_read_b64_tr_b16 v[84:85], v9 offset:10240
ds_read_b64_tr_b16 v[86:87], v9 offset:10752
v_mul_f32 v153, v153, v41
v_mul_f32 v154, v154, v42
v_mfma_f32_32x32x16_bf16 v[208:223], v[76:79], a[236:239], v[208:223]
buffer_load_dwordx4 v7, s[16:19], s42 offen offset:1024 lds
v_mul_f32 v155, v155, v43
v_cvt_pk_bf16_f32 v60, v152, v153
v_cvt_pk_bf16_f32 v61, v154, v155
s_waitcnt lgkmcnt(2)
v_mfma_f32_32x32x16_bf16 v[160:175], v[80:83], a[240:243], v[160:175]
s_waitcnt vmcnt(16)
ds_read_b64_tr_b16 v[72:73], v8 offset:12288
ds_read_b64_tr_b16 v[74:75], v8 offset:12800
v_mul_f32 v44, 0xbfb8aa3b, v156
v_mul_f32 v45, 0xbfb8aa3b, v157
v_mul_f32 v46, 0xbfb8aa3b, v158
v_mfma_f32_32x32x16_bf16 v[176:191], v[80:83], a[244:247], v[176:191]
s_add_u32 m0, s41, 8192
s_add_u32 s42, s42, 18432
buffer_load_dwordx4 v6, s[16:19], s42 offen lds
v_mul_f32 v47, 0xbfb8aa3b, v159
v_exp_f32 v44, v44
v_exp_f32 v45, v45
s_waitcnt lgkmcnt(2)
v_mfma_f32_32x32x16_bf16 v[192:207], v[84:87], a[240:243], v[192:207]
ds_read_b64_tr_b16 v[76:77], v9 offset:12288
ds_read_b64_tr_b16 v[78:79], v9 offset:12800
v_exp_f32 v46, v46
v_exp_f32 v47, v47
v_fma_f32 v44, v44, v31, v31
v_mfma_f32_32x32x16_bf16 v[208:223], v[84:87], a[244:247], v[208:223]
buffer_load_dwordx4 v7, s[16:19], s42 offen offset:1024 lds
v_fma_f32 v45, v45, v31, v31
v_fma_f32 v46, v46, v31, v31
v_fma_f32 v47, v47, v31, v31
s_waitcnt lgkmcnt(2)
v_mfma_f32_32x32x16_bf16 v[160:175], v[72:75], a[248:251], v[160:175]
s_waitcnt vmcnt(15)
ds_read_b64_tr_b16 v[80:81], v8 offset:14336
ds_read_b64_tr_b16 v[82:83], v8 offset:14848
v_rcp_f32 v44, v44
v_rcp_f32 v45, v45
v_rcp_f32 v46, v46
v_mfma_f32_32x32x16_bf16 v[176:191], v[72:75], a[252:255], v[176:191]
s_add_u32 m0, s41, 10240
s_add_u32 s42, s55, s66
buffer_load_dwordx4 v6, s[16:19], s42 offen lds
v_rcp_f32 v47, v47
v_mul_f32 v156, v156, v44
v_mul_f32 v157, v157, v45
s_waitcnt lgkmcnt(2)
v_mfma_f32_32x32x16_bf16 v[192:207], v[76:79], a[248:251], v[192:207]
ds_read_b64_tr_b16 v[84:85], v9 offset:14336
ds_read_b64_tr_b16 v[86:87], v9 offset:14848
v_mul_f32 v158, v158, v46
v_mul_f32 v159, v159, v47
v_cvt_pk_bf16_f32 v62, v156, v157
s_waitcnt vmcnt(15)
s_mov_b64 exec, 2
buffer_store_dword v25, v25, s[4:7], 0 offen sc1
s_mov_b64 exec, -1
v_mfma_f32_32x32x16_bf16 v[208:223], v[76:79], a[252:255], v[208:223]
buffer_load_dwordx4 v7, s[16:19], s42 offen offset:1024 lds
v_cvt_pk_bf16_f32 v63, v158, v159
ds_write_b128 v14, v[60:63] offset:7168
s_waitcnt lgkmcnt(3)
v_mfma_f32_32x32x16_bf16 v[160:175], v[80:83], v[224:227], v[160:175]
s_waitcnt vmcnt(15)
ds_read_b64_tr_b16 v[72:73], v8 offset:16384
ds_read_b64_tr_b16 v[74:75], v8 offset:16896
v_mfma_f32_32x32x16_bf16 v[176:191], v[80:83], v[228:231], v[176:191]
s_add_u32 m0, s41, 12288
s_add_u32 s42, s42, 18432
buffer_load_dwordx4 v6, s[16:19], s42 offen lds
s_waitcnt lgkmcnt(3)
v_mfma_f32_32x32x16_bf16 v[192:207], v[84:87], v[224:227], v[192:207]
ds_read_b64_tr_b16 v[76:77], v9 offset:16384
ds_read_b64_tr_b16 v[78:79], v9 offset:16896
v_mfma_f32_32x32x16_bf16 v[208:223], v[84:87], v[228:231], v[208:223]
buffer_load_dwordx4 v7, s[16:19], s42 offen offset:1024 lds
s_waitcnt lgkmcnt(2)
v_mfma_f32_32x32x16_bf16 v[160:175], v[72:75], v[232:235], v[160:175]
s_waitcnt vmcnt(15)
ds_read_b64_tr_b16 v[80:81], v8 offset:18432
ds_read_b64_tr_b16 v[82:83], v8 offset:18944
ds_read_b128 a[0:3], v12 offset:0
v_mfma_f32_32x32x16_bf16 v[176:191], v[72:75], v[236:239], v[176:191]
s_add_u32 m0, s41, 14336
s_add_u32 s42, s42, 18432
buffer_load_dwordx4 v6, s[16:19], s42 offen lds
ds_read_b128 a[4:7], v12 offset:1024
s_waitcnt lgkmcnt(4)
v_mfma_f32_32x32x16_bf16 v[192:207], v[76:79], v[232:235], v[192:207]
ds_read_b64_tr_b16 v[84:85], v9 offset:18432
ds_read_b64_tr_b16 v[86:87], v9 offset:18944
v_mfma_f32_32x32x16_bf16 v[208:223], v[76:79], v[236:239], v[208:223]
buffer_load_dwordx4 v7, s[16:19], s42 offen offset:1024 lds
ds_read_b128 a[8:11], v12 offset:2048
s_waitcnt lgkmcnt(5)
v_mfma_f32_32x32x16_bf16 v[160:175], v[80:83], v[240:243], v[160:175]
s_waitcnt vmcnt(15)
ds_read_b64_tr_b16 v[72:73], v8 offset:0
ds_read_b64_tr_b16 v[74:75], v8 offset:512
v_mfma_f32_32x32x16_bf16 v[176:191], v[80:83], v[244:247], v[176:191]
s_add_u32 m0, s41, 16384
s_add_u32 s42, s42, 18432
buffer_load_dwordx4 v6, s[16:19], s42 offen lds
ds_read_b128 a[12:15], v12 offset:3072
s_waitcnt lgkmcnt(4)
v_mfma_f32_32x32x16_bf16 v[192:207], v[84:87], v[240:243], v[192:207]
ds_read_b64_tr_b16 v[76:77], v9 offset:0
ds_read_b64_tr_b16 v[78:79], v9 offset:512
ds_read_b128 a[16:19], v12 offset:4096
v_mfma_f32_32x32x16_bf16 v[208:223], v[84:87], v[244:247], v[208:223]
buffer_load_dwordx4 v7, s[16:19], s42 offen offset:1024 lds
s_waitcnt lgkmcnt(4)
v_mfma_f32_32x32x16_bf16 v[160:175], v[72:75], v[248:251], v[160:175]
s_waitcnt vmcnt(15)
ds_read_b64_tr_b16 v[80:81], v10 offset:2048
ds_read_b64_tr_b16 v[82:83], v10 offset:3072
ds_read_b128 a[20:23], v12 offset:5120
v_mfma_f32_32x32x16_bf16 v[176:191], v[72:75], v[252:255], v[176:191]
s_add_u32 m0, s41, 18432
s_add_u32 s42, s56, s66
buffer_load_dwordx4 v6, s[16:19], s42 offen lds
s_waitcnt lgkmcnt(4)
v_mfma_f32_32x32x16_bf16 v[192:207], v[76:79], v[248:251], v[192:207]
ds_read_b64_tr_b16 v[84:85], v11 offset:2048
ds_read_b64_tr_b16 v[86:87], v11 offset:3072
v_mfma_f32_32x32x16_bf16 v[208:223], v[76:79], v[252:255], v[208:223]
buffer_load_dwordx4 v7, s[16:19], s42 offen offset:1024 lds
s_barrier
s_waitcnt lgkmcnt(3)
v_mfma_f32_32x32x16_bf16 v[96:111], v[80:83], a[0:3], 0
s_waitcnt vmcnt(15)
ds_read_b64_tr_b16 v[72:73], v10 offset:4096
ds_read_b64_tr_b16 v[74:75], v10 offset:5120
v_mfma_f32_32x32x16_bf16 v[112:127], v[80:83], a[4:7], 0
s_add_u32 m0, s41, 0
s_add_u32 s42, s42, 18432
buffer_load_dwordx4 v6, s[16:19], s42 offen lds
ds_read_b128 a[24:27], v12 offset:6144
s_waitcnt lgkmcnt(3)
v_mfma_f32_32x32x16_bf16 v[128:143], v[84:87], a[0:3], 0
ds_read_b64_tr_b16 v[76:77], v11 offset:4096
ds_read_b64_tr_b16 v[78:79], v11 offset:5120
v_mfma_f32_32x32x16_bf16 v[144:159], v[84:87], a[4:7], 0
buffer_load_dwordx4 v7, s[16:19], s42 offen offset:1024 lds
ds_read_b128 a[28:31], v12 offset:7168
v_mul_f32 v40, 0xbfb8aa3b, v160
v_mul_f32 v41, 0xbfb8aa3b, v161
v_mul_f32 v42, 0xbfb8aa3b, v162
v_mul_f32 v43, 0xbfb8aa3b, v163
v_exp_f32 v40, v40
v_exp_f32 v41, v41
s_waitcnt lgkmcnt(4)
v_mfma_f32_32x32x16_bf16 v[96:111], v[72:75], a[8:11], v[96:111]
s_waitcnt vmcnt(15)
ds_read_b64_tr_b16 v[80:81], v10 offset:6144
ds_read_b64_tr_b16 v[82:83], v10 offset:7168
v_exp_f32 v42, v42
v_exp_f32 v43, v43
v_fma_f32 v40, v40, v3, v3
v_fma_f32 v41, v41, v3, v3
v_fma_f32 v42, v42, v3, v3
v_fma_f32 v43, v43, v3, v3
v_mfma_f32_32x32x16_bf16 v[112:127], v[72:75], a[12:15], v[112:127]
s_add_u32 m0, s41, 2048
s_add_u32 s42, s42, 18432
buffer_load_dwordx4 v6, s[16:19], s42 offen lds
ds_read_b128 a[32:35], v12 offset:8192
v_rcp_f32 v40, v40
v_rcp_f32 v41, v41
v_rcp_f32 v42, v42
v_rcp_f32 v43, v43
v_mul_f32 v160, v160, v40
s_waitcnt lgkmcnt(4)
v_mfma_f32_32x32x16_bf16 v[128:143], v[76:79], a[8:11], v[128:143]
ds_read_b64_tr_b16 v[84:85], v11 offset:6144
ds_read_b64_tr_b16 v[86:87], v11 offset:7168
v_mul_f32 v161, v161, v41
v_mul_f32 v162, v162, v42
v_mul_f32 v163, v163, v43
v_cvt_pk_bf16_f32 v48, v160, v161
v_cvt_pk_bf16_f32 v49, v162, v163
v_mul_f32 v44, 0xbfb8aa3b, v164
v_mfma_f32_32x32x16_bf16 v[144:159], v[76:79], a[12:15], v[144:159]
buffer_load_dwordx4 v7, s[16:19], s42 offen offset:1024 lds
ds_read_b128 a[36:39], v12 offset:9216
v_mul_f32 v45, 0xbfb8aa3b, v165
v_mul_f32 v46, 0xbfb8aa3b, v166
v_mul_f32 v47, 0xbfb8aa3b, v167
v_exp_f32 v44, v44
v_exp_f32 v45, v45
v_exp_f32 v46, v46
s_waitcnt lgkmcnt(4)
v_mfma_f32_32x32x16_bf16 v[96:111], v[80:83], a[16:19], v[96:111]
s_waitcnt vmcnt(15)
ds_read_b64_tr_b16 v[72:73], v10 offset:8192
ds_read_b64_tr_b16 v[74:75], v10 offset:9216
v_exp_f32 v47, v47
v_fma_f32 v44, v44, v3, v3
v_fma_f32 v45, v45, v3, v3
v_fma_f32 v46, v46, v3, v3
v_fma_f32 v47, v47, v3, v3
v_mfma_f32_32x32x16_bf16 v[112:127], v[80:83], a[20:23], v[112:127]
s_add_u32 m0, s41, 4096
s_add_u32 s42, s42, 18432
buffer_load_dwordx4 v6, s[16:19], s42 offen lds
ds_read_b128 a[40:43], v12 offset:10240
v_rcp_f32 v44, v44
v_rcp_f32 v45, v45
v_rcp_f32 v46, v46
v_rcp_f32 v47, v47
v_mul_f32 v164, v164, v44
v_mul_f32 v165, v165, v45
s_waitcnt lgkmcnt(4)
v_mfma_f32_32x32x16_bf16 v[128:143], v[84:87], a[16:19], v[128:143]
ds_read_b64_tr_b16 v[76:77], v11 offset:8192
ds_read_b64_tr_b16 v[78:79], v11 offset:9216
v_mul_f32 v166, v166, v46
v_mul_f32 v167, v167, v47
v_cvt_pk_bf16_f32 v50, v164, v165
v_cvt_pk_bf16_f32 v51, v166, v167
ds_write_b128 v14, v[48:51] offset:32768
v_mul_f32 v40, 0xbfb8aa3b, v168
v_mfma_f32_32x32x16_bf16 v[144:159], v[84:87], a[20:23], v[144:159]
buffer_load_dwordx4 v7, s[16:19], s42 offen offset:1024 lds
ds_read_b128 a[44:47], v12 offset:11264
v_mul_f32 v41, 0xbfb8aa3b, v169
v_mul_f32 v42, 0xbfb8aa3b, v170
v_mul_f32 v43, 0xbfb8aa3b, v171
v_exp_f32 v40, v40
v_exp_f32 v41, v41
s_waitcnt lgkmcnt(5)
v_mfma_f32_32x32x16_bf16 v[96:111], v[72:75], a[24:27], v[96:111]
s_waitcnt vmcnt(14)
ds_read_b64_tr_b16 v[80:81], v10 offset:10240
ds_read_b64_tr_b16 v[82:83], v10 offset:11264
v_exp_f32 v42, v42
v_exp_f32 v43, v43
v_fma_f32 v40, v40, v3, v3
v_fma_f32 v41, v41, v3, v3
v_fma_f32 v42, v42, v3, v3
v_fma_f32 v43, v43, v3, v3
v_mfma_f32_32x32x16_bf16 v[112:127], v[72:75], a[28:31], v[112:127]
s_add_u32 m0, s41, 6144
s_add_u32 s42, s57, s66
buffer_load_dwordx4 v6, s[16:19], s42 offen lds
ds_read_b128 a[48:51], v12 offset:12288
v_rcp_f32 v40, v40
v_rcp_f32 v41, v41
v_rcp_f32 v42, v42
v_rcp_f32 v43, v43
v_mul_f32 v168, v168, v40
v_mul_f32 v169, v169, v41
s_waitcnt lgkmcnt(5)
v_mfma_f32_32x32x16_bf16 v[128:143], v[76:79], a[24:27], v[128:143]
ds_read_b64_tr_b16 v[84:85], v11 offset:10240
ds_read_b64_tr_b16 v[86:87], v11 offset:11264
v_mul_f32 v170, v170, v42
v_mul_f32 v171, v171, v43
v_cvt_pk_bf16_f32 v52, v168, v169
v_cvt_pk_bf16_f32 v53, v170, v171
v_mul_f32 v44, 0xbfb8aa3b, v172
v_mfma_f32_32x32x16_bf16 v[144:159], v[76:79], a[28:31], v[144:159]
buffer_load_dwordx4 v7, s[16:19], s42 offen offset:1024 lds
ds_read_b128 a[52:55], v12 offset:13312
v_mul_f32 v45, 0xbfb8aa3b, v173
v_mul_f32 v46, 0xbfb8aa3b, v174
v_mul_f32 v47, 0xbfb8aa3b, v175
v_exp_f32 v44, v44
v_exp_f32 v45, v45
v_exp_f32 v46, v46
s_waitcnt lgkmcnt(4)
v_mfma_f32_32x32x16_bf16 v[96:111], v[80:83], a[32:35], v[96:111]
s_waitcnt vmcnt(14)
ds_read_b64_tr_b16 v[72:73], v10 offset:12288
ds_read_b64_tr_b16 v[74:75], v10 offset:13312
v_exp_f32 v47, v47
v_fma_f32 v44, v44, v3, v3
v_fma_f32 v45, v45, v3, v3
v_fma_f32 v46, v46, v3, v3
v_fma_f32 v47, v47, v3, v3
v_rcp_f32 v44, v44
v_mfma_f32_32x32x16_bf16 v[112:127], v[80:83], a[36:39], v[112:127]
s_add_u32 m0, s41, 8192
s_add_u32 s42, s42, 18432
buffer_load_dwordx4 v6, s[16:19], s42 offen lds
ds_read_b128 a[56:59], v12 offset:14336
v_rcp_f32 v45, v45
v_rcp_f32 v46, v46
v_rcp_f32 v47, v47
v_mul_f32 v172, v172, v44
v_mul_f32 v173, v173, v45
s_waitcnt lgkmcnt(4)
v_mfma_f32_32x32x16_bf16 v[128:143], v[84:87], a[32:35], v[128:143]
ds_read_b64_tr_b16 v[76:77], v11 offset:12288
ds_read_b64_tr_b16 v[78:79], v11 offset:13312
v_mul_f32 v174, v174, v46
v_mul_f32 v175, v175, v47
v_cvt_pk_bf16_f32 v54, v172, v173
v_cvt_pk_bf16_f32 v55, v174, v175
ds_write_b128 v14, v[52:55] offset:34816
v_mul_f32 v40, 0xbfb8aa3b, v176
v_mfma_f32_32x32x16_bf16 v[144:159], v[84:87], a[36:39], v[144:159]
buffer_load_dwordx4 v7, s[16:19], s42 offen offset:1024 lds
ds_read_b128 a[60:63], v12 offset:15360
v_mul_f32 v41, 0xbfb8aa3b, v177
v_mul_f32 v42, 0xbfb8aa3b, v178
v_mul_f32 v43, 0xbfb8aa3b, v179
v_exp_f32 v40, v40
v_exp_f32 v41, v41
v_exp_f32 v42, v42
s_waitcnt lgkmcnt(5)
v_mfma_f32_32x32x16_bf16 v[96:111], v[72:75], a[40:43], v[96:111]
s_waitcnt vmcnt(14)
ds_read_b64_tr_b16 v[80:81], v10 offset:14336
ds_read_b64_tr_b16 v[82:83], v10 offset:15360
v_exp_f32 v43, v43
v_fma_f32 v40, v40, v31, v31
v_fma_f32 v41, v41, v31, v31
v_fma_f32 v42, v42, v31, v31
v_fma_f32 v43, v43, v31, v31
v_mfma_f32_32x32x16_bf16 v[112:127], v[72:75], a[44:47], v[112:127]
s_add_u32 m0, s41, 10240
s_add_u32 s42, s42, 18432
buffer_load_dwordx4 v6, s[16:19], s42 offen lds
ds_read_b128 a[64:67], v12 offset:16384
v_rcp_f32 v40, v40
v_rcp_f32 v41, v41
v_rcp_f32 v42, v42
v_rcp_f32 v43, v43
v_mul_f32 v176, v176, v40
v_mul_f32 v177, v177, v41
s_waitcnt lgkmcnt(5)
v_mfma_f32_32x32x16_bf16 v[128:143], v[76:79], a[40:43], v[128:143]
ds_read_b64_tr_b16 v[84:85], v11 offset:14336
ds_read_b64_tr_b16 v[86:87], v11 offset:15360
v_mul_f32 v178, v178, v42
v_mul_f32 v179, v179, v43
v_cvt_pk_bf16_f32 v56, v176, v177
v_cvt_pk_bf16_f32 v57, v178, v179
v_mul_f32 v44, 0xbfb8aa3b, v180
v_mul_f32 v45, 0xbfb8aa3b, v181
v_mfma_f32_32x32x16_bf16 v[144:159], v[76:79], a[44:47], v[144:159]
buffer_load_dwordx4 v7, s[16:19], s42 offen offset:1024 lds
ds_read_b128 a[68:71], v12 offset:17408
v_mul_f32 v46, 0xbfb8aa3b, v182
v_mul_f32 v47, 0xbfb8aa3b, v183
v_exp_f32 v44, v44
v_exp_f32 v45, v45
v_exp_f32 v46, v46
s_waitcnt lgkmcnt(4)
v_mfma_f32_32x32x16_bf16 v[96:111], v[80:83], a[48:51], v[96:111]
s_waitcnt vmcnt(14)
ds_read_b64_tr_b16 v[72:73], v10 offset:16384
ds_read_b64_tr_b16 v[74:75], v10 offset:17408
v_exp_f32 v47, v47
v_fma_f32 v44, v44, v31, v31
v_fma_f32 v45, v45, v31, v31
v_fma_f32 v46, v46, v31, v31
v_fma_f32 v47, v47, v31, v31
v_rcp_f32 v44, v44
v_mfma_f32_32x32x16_bf16 v[112:127], v[80:83], a[52:55], v[112:127]
s_add_u32 m0, s41, 12288
s_add_u32 s42, s42, 18432
buffer_load_dwordx4 v6, s[16:19], s42 offen lds
ds_read_b128 a[72:75], v12 offset:18432
v_rcp_f32 v45, v45
v_rcp_f32 v46, v46
v_rcp_f32 v47, v47
v_mul_f32 v180, v180, v44
v_mul_f32 v181, v181, v45
v_mul_f32 v182, v182, v46
s_waitcnt lgkmcnt(4)
v_mfma_f32_32x32x16_bf16 v[128:143], v[84:87], a[48:51], v[128:143]
ds_read_b64_tr_b16 v[76:77], v11 offset:16384
ds_read_b64_tr_b16 v[78:79], v11 offset:17408
v_mul_f32 v183, v183, v47
v_cvt_pk_bf16_f32 v58, v180, v181
v_cvt_pk_bf16_f32 v59, v182, v183
ds_write_b128 v14, v[56:59] offset:33792
v_mul_f32 v40, 0xbfb8aa3b, v184
v_mfma_f32_32x32x16_bf16 v[144:159], v[84:87], a[52:55], v[144:159]
buffer_load_dwordx4 v7, s[16:19], s42 offen offset:1024 lds
ds_read_b128 a[76:79], v12 offset:19456
v_mul_f32 v41, 0xbfb8aa3b, v185
v_mul_f32 v42, 0xbfb8aa3b, v186
v_mul_f32 v43, 0xbfb8aa3b, v187
v_exp_f32 v40, v40
v_exp_f32 v41, v41
v_exp_f32 v42, v42
s_waitcnt lgkmcnt(5)
v_mfma_f32_32x32x16_bf16 v[96:111], v[72:75], a[56:59], v[96:111]
s_waitcnt vmcnt(14)
ds_read_b64_tr_b16 v[80:81], v10 offset:18432
ds_read_b64_tr_b16 v[82:83], v10 offset:19456
v_exp_f32 v43, v43
v_fma_f32 v40, v40, v31, v31
v_fma_f32 v41, v41, v31, v31
v_fma_f32 v42, v42, v31, v31
v_fma_f32 v43, v43, v31, v31
v_rcp_f32 v40, v40
v_mfma_f32_32x32x16_bf16 v[112:127], v[72:75], a[60:63], v[112:127]
s_add_u32 m0, s41, 14336
s_add_u32 s42, s58, s66
buffer_load_dwordx4 v6, s[16:19], s42 offen lds
ds_read_b128 a[80:83], v12 offset:20480
v_rcp_f32 v41, v41
v_rcp_f32 v42, v42
v_rcp_f32 v43, v43
v_mul_f32 v184, v184, v40
v_mul_f32 v185, v185, v41
s_waitcnt lgkmcnt(5)
v_mfma_f32_32x32x16_bf16 v[128:143], v[76:79], a[56:59], v[128:143]
ds_read_b64_tr_b16 v[84:85], v11 offset:18432
ds_read_b64_tr_b16 v[86:87], v11 offset:19456
v_mul_f32 v186, v186, v42
v_mul_f32 v187, v187, v43
v_cvt_pk_bf16_f32 v60, v184, v185
v_cvt_pk_bf16_f32 v61, v186, v187
v_mul_f32 v44, 0xbfb8aa3b, v188
v_mul_f32 v45, 0xbfb8aa3b, v189
v_mfma_f32_32x32x16_bf16 v[144:159], v[76:79], a[60:63], v[144:159]
buffer_load_dwordx4 v7, s[16:19], s42 offen offset:1024 lds
ds_read_b128 a[84:87], v12 offset:21504
v_mul_f32 v46, 0xbfb8aa3b, v190
v_mul_f32 v47, 0xbfb8aa3b, v191
v_exp_f32 v44, v44
v_exp_f32 v45, v45
v_exp_f32 v46, v46
v_exp_f32 v47, v47
s_waitcnt lgkmcnt(4)
v_mfma_f32_32x32x16_bf16 v[96:111], v[80:83], a[64:67], v[96:111]
s_waitcnt vmcnt(14)
ds_read_b64_tr_b16 v[72:73], v10 offset:0
ds_read_b64_tr_b16 v[74:75], v10 offset:1024
v_fma_f32 v44, v44, v31, v31
v_fma_f32 v45, v45, v31, v31
v_fma_f32 v46, v46, v31, v31
v_fma_f32 v47, v47, v31, v31
v_rcp_f32 v44, v44
v_mfma_f32_32x32x16_bf16 v[112:127], v[80:83], a[68:71], v[112:127]
s_add_u32 m0, s41, 16384
s_add_u32 s42, s42, 18432
buffer_load_dwordx4 v6, s[16:19], s42 offen lds
ds_read_b128 a[88:91], v12 offset:22528
v_rcp_f32 v45, v45
v_rcp_f32 v46, v46
v_rcp_f32 v47, v47
v_mul_f32 v188, v188, v44
v_mul_f32 v189, v189, v45
v_mul_f32 v190, v190, v46
s_waitcnt lgkmcnt(4)
v_mfma_f32_32x32x16_bf16 v[128:143], v[84:87], a[64:67], v[128:143]
ds_read_b64_tr_b16 v[76:77], v11 offset:0
ds_read_b64_tr_b16 v[78:79], v11 offset:1024
v_mul_f32 v191, v191, v47
v_cvt_pk_bf16_f32 v62, v188, v189
v_cvt_pk_bf16_f32 v63, v190, v191
ds_write_b128 v14, v[60:63] offset:35840
v_mfma_f32_32x32x16_bf16 v[144:159], v[84:87], a[68:71], v[144:159]
buffer_load_dwordx4 v7, s[16:19], s42 offen offset:1024 lds
ds_read_b128 a[92:95], v12 offset:23552
v_mul_f32 v40, 0xbfb8aa3b, v192
v_mul_f32 v41, 0xbfb8aa3b, v193
v_mul_f32 v42, 0xbfb8aa3b, v194
v_mul_f32 v43, 0xbfb8aa3b, v195
v_exp_f32 v40, v40
v_exp_f32 v41, v41
s_waitcnt lgkmcnt(5)
v_mfma_f32_32x32x16_bf16 v[96:111], v[72:75], a[72:75], v[96:111]
s_waitcnt vmcnt(14)
ds_read_b64_tr_b16 v[80:81], v10 offset:2048
ds_read_b64_tr_b16 v[82:83], v10 offset:3072
v_exp_f32 v42, v42
v_exp_f32 v43, v43
v_fma_f32 v40, v40, v3, v3
v_fma_f32 v41, v41, v3, v3
v_fma_f32 v42, v42, v3, v3
v_fma_f32 v43, v43, v3, v3
v_min_u32 v66, 32, v1
v_lshlrev_b32 v66, 2, v66
v_mfma_f32_32x32x16_bf16 v[112:127], v[72:75], a[76:79], v[112:127]
s_add_u32 m0, s41, 18432
s_add_u32 s42, s42, 18432
buffer_load_dwordx4 v6, s[16:19], s42 offen lds
ds_read_b128 a[96:99], v12 offset:24576
v_rcp_f32 v40, v40
v_rcp_f32 v41, v41
v_rcp_f32 v42, v42
v_rcp_f32 v43, v43
v_mul_f32 v192, v192, v40
s_lshr_b32 s24, s38, 1
s_lshl_b32 s3, s36, 1
s_waitcnt lgkmcnt(5)
v_mfma_f32_32x32x16_bf16 v[128:143], v[76:79], a[72:75], v[128:143]
ds_read_b64_tr_b16 v[84:85], v11 offset:2048
ds_read_b64_tr_b16 v[86:87], v11 offset:3072
v_mul_f32 v193, v193, v41
v_mul_f32 v194, v194, v42
v_mul_f32 v195, v195, v43
v_cvt_pk_bf16_f32 v48, v192, v193
v_cvt_pk_bf16_f32 v49, v194, v195
v_mul_f32 v44, 0xbfb8aa3b, v196
s_add_u32 s24, s24, s3
s_add_u32 s25, s36, 12
v_mfma_f32_32x32x16_bf16 v[144:159], v[76:79], a[76:79], v[144:159]
buffer_load_dwordx4 v7, s[16:19], s42 offen offset:1024 lds
ds_read_b128 a[100:103], v12 offset:25600
v_mul_f32 v45, 0xbfb8aa3b, v197
v_mul_f32 v46, 0xbfb8aa3b, v198
v_mul_f32 v47, 0xbfb8aa3b, v199
v_exp_f32 v44, v44
v_exp_f32 v45, v45
v_exp_f32 v46, v46
s_and_b32 s3, s36, 6
s_cmp_eq_u32 s3, 4
s_cselect_b32 s25, s25, s24
s_cselect_b32 s26, 1, 0
s_waitcnt lgkmcnt(4)
v_mfma_f32_32x32x16_bf16 v[96:111], v[80:83], a[80:83], v[96:111]
s_waitcnt vmcnt(14)
ds_read_b64_tr_b16 v[72:73], v10 offset:4096
ds_read_b64_tr_b16 v[74:75], v10 offset:5120
v_exp_f32 v47, v47
v_fma_f32 v44, v44, v3, v3
v_fma_f32 v45, v45, v3, v3
v_fma_f32 v46, v46, v3, v3
v_fma_f32 v47, v47, v3, v3
s_mul_i32 s22, s24, 4352
s_add_u32 s22, s22, 25247744
v_mfma_f32_32x32x16_bf16 v[112:127], v[80:83], a[84:87], v[112:127]
s_add_u32 m0, s41, 0
s_add_u32 s42, s42, 18432
buffer_load_dwordx4 v6, s[16:19], s42 offen lds
ds_read_b128 a[104:107], v12 offset:26624
v_rcp_f32 v44, v44
v_rcp_f32 v45, v45
v_rcp_f32 v46, v46
v_rcp_f32 v47, v47
v_mul_f32 v196, v196, v44
v_mul_f32 v197, v197, v45
s_mul_i32 s23, s25, 4352
s_add_u32 s23, s23, 25247744
s_waitcnt lgkmcnt(4)
v_mfma_f32_32x32x16_bf16 v[128:143], v[84:87], a[80:83], v[128:143]
ds_read_b64_tr_b16 v[76:77], v11 offset:4096
ds_read_b64_tr_b16 v[78:79], v11 offset:5120
v_mul_f32 v198, v198, v46
v_mul_f32 v199, v199, v47
v_cvt_pk_bf16_f32 v50, v196, v197
v_cvt_pk_bf16_f32 v51, v198, v199
ds_write_b128 v14, v[48:51] offset:36864
v_mul_f32 v40, 0xbfb8aa3b, v200
v_mov_b32 v69, 1
s_cmp_eq_u32 s26, 1
s_cbranch_scc0 Lsk_pe_18
buffer_load_dword v69, v66, s[4:7], s23 offen sc1
Lsk_pe_18:
v_mfma_f32_32x32x16_bf16 v[144:159], v[84:87], a[84:87], v[144:159]
buffer_load_dwordx4 v7, s[16:19], s42 offen offset:1024 lds
ds_read_b128 a[108:111], v12 offset:27648
v_mul_f32 v41, 0xbfb8aa3b, v201
v_mul_f32 v42, 0xbfb8aa3b, v202
v_mul_f32 v43, 0xbfb8aa3b, v203
v_exp_f32 v40, v40
v_exp_f32 v41, v41
buffer_load_dword v68, v66, s[4:7], s22 offen sc1
s_waitcnt lgkmcnt(5)
v_mfma_f32_32x32x16_bf16 v[96:111], v[72:75], a[88:91], v[96:111]
s_waitcnt vmcnt(15)
ds_read_b64_tr_b16 v[80:81], v10 offset:6144
ds_read_b64_tr_b16 v[82:83], v10 offset:7168
v_exp_f32 v42, v42
v_exp_f32 v43, v43
v_fma_f32 v40, v40, v3, v3
v_fma_f32 v41, v41, v3, v3
v_fma_f32 v42, v42, v3, v3
v_fma_f32 v43, v43, v3, v3
v_mfma_f32_32x32x16_bf16 v[112:127], v[72:75], a[92:95], v[112:127]
s_add_u32 m0, s41, 2048
s_add_u32 s42, s59, s66
buffer_load_dwordx4 v6, s[16:19], s42 offen lds
ds_read_b128 a[112:115], v12 offset:28672
v_rcp_f32 v40, v40
v_rcp_f32 v41, v41
v_rcp_f32 v42, v42
v_rcp_f32 v43, v43
v_mul_f32 v200, v200, v40
v_mul_f32 v201, v201, v41
s_waitcnt lgkmcnt(5)
v_mfma_f32_32x32x16_bf16 v[128:143], v[76:79], a[88:91], v[128:143]
ds_read_b64_tr_b16 v[84:85], v11 offset:6144
ds_read_b64_tr_b16 v[86:87], v11 offset:7168
v_mul_f32 v202, v202, v42
v_mul_f32 v203, v203, v43
v_cvt_pk_bf16_f32 v52, v200, v201
v_cvt_pk_bf16_f32 v53, v202, v203
v_mul_f32 v44, 0xbfb8aa3b, v204
v_mfma_f32_32x32x16_bf16 v[144:159], v[76:79], a[92:95], v[144:159]
buffer_load_dwordx4 v7, s[16:19], s42 offen offset:1024 lds
ds_read_b128 a[116:119], v12 offset:29696
v_mul_f32 v45, 0xbfb8aa3b, v205
v_mul_f32 v46, 0xbfb8aa3b, v206
v_mul_f32 v47, 0xbfb8aa3b, v207
v_exp_f32 v44, v44
v_exp_f32 v45, v45
v_exp_f32 v46, v46
s_waitcnt lgkmcnt(4)
v_mfma_f32_32x32x16_bf16 v[96:111], v[80:83], a[96:99], v[96:111]
s_waitcnt vmcnt(15)
ds_read_b64_tr_b16 v[72:73], v10 offset:8192
ds_read_b64_tr_b16 v[74:75], v10 offset:9216
v_exp_f32 v47, v47
v_fma_f32 v44, v44, v3, v3
v_fma_f32 v45, v45, v3, v3
v_fma_f32 v46, v46, v3, v3
v_fma_f32 v47, v47, v3, v3
v_rcp_f32 v44, v44
v_mfma_f32_32x32x16_bf16 v[112:127], v[80:83], a[100:103], v[112:127]
s_add_u32 m0, s41, 4096
s_add_u32 s42, s42, 18432
buffer_load_dwordx4 v6, s[16:19], s42 offen lds
ds_read_b128 a[120:123], v12 offset:30720
v_rcp_f32 v45, v45
v_rcp_f32 v46, v46
v_rcp_f32 v47, v47
v_mul_f32 v204, v204, v44
v_mul_f32 v205, v205, v45
s_waitcnt lgkmcnt(4)
v_mfma_f32_32x32x16_bf16 v[128:143], v[84:87], a[96:99], v[128:143]
ds_read_b64_tr_b16 v[76:77], v11 offset:8192
ds_read_b64_tr_b16 v[78:79], v11 offset:9216
v_mul_f32 v206, v206, v46
v_mul_f32 v207, v207, v47
v_cvt_pk_bf16_f32 v54, v204, v205
v_cvt_pk_bf16_f32 v55, v206, v207
ds_write_b128 v14, v[52:55] offset:38912
v_mfma_f32_32x32x16_bf16 v[144:159], v[84:87], a[100:103], v[144:159]
buffer_load_dwordx4 v7, s[16:19], s42 offen offset:1024 lds
ds_read_b128 a[124:127], v12 offset:31744
v_mul_f32 v40, 0xbfb8aa3b, v208
v_mul_f32 v41, 0xbfb8aa3b, v209
v_mul_f32 v42, 0xbfb8aa3b, v210
v_mul_f32 v43, 0xbfb8aa3b, v211
v_exp_f32 v40, v40
v_exp_f32 v41, v41
s_waitcnt lgkmcnt(5)
v_mfma_f32_32x32x16_bf16 v[96:111], v[72:75], a[104:107], v[96:111]
s_waitcnt vmcnt(15)
ds_read_b64_tr_b16 v[80:81], v10 offset:10240
ds_read_b64_tr_b16 v[82:83], v10 offset:11264
v_exp_f32 v42, v42
v_exp_f32 v43, v43
v_fma_f32 v40, v40, v31, v31
v_fma_f32 v41, v41, v31, v31
v_fma_f32 v42, v42, v31, v31
v_mfma_f32_32x32x16_bf16 v[112:127], v[72:75], a[108:111], v[112:127]
s_add_u32 m0, s41, 6144
s_add_u32 s42, s42, 18432
buffer_load_dwordx4 v6, s[16:19], s42 offen lds
ds_read_b128 a[128:131], v13 offset:0
v_fma_f32 v43, v43, v31, v31
v_rcp_f32 v40, v40
v_rcp_f32 v41, v41
v_rcp_f32 v42, v42
v_rcp_f32 v43, v43
v_mul_f32 v208, v208, v40
s_waitcnt lgkmcnt(5)
v_mfma_f32_32x32x16_bf16 v[128:143], v[76:79], a[104:107], v[128:143]
ds_read_b64_tr_b16 v[84:85], v11 offset:10240
ds_read_b64_tr_b16 v[86:87], v11 offset:11264
v_mul_f32 v209, v209, v41
v_mul_f32 v210, v210, v42
v_mul_f32 v211, v211, v43
v_cvt_pk_bf16_f32 v56, v208, v209
v_cvt_pk_bf16_f32 v57, v210, v211
v_mul_f32 v44, 0xbfb8aa3b, v212
v_mfma_f32_32x32x16_bf16 v[144:159], v[76:79], a[108:111], v[144:159]
buffer_load_dwordx4 v7, s[16:19], s42 offen offset:1024 lds
ds_read_b128 a[132:135], v13 offset:1024
v_mul_f32 v45, 0xbfb8aa3b, v213
v_mul_f32 v46, 0xbfb8aa3b, v214
v_mul_f32 v47, 0xbfb8aa3b, v215
v_exp_f32 v44, v44
v_exp_f32 v45, v45
s_waitcnt lgkmcnt(4)
v_mfma_f32_32x32x16_bf16 v[96:111], v[80:83], a[112:115], v[96:111]
s_waitcnt vmcnt(15)
ds_read_b64_tr_b16 v[72:73], v10 offset:12288
ds_read_b64_tr_b16 v[74:75], v10 offset:13312
v_exp_f32 v46, v46
v_exp_f32 v47, v47
v_fma_f32 v44, v44, v31, v31
v_fma_f32 v45, v45, v31, v31
v_fma_f32 v46, v46, v31, v31
v_fma_f32 v47, v47, v31, v31
v_mfma_f32_32x32x16_bf16 v[112:127], v[80:83], a[116:119], v[112:127]
s_add_u32 m0, s41, 8192
s_add_u32 s42, s42, 18432
buffer_load_dwordx4 v6, s[16:19], s42 offen lds
ds_read_b128 a[136:139], v13 offset:2048
v_rcp_f32 v44, v44
v_rcp_f32 v45, v45
v_rcp_f32 v46, v46
v_rcp_f32 v47, v47
v_mul_f32 v212, v212, v44
v_mul_f32 v213, v213, v45
s_waitcnt lgkmcnt(4)
v_mfma_f32_32x32x16_bf16 v[128:143], v[84:87], a[112:115], v[128:143]
ds_read_b64_tr_b16 v[76:77], v11 offset:12288
ds_read_b64_tr_b16 v[78:79], v11 offset:13312
v_mul_f32 v214, v214, v46
v_mul_f32 v215, v215, v47
v_cvt_pk_bf16_f32 v58, v212, v213
v_cvt_pk_bf16_f32 v59, v214, v215
ds_write_b128 v14, v[56:59] offset:37888
v_mfma_f32_32x32x16_bf16 v[144:159], v[84:87], a[116:119], v[144:159]
buffer_load_dwordx4 v7, s[16:19], s42 offen offset:1024 lds
ds_read_b128 a[140:143], v13 offset:3072
v_mul_f32 v40, 0xbfb8aa3b, v216
v_mul_f32 v41, 0xbfb8aa3b, v217
v_mul_f32 v42, 0xbfb8aa3b, v218
v_mul_f32 v43, 0xbfb8aa3b, v219
v_exp_f32 v40, v40
v_exp_f32 v41, v41
s_waitcnt lgkmcnt(5)
v_mfma_f32_32x32x16_bf16 v[96:111], v[72:75], a[120:123], v[96:111]
s_waitcnt vmcnt(15)
ds_read_b64_tr_b16 v[80:81], v10 offset:14336
ds_read_b64_tr_b16 v[82:83], v10 offset:15360
v_exp_f32 v42, v42
v_exp_f32 v43, v43
v_fma_f32 v40, v40, v31, v31
v_fma_f32 v41, v41, v31, v31
v_fma_f32 v42, v42, v31, v31
v_fma_f32 v43, v43, v31, v31
v_mfma_f32_32x32x16_bf16 v[112:127], v[72:75], a[124:127], v[112:127]
s_add_u32 m0, s41, 10240
s_add_u32 s42, s60, s66
buffer_load_dwordx4 v6, s[16:19], s42 offen lds
ds_read_b128 a[144:147], v13 offset:4096
v_rcp_f32 v40, v40
v_rcp_f32 v41, v41
v_rcp_f32 v42, v42
v_rcp_f32 v43, v43
v_mul_f32 v216, v216, v40
s_waitcnt lgkmcnt(5)
v_mfma_f32_32x32x16_bf16 v[128:143], v[76:79], a[120:123], v[128:143]
ds_read_b64_tr_b16 v[84:85], v11 offset:14336
ds_read_b64_tr_b16 v[86:87], v11 offset:15360
v_mul_f32 v217, v217, v41
v_mul_f32 v218, v218, v42
v_mul_f32 v219, v219, v43
v_cvt_pk_bf16_f32 v60, v216, v217
v_cvt_pk_bf16_f32 v61, v218, v219
v_mul_f32 v44, 0xbfb8aa3b, v220
v_mfma_f32_32x32x16_bf16 v[144:159], v[76:79], a[124:127], v[144:159]
buffer_load_dwordx4 v7, s[16:19], s42 offen offset:1024 lds
ds_read_b128 a[148:151], v13 offset:5120
v_mul_f32 v45, 0xbfb8aa3b, v221
v_mul_f32 v46, 0xbfb8aa3b, v222
v_mul_f32 v47, 0xbfb8aa3b, v223
v_exp_f32 v44, v44
v_exp_f32 v45, v45
v_exp_f32 v46, v46
s_waitcnt lgkmcnt(4)
v_mfma_f32_32x32x16_bf16 v[96:111], v[80:83], a[128:131], v[96:111]
s_waitcnt vmcnt(15)
ds_read_b64_tr_b16 v[72:73], v10 offset:16384
ds_read_b64_tr_b16 v[74:75], v10 offset:17408
v_exp_f32 v47, v47
v_fma_f32 v44, v44, v31, v31
v_fma_f32 v45, v45, v31, v31
v_fma_f32 v46, v46, v31, v31
v_fma_f32 v47, v47, v31, v31
s_waitcnt vmcnt(10)
v_cmp_eq_u32 vcc, 0, v68
v_cmp_eq_u32 s[28:29], 0, v69
s_or_b64 vcc, vcc, s[28:29]
s_cbranch_scc1 Lsp_E
Lbk_E:
s_mul_i32 s3, s37, 18
s_add_u32 s22, s24, s3
s_lshl_b32 s22, s22, 12
v_mfma_f32_32x32x16_bf16 v[112:127], v[80:83], a[132:135], v[112:127]
s_add_u32 m0, s41, 12288
s_add_u32 s42, s42, 18432
buffer_load_dwordx4 v6, s[16:19], s42 offen lds
ds_read_b128 a[152:155], v13 offset:6144
v_rcp_f32 v44, v44
v_rcp_f32 v45, v45
v_rcp_f32 v46, v46
v_rcp_f32 v47, v47
v_mul_f32 v220, v220, v44
v_mul_f32 v221, v221, v45
s_add_u32 s22, s22, 21495808
s_add_u32 s23, s25, s3
s_lshl_b32 s23, s23, 12
s_waitcnt lgkmcnt(4)
v_mfma_f32_32x32x16_bf16 v[128:143], v[84:87], a[128:131], v[128:143]
ds_read_b64_tr_b16 v[76:77], v11 offset:16384
ds_read_b64_tr_b16 v[78:79], v11 offset:17408
v_mul_f32 v222, v222, v46
v_mul_f32 v223, v223, v47
v_cvt_pk_bf16_f32 v62, v220, v221
v_cvt_pk_bf16_f32 v63, v222, v223
ds_write_b128 v14, v[60:63] offset:39936
s_add_u32 s23, s23, 21495808
s_lshl_b32 s27, s38, 12
s_add_u32 s27, s27, 12288
v_mfma_f32_32x32x16_bf16 v[144:159], v[84:87], a[132:135], v[144:159]
buffer_load_dwordx4 v7, s[16:19], s42 offen offset:1024 lds
ds_read_b128 a[156:159], v13 offset:7168
s_and_b32 s28, s38, 1
s_lshl_b32 s28, s28, 12
s_add_u32 s28, s28, 28672
s_waitcnt lgkmcnt(5)
v_mfma_f32_32x32x16_bf16 v[96:111], v[72:75], a[136:139], v[96:111]
ds_read_b64_tr_b16 v[80:81], v10 offset:18432
ds_read_b64_tr_b16 v[82:83], v10 offset:19456
v_mfma_f32_32x32x16_bf16 v[112:127], v[72:75], a[140:143], v[112:127]
s_add_u32 m0, s41, 14336
s_add_u32 s42, s42, 18432
buffer_load_dwordx4 v6, s[16:19], s42 offen lds
s_waitcnt lgkmcnt(3)
s_barrier
ds_read_b128 a[160:163], v13 offset:8192
v_mfma_f32_32x32x16_bf16 v[128:143], v[76:79], a[136:139], v[128:143]
ds_read_b64_tr_b16 v[84:85], v11 offset:18432
ds_read_b64_tr_b16 v[86:87], v11 offset:19456
v_mfma_f32_32x32x16_bf16 v[144:159], v[76:79], a[140:143], v[144:159]
buffer_load_dwordx4 v7, s[16:19], s42 offen offset:1024 lds
ds_read_b128 a[164:167], v13 offset:9216
s_mov_b32 m0, s27
s_nop 0
buffer_load_dwordx4 v12, s[4:7], s22 offen offset:0 sc1 lds
buffer_load_dwordx4 v12, s[4:7], s22 offen offset:1024 sc1 lds
buffer_load_dwordx4 v12, s[4:7], s22 offen offset:2048 sc1 lds
buffer_load_dwordx4 v12, s[4:7], s22 offen offset:3072 sc1 lds
s_cmp_eq_u32 s26, 1
s_cbranch_scc0 Lsk_ex_19
s_mov_b32 m0, s28
s_nop 0
buffer_load_dwordx4 v12, s[4:7], s23 offen offset:0 sc1 lds
buffer_load_dwordx4 v12, s[4:7], s23 offen offset:1024 sc1 lds
buffer_load_dwordx4 v12, s[4:7], s23 offen offset:2048 sc1 lds
buffer_load_dwordx4 v12, s[4:7], s23 offen offset:3072 sc1 lds
Lsk_ex_19:
buffer_load_dword v69, v12, s[4:7], 0 offen
s_waitcnt lgkmcnt(4)
v_mfma_f32_32x32x16_bf16 v[96:111], v[80:83], a[144:147], v[96:111]
ds_read_b64_tr_b16 v[72:73], v10 offset:0
ds_read_b64_tr_b16 v[74:75], v10 offset:1024
v_mfma_f32_32x32x16_bf16 v[112:127], v[80:83], a[148:151], v[112:127]
s_add_u32 m0, s41, 16384
s_add_u32 s42, s42, 18432
buffer_load_dwordx4 v6, s[16:19], s42 offen lds
ds_read_b128 a[168:171], v13 offset:10240
s_waitcnt lgkmcnt(4)
v_mfma_f32_32x32x16_bf16 v[128:143], v[84:87], a[144:147], v[128:143]
ds_read_b64_tr_b16 v[76:77], v11 offset:0
ds_read_b64_tr_b16 v[78:79], v11 offset:1024
v_and_b32 v64, 31, v1
s_and_b32 s3, s38, 1
s_lshl_b32 s3, s3, 5
v_add_u32 v64, s3, v64
v_mfma_f32_32x32x16_bf16 v[144:159], v[84:87], a[148:151], v[144:159]
buffer_load_dwordx4 v7, s[16:19], s42 offen offset:1024 lds
ds_read_b128 a[172:175], v13 offset:11264
v_lshlrev_b32 v65, 2, v64
v_add_u32 v65, 163072, v65
ds_read_b32 v62, v65
v_lshlrev_b32 v64, 5, v64
s_waitcnt lgkmcnt(5)
v_mfma_f32_32x32x16_bf16 v[96:111], v[72:75], a[152:155], v[96:111]
s_waitcnt vmcnt(19)
ds_read_b64_tr_b16 v[80:81], v10 offset:2048
ds_read_b64_tr_b16 v[82:83], v10 offset:3072
v_add_u32 v64, s37, v64
v_cvt_f32_u32 v64, v64
v_mul_f32 v64, 0x3a000000, v64
v_mul_f32 v65, 0x41800000, v23
v_mfma_f32_32x32x16_bf16 v[112:127], v[72:75], a[156:159], v[112:127]
s_add_u32 m0, s41, 18432
s_add_u32 s42, s61, s66
buffer_load_dwordx4 v6, s[16:19], s42 offen lds
ds_read_b128 a[176:179], v13 offset:12288
v_mul_f32 v65, v65, v64
v_fmamk_f32 v56, v64, 0x00000000, v65
v_fmamk_f32 v57, v64, 0x3f800000, v65
v_cos_f32 v58, v56
s_waitcnt lgkmcnt(5)
v_mfma_f32_32x32x16_bf16 v[128:143], v[76:79], a[152:155], v[128:143]
ds_read_b64_tr_b16 v[84:85], v11 offset:2048
ds_read_b64_tr_b16 v[86:87], v11 offset:3072
v_sin_f32 v59, -v56
v_cos_f32 v60, v57
v_sin_f32 v61, -v57
v_cvt_pk_bf16_f32 v40, v58, v59
v_mfma_f32_32x32x16_bf16 v[144:159], v[76:79], a[156:159], v[144:159]
buffer_load_dwordx4 v7, s[16:19], s42 offen offset:1024 lds
ds_read_b128 a[180:183], v13 offset:13312
v_cvt_pk_bf16_f32 v41, v60, v61
v_fmamk_f32 v56, v64, 0x40000000, v65
v_fmamk_f32 v57, v64, 0x40400000, v65
v_cos_f32 v58, v56
s_waitcnt lgkmcnt(4)
v_mfma_f32_32x32x16_bf16 v[96:111], v[80:83], a[160:163], v[96:111]
s_waitcnt vmcnt(19)
ds_read_b64_tr_b16 v[72:73], v10 offset:4096
ds_read_b64_tr_b16 v[74:75], v10 offset:5120
v_sin_f32 v59, -v56
v_cos_f32 v60, v57
v_sin_f32 v61, -v57
v_cvt_pk_bf16_f32 v42, v58, v59
v_mfma_f32_32x32x16_bf16 v[112:127], v[80:83], a[164:167], v[112:127]
s_add_u32 m0, s41, 0
s_add_u32 s42, s42, 18432
buffer_load_dwordx4 v6, s[16:19], s42 offen lds
ds_read_b128 a[184:187], v13 offset:14336
v_cvt_pk_bf16_f32 v43, v60, v61
v_fmamk_f32 v56, v64, 0x41000000, v65
v_fmamk_f32 v57, v64, 0x41100000, v65
v_cos_f32 v58, v56
s_waitcnt lgkmcnt(4)
v_mfma_f32_32x32x16_bf16 v[128:143], v[84:87], a[160:163], v[128:143]
ds_read_b64_tr_b16 v[76:77], v11 offset:4096
ds_read_b64_tr_b16 v[78:79], v11 offset:5120
v_sin_f32 v59, -v56
v_cos_f32 v60, v57
v_sin_f32 v61, -v57
v_cvt_pk_bf16_f32 v44, v58, v59
v_mfma_f32_32x32x16_bf16 v[144:159], v[84:87], a[164:167], v[144:159]
buffer_load_dwordx4 v7, s[16:19], s42 offen offset:1024 lds
ds_read_b128 a[188:191], v13 offset:15360
v_cvt_pk_bf16_f32 v45, v60, v61
v_fmamk_f32 v56, v64, 0x41200000, v65
v_fmamk_f32 v57, v64, 0x41300000, v65
v_cos_f32 v58, v56
s_waitcnt lgkmcnt(4)
v_mfma_f32_32x32x16_bf16 v[96:111], v[72:75], a[168:171], v[96:111]
s_waitcnt vmcnt(19)
ds_read_b64_tr_b16 v[80:81], v10 offset:6144
ds_read_b64_tr_b16 v[82:83], v10 offset:7168
v_sin_f32 v59, -v56
v_cos_f32 v60, v57
v_sin_f32 v61, -v57
v_mfma_f32_32x32x16_bf16 v[112:127], v[72:75], a[172:175], v[112:127]
s_add_u32 m0, s41, 2048
s_add_u32 s42, s42, 18432
buffer_load_dwordx4 v6, s[16:19], s42 offen lds
ds_read_b128 a[192:195], v13 offset:16384
v_cvt_pk_bf16_f32 v46, v58, v59
v_cvt_pk_bf16_f32 v47, v60, v61
v_fmamk_f32 v56, v64, 0x41800000, v65
v_fmamk_f32 v57, v64, 0x41880000, v65
s_waitcnt lgkmcnt(4)
v_mfma_f32_32x32x16_bf16 v[128:143], v[76:79], a[168:171], v[128:143]
ds_read_b64_tr_b16 v[84:85], v11 offset:6144
ds_read_b64_tr_b16 v[86:87], v11 offset:7168
v_cos_f32 v58, v56
v_sin_f32 v59, -v56
v_cos_f32 v60, v57
v_sin_f32 v61, -v57
v_mfma_f32_32x32x16_bf16 v[144:159], v[76:79], a[172:175], v[144:159]
buffer_load_dwordx4 v7, s[16:19], s42 offen offset:1024 lds
ds_read_b128 a[196:199], v13 offset:17408
v_cvt_pk_bf16_f32 v48, v58, v59
v_cvt_pk_bf16_f32 v49, v60, v61
v_fmamk_f32 v56, v64, 0x41900000, v65
v_fmamk_f32 v57, v64, 0x41980000, v65
s_waitcnt lgkmcnt(4)
v_mfma_f32_32x32x16_bf16 v[96:111], v[80:83], a[176:179], v[96:111]
s_waitcnt vmcnt(19)
ds_read_b64_tr_b16 v[72:73], v10 offset:8192
ds_read_b64_tr_b16 v[74:75], v10 offset:9216
v_cos_f32 v58, v56
v_sin_f32 v59, -v56
v_cos_f32 v60, v57
v_sin_f32 v61, -v57
v_mfma_f32_32x32x16_bf16 v[112:127], v[80:83], a[180:183], v[112:127]
s_add_u32 m0, s41, 4096
s_add_u32 s42, s42, 18432
buffer_load_dwordx4 v6, s[16:19], s42 offen lds
ds_read_b128 a[200:203], v13 offset:18432
v_cvt_pk_bf16_f32 v50, v58, v59
v_cvt_pk_bf16_f32 v51, v60, v61
v_fmamk_f32 v56, v64, 0x41c00000, v65
v_fmamk_f32 v57, v64, 0x41c80000, v65
s_waitcnt lgkmcnt(4)
v_mfma_f32_32x32x16_bf16 v[128:143], v[84:87], a[176:179], v[128:143]
ds_read_b64_tr_b16 v[76:77], v11 offset:8192
ds_read_b64_tr_b16 v[78:79], v11 offset:9216
v_cos_f32 v58, v56
v_sin_f32 v59, -v56
v_cos_f32 v60, v57
v_sin_f32 v61, -v57
v_mfma_f32_32x32x16_bf16 v[144:159], v[84:87], a[180:183], v[144:159]
buffer_load_dwordx4 v7, s[16:19], s42 offen offset:1024 lds
ds_read_b128 a[204:207], v13 offset:19456
v_cvt_pk_bf16_f32 v52, v58, v59
v_cvt_pk_bf16_f32 v53, v60, v61
v_fmamk_f32 v56, v64, 0x41d00000, v65
v_fmamk_f32 v57, v64, 0x41d80000, v65
s_waitcnt lgkmcnt(4)
v_mfma_f32_32x32x16_bf16 v[96:111], v[72:75], a[184:187], v[96:111]
s_waitcnt vmcnt(19)
ds_read_b64_tr_b16 v[80:81], v10 offset:10240
ds_read_b64_tr_b16 v[82:83], v10 offset:11264
v_cos_f32 v58, v56
v_sin_f32 v59, -v56
v_cos_f32 v60, v57
v_sin_f32 v61, -v57
v_mfma_f32_32x32x16_bf16 v[112:127], v[72:75], a[188:191], v[112:127]
s_add_u32 m0, s41, 6144
s_add_u32 s42, s62, s66
buffer_load_dwordx4 v6, s[16:19], s42 offen lds
ds_read_b128 a[208:211], v13 offset:20480
v_cvt_pk_bf16_f32 v54, v58, v59
v_cvt_pk_bf16_f32 v55, v60, v61
v_lshlrev_b32 v56, 31, v1
v_or_b32 v56, 0x3f003f00, v56
v_cmp_gt_u32 vcc, 32, v1
s_nop 1
v_cndmask_b32 v40, v40, v56, vcc
v_lshrrev_b32 v63, 5, v1
s_waitcnt lgkmcnt(4)
v_mfma_f32_32x32x16_bf16 v[128:143], v[76:79], a[184:187], v[128:143]
ds_read_b64_tr_b16 v[84:85], v11 offset:10240
ds_read_b64_tr_b16 v[86:87], v11 offset:11264
v_lshlrev_b32 v63, 9, v63
v_bfe_u32 v56, v1, 2, 2
v_lshl_add_u32 v63, v56, 6, v63
v_bfe_u32 v56, v1, 4, 1
v_mfma_f32_32x32x16_bf16 v[144:159], v[76:79], a[188:191], v[144:159]
buffer_load_dwordx4 v7, s[16:19], s42 offen offset:1024 lds
ds_read_b128 a[212:215], v13 offset:21504
v_lshl_add_u32 v63, v56, 5, v63
v_and_b32 v56, 3, v1
v_lshl_add_u32 v63, v56, 3, v63
s_waitcnt lgkmcnt(4)
v_mfma_f32_32x32x16_bf16 v[96:111], v[80:83], a[192:195], v[96:111]
s_waitcnt vmcnt(19)
ds_read_b64_tr_b16 v[72:73], v10 offset:12288
ds_read_b64_tr_b16 v[74:75], v10 offset:13312
s_waitcnt vmcnt(12)
s_lshl_b32 s43, s36, 2
s_add_u32 s43, s43, s38
v_mfma_f32_32x32x16_bf16 v[112:127], v[80:83], a[196:199], v[112:127]
s_add_u32 m0, s41, 8192
s_add_u32 s42, s42, 18432
buffer_load_dwordx4 v6, s[16:19], s42 offen lds
ds_read_b128 a[216:219], v13 offset:22528
s_lshl_b32 s43, s43, 3
s_add_u32 s43, s43, 574
s_waitcnt lgkmcnt(4)
v_mfma_f32_32x32x16_bf16 v[128:143], v[84:87], a[192:195], v[128:143]
ds_read_b64_tr_b16 v[76:77], v11 offset:12288
ds_read_b64_tr_b16 v[78:79], v11 offset:13312
s_lshr_b32 s3, s97, 1
v_add_u32 v64, s3, v22
v_mfma_f32_32x32x16_bf16 v[144:159], v[84:87], a[196:199], v[144:159]
buffer_load_dwordx4 v7, s[16:19], s42 offen offset:1024 lds
ds_read_b128 a[220:223], v13 offset:23552
v_add_u32 v65, 32, v64
v_mul_u32_u24 v66, s43, v64
s_waitcnt lgkmcnt(4)
v_mfma_f32_32x32x16_bf16 v[96:111], v[72:75], a[200:203], v[96:111]
ds_read_b64_tr_b16 v[80:81], v10 offset:14336
ds_read_b64_tr_b16 v[82:83], v10 offset:15360
v_add_u32 v57, s27, v63
ds_read_b64_tr_b16 v[192:193], v57 offset:0
ds_read_b64_tr_b16 v[194:195], v57 offset:256
ds_read_b64_tr_b16 v[196:197], v57 offset:1024
ds_read_b64_tr_b16 v[198:199], v57 offset:1280
ds_read_b64_tr_b16 v[200:201], v57 offset:2048
v_mfma_f32_32x32x16_bf16 v[112:127], v[72:75], a[204:207], v[112:127]
s_add_u32 m0, s41, 10240
s_add_u32 s42, s42, 18432
buffer_load_dwordx4 v6, s[16:19], s42 offen lds
ds_read_b128 a[224:227], v13 offset:24576
ds_read_b64_tr_b16 v[202:203], v57 offset:2304
ds_read_b64_tr_b16 v[204:205], v57 offset:3072
ds_read_b64_tr_b16 v[206:207], v57 offset:3328
s_waitcnt lgkmcnt(7)
v_mfma_f32_32x32x16_bf16 v[176:191], v[192:195], v[40:43], 0
v_mfma_f32_32x32x16_bf16 v[128:143], v[76:79], a[200:203], v[128:143]
ds_read_b64_tr_b16 v[84:85], v11 offset:14336
ds_read_b64_tr_b16 v[86:87], v11 offset:15360
s_waitcnt lgkmcnt(7)
v_mfma_f32_32x32x16_bf16 v[176:191], v[196:199], v[44:47], v[176:191]
s_waitcnt lgkmcnt(4)
v_mfma_f32_32x32x16_bf16 v[176:191], v[200:203], v[48:51], v[176:191]
s_waitcnt lgkmcnt(2)
v_mfma_f32_32x32x16_bf16 v[176:191], v[204:207], v[52:55], v[176:191]
v_mfma_f32_32x32x16_bf16 v[144:159], v[76:79], a[204:207], v[144:159]
buffer_load_dwordx4 v7, s[16:19], s42 offen offset:1024 lds
ds_read_b128 a[228:231], v13 offset:25600
s_lshr_b32 s3, s38, 1
s_lshl_b32 s3, s3, 12
s_and_b32 s53, s38, 1
s_lshl_b32 s53, s53, 10
s_add_u32 s3, s3, s53
v_mfma_f32_32x32x16_bf16 v[96:111], v[80:83], a[208:211], v[96:111]
s_waitcnt vmcnt(14)
ds_read_b64_tr_b16 v[72:73], v10 offset:16384
ds_read_b64_tr_b16 v[74:75], v10 offset:17408
v_add_u32 v56, s3, v12
v_add_u32 v67, v66, v64
v_mul_hi_u32 v68, v66, s100
v_mul_hi_u32 v69, v67, s100
v_mul_hi_u32 v70, v64, s100
v_mul_u32_u24 v68, s101, v68
v_mfma_f32_32x32x16_bf16 v[112:127], v[80:83], a[212:215], v[112:127]
s_add_u32 m0, s41, 12288
s_add_u32 s42, s42, 18432
buffer_load_dwordx4 v6, s[16:19], s42 offen lds
ds_read_b128 a[232:235], v13 offset:26624
v_mul_u32_u24 v69, s101, v69
v_mul_u32_u24 v70, s101, v70
v_sub_u32 v68, v66, v68
v_sub_u32 v69, v67, v69
v_sub_u32 v70, v64, v70
s_waitcnt lgkmcnt(4)
v_mfma_f32_32x32x16_bf16 v[128:143], v[84:87], a[208:211], v[128:143]
ds_read_b64_tr_b16 v[76:77], v11 offset:16384
ds_read_b64_tr_b16 v[78:79], v11 offset:17408
v_cvt_f32_u32 v68, v68
v_cvt_f32_u32 v69, v69
v_cvt_f32_u32 v70, v70
v_fmamk_f32 v68, v68, 0x3ae38e39, v23
v_fmamk_f32 v69, v69, 0x3ae38e39, v23
v_mul_f32 v70, 0x3ae38e39, v70
v_mfma_f32_32x32x16_bf16 v[144:159], v[84:87], a[212:215], v[144:159]
buffer_load_dwordx4 v7, s[16:19], s42 offen offset:1024 lds
ds_read_b128 a[236:239], v13 offset:27648
v_cos_f32 v214, v68
v_cos_f32 v215, v69
v_cos_f32 v20, v70
v_mul_u32_u24 v66, s43, v65
v_add_u32 v67, v66, v65
s_waitcnt lgkmcnt(4)
v_mfma_f32_32x32x16_bf16 v[96:111], v[72:75], a[216:219], v[96:111]
s_waitcnt vmcnt(14)
ds_read_b64_tr_b16 v[80:81], v10 offset:18432
ds_read_b64_tr_b16 v[82:83], v10 offset:19456
v_mul_hi_u32 v68, v66, s100
v_mul_hi_u32 v69, v67, s100
v_mul_hi_u32 v70, v65, s100
v_mul_u32_u24 v68, s101, v68
v_mul_u32_u24 v69, s101, v69
v_mul_u32_u24 v70, s101, v70
v_mfma_f32_32x32x16_bf16 v[112:127], v[72:75], a[220:223], v[112:127]
s_add_u32 m0, s41, 14336
s_add_u32 s42, s54, s68
buffer_load_dwordx4 v6, s[16:19], s42 offen lds
ds_read_b128 a[240:243], v13 offset:28672
v_sub_u32 v68, v66, v68
v_sub_u32 v69, v67, v69
v_sub_u32 v70, v65, v70
v_cvt_f32_u32 v68, v68
v_cvt_f32_u32 v69, v69
s_waitcnt lgkmcnt(4)
v_mfma_f32_32x32x16_bf16 v[128:143], v[76:79], a[216:219], v[128:143]
ds_read_b64_tr_b16 v[84:85], v11 offset:18432
ds_read_b64_tr_b16 v[86:87], v11 offset:19456
v_cvt_f32_u32 v70, v70
v_fmamk_f32 v68, v68, 0x3ae38e39, v23
v_fmamk_f32 v69, v69, 0x3ae38e39, v23
v_mul_f32 v70, 0x3ae38e39, v70
v_mfma_f32_32x32x16_bf16 v[144:159], v[76:79], a[220:223], v[144:159]
buffer_load_dwordx4 v7, s[16:19], s42 offen offset:1024 lds
ds_read_b128 a[244:247], v13 offset:29696
v_cos_f32 v222, v68
v_cos_f32 v223, v69
v_cos_f32 v21, v70
s_waitcnt lgkmcnt(4)
v_mfma_f32_32x32x16_bf16 v[96:111], v[80:83], a[224:227], v[96:111]
s_waitcnt vmcnt(14)
ds_read_b64_tr_b16 v[72:73], v10 offset:0
ds_read_b64_tr_b16 v[74:75], v10 offset:1024
v_add_f32 v20, v20, v20
v_add_f32 v21, v21, v21
v_fma_f32 v208, v20, v215, -v214
v_mfma_f32_32x32x16_bf16 v[112:127], v[80:83], a[228:231], v[112:127]
s_add_u32 m0, s41, 16384
s_add_u32 s42, s55, s68
buffer_load_dwordx4 v6, s[16:19], s42 offen lds
ds_read_b128 a[248:251], v13 offset:30720
v_fma_f32 v216, v21, v223, -v222
v_fma_f32 v209, v20, v208, -v215
v_fma_f32 v217, v21, v216, -v223
s_cmp_eq_u32 s43, 574
s_cselect_b64 vcc, -1, 0
v_cndmask_b32 v71, v208, v24, vcc
v_cvt_pk_bf16_f32 v32, v71, v209
s_waitcnt lgkmcnt(4)
v_mfma_f32_32x32x16_bf16 v[128:143], v[84:87], a[224:227], v[128:143]
ds_read_b64_tr_b16 v[76:77], v11 offset:0
ds_read_b64_tr_b16 v[78:79], v11 offset:1024
s_cmp_eq_u32 s43, 574
s_cselect_b64 vcc, -1, 0
v_cndmask_b32 v71, v216, v24, vcc
v_cvt_pk_bf16_f32 v36, v71, v217
v_fma_f32 v210, v20, v209, -v208
v_fma_f32 v218, v21, v217, -v216
v_mul_f32 v176, v62, v176
v_mul_f32 v177, v62, v177
v_mul_f32 v178, v62, v178
v_mfma_f32_32x32x16_bf16 v[144:159], v[84:87], a[228:231], v[144:159]
buffer_load_dwordx4 v7, s[16:19], s42 offen offset:1024 lds
ds_read_b128 a[252:255], v13 offset:31744
v_fma_f32 v211, v20, v210, -v209
v_fma_f32 v219, v21, v218, -v217
v_cvt_pk_bf16_f32 v33, v210, v211
v_mul_f32 v179, v62, v179
v_mul_f32 v180, v62, v180
v_mul_f32 v181, v62, v181
s_waitcnt lgkmcnt(4)
v_mfma_f32_32x32x16_bf16 v[96:111], v[72:75], a[232:235], v[96:111]
s_waitcnt vmcnt(14)
ds_read_b64_tr_b16 v[80:81], v10 offset:2048
ds_read_b64_tr_b16 v[82:83], v10 offset:3072
v_cvt_pk_bf16_f32 v37, v218, v219
v_fma_f32 v212, v20, v211, -v210
v_fma_f32 v220, v21, v219, -v218
v_fma_f32 v213, v20, v212, -v211
v_mul_f32 v182, v62, v182
v_mul_f32 v183, v62, v183
v_mfma_f32_32x32x16_bf16 v[112:127], v[72:75], a[236:239], v[112:127]
s_add_u32 m0, s41, 18432
s_add_u32 s42, s56, s68
buffer_load_dwordx4 v6, s[16:19], s42 offen lds
ds_read_b128 v[224:227], v13 offset:32768
v_fma_f32 v221, v21, v220, -v219
v_cvt_pk_bf16_f32 v34, v212, v213
v_cvt_pk_bf16_f32 v38, v220, v221
v_mul_f32 v184, v62, v184
v_mul_f32 v185, v62, v185
v_mul_f32 v186, v62, v186
s_waitcnt lgkmcnt(4)
v_mfma_f32_32x32x16_bf16 v[128:143], v[76:79], a[232:235], v[128:143]
ds_read_b64_tr_b16 v[84:85], v11 offset:2048
ds_read_b64_tr_b16 v[86:87], v11 offset:3072
v_fma_f32 v214, v20, v213, -v212
v_fma_f32 v222, v21, v221, -v220
v_fma_f32 v215, v20, v214, -v213
v_mul_f32 v187, v62, v187
v_mul_f32 v188, v62, v188
v_mfma_f32_32x32x16_bf16 v[144:159], v[76:79], a[236:239], v[144:159]
buffer_load_dwordx4 v7, s[16:19], s42 offen offset:1024 lds
ds_read_b128 v[228:231], v13 offset:33792
v_fma_f32 v223, v21, v222, -v221
v_cvt_pk_bf16_f32 v35, v214, v215
v_cvt_pk_bf16_f32 v39, v222, v223
v_mul_f32 v189, v62, v189
v_mul_f32 v190, v62, v190
v_mul_f32 v191, v62, v191
s_waitcnt lgkmcnt(4)
v_mfma_f32_32x32x16_bf16 v[96:111], v[80:83], a[240:243], v[96:111]
s_waitcnt vmcnt(14)
ds_read_b64_tr_b16 v[72:73], v10 offset:4096
ds_read_b64_tr_b16 v[74:75], v10 offset:5120
v_cvt_pk_bf16_f32 v176, v176, v177
v_cvt_pk_bf16_f32 v177, v178, v179
v_cvt_pk_bf16_f32 v178, v180, v181
v_mfma_f32_32x32x16_bf16 v[112:127], v[80:83], a[244:247], v[112:127]
s_add_u32 m0, s41, 0
s_add_u32 s42, s57, s68
buffer_load_dwordx4 v6, s[16:19], s42 offen lds
ds_read_b128 v[232:235], v13 offset:34816
v_cvt_pk_bf16_f32 v179, v182, v183
v_cvt_pk_bf16_f32 v180, v184, v185
s_waitcnt lgkmcnt(4)
v_mfma_f32_32x32x16_bf16 v[128:143], v[84:87], a[240:243], v[128:143]
ds_read_b64_tr_b16 v[76:77], v11 offset:4096
ds_read_b64_tr_b16 v[78:79], v11 offset:5120
v_cvt_pk_bf16_f32 v181, v186, v187
v_cvt_pk_bf16_f32 v182, v188, v189
v_cvt_pk_bf16_f32 v183, v190, v191
v_mfma_f32_32x32x16_bf16 v[144:159], v[84:87], a[244:247], v[144:159]
buffer_load_dwordx4 v7, s[16:19], s42 offen offset:1024 lds
ds_read_b128 v[236:239], v13 offset:35840
ds_write_b128 v56, v[176:179]
ds_write_b128 v56, v[180:183] offset:2048
s_waitcnt lgkmcnt(6)
v_mfma_f32_32x32x16_bf16 v[96:111], v[72:75], a[248:251], v[96:111]
s_waitcnt vmcnt(14)
ds_read_b64_tr_b16 v[80:81], v10 offset:6144
ds_read_b64_tr_b16 v[82:83], v10 offset:7168
s_lshr_b32 s3, s38, 1
s_sub_u32 s3, s26, s3
s_cmp_eq_u32 s3, 1
s_cbranch_scc0 Lsk_u2_20
s_waitcnt lgkmcnt(0)
v_add_u32 v57, s28, v63
ds_read_b64_tr_b16 v[192:193], v57 offset:0
ds_read_b64_tr_b16 v[194:195], v57 offset:256
ds_read_b64_tr_b16 v[196:197], v57 offset:1024
ds_read_b64_tr_b16 v[198:199], v57 offset:1280
ds_read_b64_tr_b16 v[200:201], v57 offset:2048
ds_read_b64_tr_b16 v[202:203], v57 offset:2304
ds_read_b64_tr_b16 v[204:205], v57 offset:3072
ds_read_b64_tr_b16 v[206:207], v57 offset:3328
s_waitcnt lgkmcnt(6)
v_mfma_f32_32x32x16_bf16 v[176:191], v[192:195], v[40:43], 0
s_waitcnt lgkmcnt(4)
v_mfma_f32_32x32x16_bf16 v[176:191], v[196:199], v[44:47], v[176:191]
s_waitcnt lgkmcnt(2)
v_mfma_f32_32x32x16_bf16 v[176:191], v[200:203], v[48:51], v[176:191]
s_waitcnt lgkmcnt(0)
v_mfma_f32_32x32x16_bf16 v[176:191], v[204:207], v[52:55], v[176:191]
s_lshl_b32 s3, s38, 10
s_add_u32 s3, s3, 8192
v_add_u32 v56, s3, v12
s_nop 8
v_mul_f32 v176, v62, v176
v_mul_f32 v177, v62, v177
v_mul_f32 v178, v62, v178
v_mul_f32 v179, v62, v179
v_mul_f32 v180, v62, v180
v_mul_f32 v181, v62, v181
v_mul_f32 v182, v62, v182
v_mul_f32 v183, v62, v183
v_mul_f32 v184, v62, v184
v_mul_f32 v185, v62, v185
v_mul_f32 v186, v62, v186
v_mul_f32 v187, v62, v187
v_mul_f32 v188, v62, v188
v_mul_f32 v189, v62, v189
v_mul_f32 v190, v62, v190
v_mul_f32 v191, v62, v191
v_cvt_pk_bf16_f32 v176, v176, v177
v_cvt_pk_bf16_f32 v177, v178, v179
v_cvt_pk_bf16_f32 v178, v180, v181
v_cvt_pk_bf16_f32 v179, v182, v183
v_cvt_pk_bf16_f32 v180, v184, v185
v_cvt_pk_bf16_f32 v181, v186, v187
v_cvt_pk_bf16_f32 v182, v188, v189
v_cvt_pk_bf16_f32 v183, v190, v191
ds_write_b128 v56, v[176:179]
ds_write_b128 v56, v[180:183] offset:2048
s_waitcnt lgkmcnt(0)
Lsk_u2_20:
s_lshr_b32 s3, s38, 1
s_sub_u32 s3, s26, s3
s_cmp_eq_u32 s3, 1
s_cbranch_scc0 Lsk_gqx_21
s_lshl_b32 s43, s36, 1
s_add_u32 s43, s43, s38
s_lshl_b32 s43, s43, 3
s_add_u32 s43, s43, 766
s_lshr_b32 s3, s97, 1
v_add_u32 v64, s3, v22
v_add_u32 v65, 32, v64
v_mul_u32_u24 v66, s43, v64
v_add_u32 v67, v66, v64
v_mul_hi_u32 v68, v66, s100
v_mul_hi_u32 v69, v67, s100
v_mul_hi_u32 v70, v64, s100
v_mul_u32_u24 v68, s101, v68
v_mul_u32_u24 v69, s101, v69
v_mul_u32_u24 v70, s101, v70
v_sub_u32 v68, v66, v68
v_sub_u32 v69, v67, v69
v_sub_u32 v70, v64, v70
v_cvt_f32_u32 v68, v68
v_cvt_f32_u32 v69, v69
v_cvt_f32_u32 v70, v70
v_fmamk_f32 v68, v68, 0x3ae38e39, v23
v_fmamk_f32 v69, v69, 0x3ae38e39, v23
v_mul_f32 v70, 0x3ae38e39, v70
v_cos_f32 v214, v68
v_cos_f32 v215, v69
v_cos_f32 v20, v70
v_mul_u32_u24 v66, s43, v65
v_add_u32 v67, v66, v65
v_mul_hi_u32 v68, v66, s100
v_mul_hi_u32 v69, v67, s100
v_mul_hi_u32 v70, v65, s100
v_mul_u32_u24 v68, s101, v68
v_mul_u32_u24 v69, s101, v69
v_mul_u32_u24 v70, s101, v70
v_sub_u32 v68, v66, v68
v_sub_u32 v69, v67, v69
v_sub_u32 v70, v65, v70
v_cvt_f32_u32 v68, v68
v_cvt_f32_u32 v69, v69
v_cvt_f32_u32 v70, v70
v_fmamk_f32 v68, v68, 0x3ae38e39, v23
v_fmamk_f32 v69, v69, 0x3ae38e39, v23
v_mul_f32 v70, 0x3ae38e39, v70
v_cos_f32 v222, v68
v_cos_f32 v223, v69
v_cos_f32 v21, v70
v_add_f32 v20, v20, v20
v_add_f32 v21, v21, v21
v_fma_f32 v208, v20, v215, -v214
v_fma_f32 v216, v21, v223, -v222
v_fma_f32 v209, v20, v208, -v215
v_fma_f32 v217, v21, v216, -v223
v_cvt_pk_bf16_f32 v40, v208, v209
v_cvt_pk_bf16_f32 v44, v216, v217
v_fma_f32 v210, v20, v209, -v208
v_fma_f32 v218, v21, v217, -v216
v_fma_f32 v211, v20, v210, -v209
v_fma_f32 v219, v21, v218, -v217
v_cvt_pk_bf16_f32 v41, v210, v211
v_cvt_pk_bf16_f32 v45, v218, v219
v_fma_f32 v212, v20, v211, -v210
v_fma_f32 v220, v21, v219, -v218
v_fma_f32 v213, v20, v212, -v211
v_fma_f32 v221, v21, v220, -v219
v_cvt_pk_bf16_f32 v42, v212, v213
v_cvt_pk_bf16_f32 v46, v220, v221
v_fma_f32 v214, v20, v213, -v212
v_fma_f32 v222, v21, v221, -v220
v_fma_f32 v215, v20, v214, -v213
v_fma_f32 v223, v21, v222, -v221
v_cvt_pk_bf16_f32 v43, v214, v215
v_cvt_pk_bf16_f32 v47, v222, v223
Lsk_gqx_21:
v_mfma_f32_32x32x16_bf16 v[112:127], v[72:75], a[252:255], v[112:127]
s_add_u32 m0, s41, 2048
s_add_u32 s42, s58, s68
buffer_load_dwordx4 v6, s[16:19], s42 offen lds
ds_read_b128 v[240:243], v13 offset:36864
s_waitcnt lgkmcnt(6)
v_mfma_f32_32x32x16_bf16 v[128:143], v[76:79], a[248:251], v[128:143]
ds_read_b64_tr_b16 v[84:85], v11 offset:6144
ds_read_b64_tr_b16 v[86:87], v11 offset:7168
s_lshl_b32 s43, s36, 5
s_add_u32 s43, s43, 574
s_lshr_b32 s3, s66, 1
v_add_u32 v64, s3, v22
v_add_u32 v65, 32, v64
v_mfma_f32_32x32x16_bf16 v[144:159], v[76:79], a[252:255], v[144:159]
buffer_load_dwordx4 v7, s[16:19], s42 offen offset:1024 lds
ds_read_b128 v[244:247], v13 offset:37888
v_mul_u32_u24 v66, s43, v64
v_add_u32 v67, v66, v64
v_mul_hi_u32 v68, v66, s100
v_mul_hi_u32 v69, v67, s100
s_waitcnt lgkmcnt(4)
v_mfma_f32_32x32x16_bf16 v[96:111], v[80:83], v[224:227], v[96:111]
s_waitcnt vmcnt(14)
ds_read_b64_tr_b16 v[72:73], v10 offset:8192
ds_read_b64_tr_b16 v[74:75], v10 offset:9216
v_mul_hi_u32 v70, v64, s100
v_mul_u32_u24 v68, s101, v68
v_mul_u32_u24 v69, s101, v69
v_mul_u32_u24 v70, s101, v70
v_mfma_f32_32x32x16_bf16 v[112:127], v[80:83], v[228:231], v[112:127]
s_add_u32 m0, s41, 4096
s_add_u32 s42, s59, s68
buffer_load_dwordx4 v6, s[16:19], s42 offen lds
ds_read_b128 v[248:251], v13 offset:38912
v_sub_u32 v68, v66, v68
v_sub_u32 v69, v67, v69
v_sub_u32 v70, v64, v70
v_cvt_f32_u32 v68, v68
s_waitcnt lgkmcnt(4)
v_mfma_f32_32x32x16_bf16 v[128:143], v[84:87], v[224:227], v[128:143]
ds_read_b64_tr_b16 v[76:77], v11 offset:8192
ds_read_b64_tr_b16 v[78:79], v11 offset:9216
v_cvt_f32_u32 v69, v69
v_cvt_f32_u32 v70, v70
v_fmamk_f32 v68, v68, 0x3ae38e39, v23
v_fmamk_f32 v69, v69, 0x3ae38e39, v23
v_mfma_f32_32x32x16_bf16 v[144:159], v[84:87], v[228:231], v[144:159]
buffer_load_dwordx4 v7, s[16:19], s42 offen offset:1024 lds
ds_read_b128 v[252:255], v13 offset:39936
v_mul_f32 v70, 0x3ae38e39, v70
v_cos_f32 v214, v68
v_cos_f32 v215, v69
v_cos_f32 v20, v70
v_mul_u32_u24 v66, s43, v65
s_waitcnt lgkmcnt(4)
v_mfma_f32_32x32x16_bf16 v[96:111], v[72:75], v[232:235], v[96:111]
s_waitcnt vmcnt(14)
ds_read_b64_tr_b16 v[80:81], v10 offset:10240
ds_read_b64_tr_b16 v[82:83], v10 offset:11264
v_add_u32 v67, v66, v65
v_mul_hi_u32 v68, v66, s100
v_mul_hi_u32 v69, v67, s100
v_mul_hi_u32 v70, v65, s100
v_mfma_f32_32x32x16_bf16 v[112:127], v[72:75], v[236:239], v[112:127]
s_add_u32 m0, s41, 6144
s_add_u32 s42, s60, s68
buffer_load_dwordx4 v6, s[16:19], s42 offen lds
v_mul_u32_u24 v68, s101, v68
v_mul_u32_u24 v69, s101, v69
v_mul_u32_u24 v70, s101, v70
v_sub_u32 v68, v66, v68
s_waitcnt lgkmcnt(3)
v_mfma_f32_32x32x16_bf16 v[128:143], v[76:79], v[232:235], v[128:143]
ds_read_b64_tr_b16 v[84:85], v11 offset:10240
ds_read_b64_tr_b16 v[86:87], v11 offset:11264
v_sub_u32 v69, v67, v69
v_sub_u32 v70, v65, v70
v_cvt_f32_u32 v68, v68
v_cvt_f32_u32 v69, v69
v_mfma_f32_32x32x16_bf16 v[144:159], v[76:79], v[236:239], v[144:159]
buffer_load_dwordx4 v7, s[16:19], s42 offen offset:1024 lds
v_cvt_f32_u32 v70, v70
v_fmamk_f32 v68, v68, 0x3ae38e39, v23
v_fmamk_f32 v69, v69, 0x3ae38e39, v23
v_mul_f32 v70, 0x3ae38e39, v70
s_waitcnt lgkmcnt(2)
v_mfma_f32_32x32x16_bf16 v[96:111], v[80:83], v[240:243], v[96:111]
s_waitcnt vmcnt(14)
ds_read_b64_tr_b16 v[72:73], v10 offset:12288
ds_read_b64_tr_b16 v[74:75], v10 offset:13312
v_cos_f32 v222, v68
v_cos_f32 v223, v69
v_cos_f32 v21, v70
v_add_f32 v20, v20, v20
s_barrier
v_mfma_f32_32x32x16_bf16 v[112:127], v[80:83], v[244:247], v[112:127]
s_add_u32 m0, s41, 8192
s_add_u32 s42, s61, s68
buffer_load_dwordx4 v6, s[16:19], s42 offen lds
v_add_f32 v21, v21, v21
v_fma_f32 v208, v20, v215, -v214
v_fma_f32 v216, v21, v223, -v222
v_fma_f32 v209, v20, v208, -v215
v_fma_f32 v217, v21, v216, -v223
s_waitcnt lgkmcnt(2)
v_mfma_f32_32x32x16_bf16 v[128:143], v[84:87], v[240:243], v[128:143]
ds_read_b64_tr_b16 v[76:77], v11 offset:12288
ds_read_b64_tr_b16 v[78:79], v11 offset:13312
s_cmp_eq_u32 s36, 0
s_cselect_b64 vcc, -1, 0
v_cndmask_b32 v71, v208, v24, vcc
v_cvt_pk_bf16_f32 v160, v71, v209
s_cmp_eq_u32 s36, 0
s_cselect_b64 vcc, -1, 0
v_cndmask_b32 v71, v216, v24, vcc
v_cvt_pk_bf16_f32 v164, v71, v217
v_fma_f32 v210, v20, v209, -v208
v_fma_f32 v218, v21, v217, -v216
v_mfma_f32_32x32x16_bf16 v[144:159], v[84:87], v[244:247], v[144:159]
buffer_load_dwordx4 v7, s[16:19], s42 offen offset:1024 lds
v_fma_f32 v211, v20, v210, -v209
v_fma_f32 v219, v21, v218, -v217
v_cvt_pk_bf16_f32 v161, v210, v211
v_cvt_pk_bf16_f32 v165, v218, v219
s_waitcnt lgkmcnt(2)
v_mfma_f32_32x32x16_bf16 v[96:111], v[72:75], v[248:251], v[96:111]
s_waitcnt vmcnt(14)
ds_read_b64_tr_b16 v[80:81], v10 offset:14336
ds_read_b64_tr_b16 v[82:83], v10 offset:15360
v_fma_f32 v212, v20, v211, -v210
v_fma_f32 v220, v21, v219, -v218
v_fma_f32 v213, v20, v212, -v211
v_fma_f32 v221, v21, v220, -v219
v_mfma_f32_32x32x16_bf16 v[112:127], v[72:75], v[252:255], v[112:127]
s_add_u32 m0, s41, 10240
s_add_u32 s42, s62, s68
buffer_load_dwordx4 v6, s[16:19], s42 offen lds
v_cvt_pk_bf16_f32 v162, v212, v213
v_cvt_pk_bf16_f32 v166, v220, v221
v_fma_f32 v214, v20, v213, -v212
v_fma_f32 v222, v21, v221, -v220
s_waitcnt lgkmcnt(2)
v_mfma_f32_32x32x16_bf16 v[128:143], v[76:79], v[248:251], v[128:143]
ds_read_b64_tr_b16 v[84:85], v11 offset:14336
ds_read_b64_tr_b16 v[86:87], v11 offset:15360
v_fma_f32 v215, v20, v214, -v213
v_fma_f32 v223, v21, v222, -v221
v_cvt_pk_bf16_f32 v163, v214, v215
v_cvt_pk_bf16_f32 v167, v222, v223
v_mfma_f32_32x32x16_bf16 v[144:159], v[76:79], v[252:255], v[144:159]
buffer_load_dwordx4 v7, s[16:19], s42 offen offset:1024 lds
ds_read_b128 v[56:59], v12 offset:0
ds_read_b128 v[60:63], v12 offset:1024
s_waitcnt lgkmcnt(0)
v_mfma_f32_32x32x16_bf16 v[96:111], v[160:163], v[56:59], v[96:111]
ds_read_b128 v[64:67], v12 offset:2048
ds_read_b128 v[68:71], v12 offset:3072
v_fma_f32 v208, v20, v215, -v214
v_fma_f32 v216, v21, v223, -v222
v_fma_f32 v209, v20, v208, -v215
v_fma_f32 v217, v21, v216, -v223
v_cvt_pk_bf16_f32 v168, v208, v209
v_mfma_f32_32x32x16_bf16 v[112:127], v[160:163], v[60:63], v[112:127]
v_cvt_pk_bf16_f32 v172, v216, v217
v_fma_f32 v210, v20, v209, -v208
v_fma_f32 v218, v21, v217, -v216
v_fma_f32 v211, v20, v210, -v209
v_fma_f32 v219, v21, v218, -v217
v_cvt_pk_bf16_f32 v169, v210, v211
v_mfma_f32_32x32x16_bf16 v[128:143], v[164:167], v[56:59], v[128:143]
v_cvt_pk_bf16_f32 v173, v218, v219
v_fma_f32 v212, v20, v211, -v210
v_fma_f32 v220, v21, v219, -v218
v_fma_f32 v213, v20, v212, -v211
v_fma_f32 v221, v21, v220, -v219
v_cvt_pk_bf16_f32 v170, v212, v213
v_cvt_pk_bf16_f32 v174, v220, v221
v_mfma_f32_32x32x16_bf16 v[144:159], v[164:167], v[60:63], v[144:159]
v_fma_f32 v214, v20, v213, -v212
v_fma_f32 v222, v21, v221, -v220
v_fma_f32 v215, v20, v214, -v213
v_fma_f32 v223, v21, v222, -v221
v_cvt_pk_bf16_f32 v171, v214, v215
v_cvt_pk_bf16_f32 v175, v222, v223
s_waitcnt lgkmcnt(0)
v_mfma_f32_32x32x16_bf16 v[96:111], v[168:171], v[64:67], v[96:111]
ds_read_b128 v[56:59], v12 offset:4096
ds_read_b128 v[60:63], v12 offset:5120
v_fma_f32 v208, v20, v215, -v214
v_fma_f32 v216, v21, v223, -v222
v_fma_f32 v209, v20, v208, -v215
v_fma_f32 v217, v21, v216, -v223
v_cvt_pk_bf16_f32 v160, v208, v209
v_mfma_f32_32x32x16_bf16 v[112:127], v[168:171], v[68:71], v[112:127]
v_cvt_pk_bf16_f32 v164, v216, v217
v_fma_f32 v210, v20, v209, -v208
v_fma_f32 v218, v21, v217, -v216
v_fma_f32 v211, v20, v210, -v209
v_fma_f32 v219, v21, v218, -v217
v_cvt_pk_bf16_f32 v161, v210, v211
v_mfma_f32_32x32x16_bf16 v[128:143], v[172:175], v[64:67], v[128:143]
v_cvt_pk_bf16_f32 v165, v218, v219
v_fma_f32 v212, v20, v211, -v210
v_fma_f32 v220, v21, v219, -v218
v_fma_f32 v213, v20, v212, -v211
v_fma_f32 v221, v21, v220, -v219
v_cvt_pk_bf16_f32 v162, v212, v213
v_cvt_pk_bf16_f32 v166, v220, v221
v_mfma_f32_32x32x16_bf16 v[144:159], v[172:175], v[68:71], v[144:159]
v_fma_f32 v214, v20, v213, -v212
v_fma_f32 v222, v21, v221, -v220
v_fma_f32 v215, v20, v214, -v213
v_fma_f32 v223, v21, v222, -v221
v_cvt_pk_bf16_f32 v163, v214, v215
v_cvt_pk_bf16_f32 v167, v222, v223
s_waitcnt lgkmcnt(0)
v_mfma_f32_32x32x16_bf16 v[96:111], v[160:163], v[56:59], v[96:111]
ds_read_b128 v[64:67], v12 offset:6144
ds_read_b128 v[68:71], v12 offset:7168
v_fma_f32 v208, v20, v215, -v214
v_fma_f32 v216, v21, v223, -v222
v_fma_f32 v209, v20, v208, -v215
v_fma_f32 v217, v21, v216, -v223
v_cvt_pk_bf16_f32 v168, v208, v209
v_mfma_f32_32x32x16_bf16 v[112:127], v[160:163], v[60:63], v[112:127]
v_cvt_pk_bf16_f32 v172, v216, v217
v_fma_f32 v210, v20, v209, -v208
v_fma_f32 v218, v21, v217, -v216
v_fma_f32 v211, v20, v210, -v209
v_fma_f32 v219, v21, v218, -v217
v_cvt_pk_bf16_f32 v169, v210, v211
v_mfma_f32_32x32x16_bf16 v[128:143], v[164:167], v[56:59], v[128:143]
v_cvt_pk_bf16_f32 v173, v218, v219
v_fma_f32 v212, v20, v211, -v210
v_fma_f32 v220, v21, v219, -v218
v_fma_f32 v213, v20, v212, -v211
v_fma_f32 v221, v21, v220, -v219
v_cvt_pk_bf16_f32 v170, v212, v213
v_cvt_pk_bf16_f32 v174, v220, v221
v_mfma_f32_32x32x16_bf16 v[144:159], v[164:167], v[60:63], v[144:159]
v_fma_f32 v214, v20, v213, -v212
v_fma_f32 v222, v21, v221, -v220
v_fma_f32 v215, v20, v214, -v213
v_fma_f32 v223, v21, v222, -v221
v_cvt_pk_bf16_f32 v171, v214, v215
v_cvt_pk_bf16_f32 v175, v222, v223
s_waitcnt lgkmcnt(0)
v_mfma_f32_32x32x16_bf16 v[96:111], v[168:171], v[64:67], v[96:111]
v_mfma_f32_32x32x16_bf16 v[112:127], v[168:171], v[68:71], v[112:127]
v_mfma_f32_32x32x16_bf16 v[128:143], v[172:175], v[64:67], v[128:143]
v_mfma_f32_32x32x16_bf16 v[144:159], v[172:175], v[68:71], v[144:159]
s_cmp_eq_u32 s26, 1
s_cbranch_scc0 Lsk_xa_22
s_lshl_b32 s43, s36, 4
s_add_u32 s43, s43, 766
s_lshr_b32 s3, s66, 1
v_add_u32 v64, s3, v22
v_add_u32 v65, 32, v64
v_mul_u32_u24 v66, s43, v64
v_add_u32 v67, v66, v64
v_mul_hi_u32 v68, v66, s100
v_mul_hi_u32 v69, v67, s100
v_mul_hi_u32 v70, v64, s100
v_mul_u32_u24 v68, s101, v68
v_mul_u32_u24 v69, s101, v69
v_mul_u32_u24 v70, s101, v70
v_sub_u32 v68, v66, v68
v_sub_u32 v69, v67, v69
v_sub_u32 v70, v64, v70
v_cvt_f32_u32 v68, v68
v_cvt_f32_u32 v69, v69
v_cvt_f32_u32 v70, v70
v_fmamk_f32 v68, v68, 0x3ae38e39, v23
v_fmamk_f32 v69, v69, 0x3ae38e39, v23
v_mul_f32 v70, 0x3ae38e39, v70
v_cos_f32 v214, v68
v_cos_f32 v215, v69
v_cos_f32 v20, v70
v_mul_u32_u24 v66, s43, v65
v_add_u32 v67, v66, v65
v_mul_hi_u32 v68, v66, s100
v_mul_hi_u32 v69, v67, s100
v_mul_hi_u32 v70, v65, s100
v_mul_u32_u24 v68, s101, v68
v_mul_u32_u24 v69, s101, v69
v_mul_u32_u24 v70, s101, v70
v_sub_u32 v68, v66, v68
v_sub_u32 v69, v67, v69
v_sub_u32 v70, v65, v70
v_cvt_f32_u32 v68, v68
v_cvt_f32_u32 v69, v69
v_cvt_f32_u32 v70, v70
v_fmamk_f32 v68, v68, 0x3ae38e39, v23
v_fmamk_f32 v69, v69, 0x3ae38e39, v23
v_mul_f32 v70, 0x3ae38e39, v70
v_cos_f32 v222, v68
v_cos_f32 v223, v69
v_cos_f32 v21, v70
v_add_f32 v20, v20, v20
v_add_f32 v21, v21, v21
ds_read_b128 v[64:67], v12 offset:8192
ds_read_b128 v[68:71], v12 offset:9216
v_fma_f32 v208, v20, v215, -v214
v_fma_f32 v216, v21, v223, -v222
v_fma_f32 v209, v20, v208, -v215
v_fma_f32 v217, v21, v216, -v223
v_cvt_pk_bf16_f32 v160, v208, v209
v_cvt_pk_bf16_f32 v164, v216, v217
v_fma_f32 v210, v20, v209, -v208
v_fma_f32 v218, v21, v217, -v216
v_fma_f32 v211, v20, v210, -v209
v_fma_f32 v219, v21, v218, -v217
v_cvt_pk_bf16_f32 v161, v210, v211
v_cvt_pk_bf16_f32 v165, v218, v219
v_fma_f32 v212, v20, v211, -v210
v_fma_f32 v220, v21, v219, -v218
v_fma_f32 v213, v20, v212, -v211
v_fma_f32 v221, v21, v220, -v219
v_cvt_pk_bf16_f32 v162, v212, v213
v_cvt_pk_bf16_f32 v166, v220, v221
v_fma_f32 v214, v20, v213, -v212
v_fma_f32 v222, v21, v221, -v220
v_fma_f32 v215, v20, v214, -v213
v_fma_f32 v223, v21, v222, -v221
v_cvt_pk_bf16_f32 v163, v214, v215
v_cvt_pk_bf16_f32 v167, v222, v223
s_waitcnt lgkmcnt(0)
v_mfma_f32_32x32x16_bf16 v[96:111], v[160:163], v[64:67], v[96:111]
v_mfma_f32_32x32x16_bf16 v[112:127], v[160:163], v[68:71], v[112:127]
v_mfma_f32_32x32x16_bf16 v[128:143], v[164:167], v[64:67], v[128:143]
v_mfma_f32_32x32x16_bf16 v[144:159], v[164:167], v[68:71], v[144:159]
ds_read_b128 v[56:59], v12 offset:10240
ds_read_b128 v[60:63], v12 offset:11264
v_fma_f32 v208, v20, v215, -v214
v_fma_f32 v216, v21, v223, -v222
v_fma_f32 v209, v20, v208, -v215
v_fma_f32 v217, v21, v216, -v223
v_cvt_pk_bf16_f32 v168, v208, v209
v_cvt_pk_bf16_f32 v172, v216, v217
v_fma_f32 v210, v20, v209, -v208
v_fma_f32 v218, v21, v217, -v216
v_fma_f32 v211, v20, v210, -v209
v_fma_f32 v219, v21, v218, -v217
v_cvt_pk_bf16_f32 v169, v210, v211
v_cvt_pk_bf16_f32 v173, v218, v219
v_fma_f32 v212, v20, v211, -v210
v_fma_f32 v220, v21, v219, -v218
v_fma_f32 v213, v20, v212, -v211
v_fma_f32 v221, v21, v220, -v219
v_cvt_pk_bf16_f32 v170, v212, v213
v_cvt_pk_bf16_f32 v174, v220, v221
v_fma_f32 v214, v20, v213, -v212
v_fma_f32 v222, v21, v221, -v220
v_fma_f32 v215, v20, v214, -v213
v_fma_f32 v223, v21, v222, -v221
v_cvt_pk_bf16_f32 v171, v214, v215
v_cvt_pk_bf16_f32 v175, v222, v223
s_waitcnt lgkmcnt(0)
v_mfma_f32_32x32x16_bf16 v[96:111], v[168:171], v[56:59], v[96:111]
v_mfma_f32_32x32x16_bf16 v[112:127], v[168:171], v[60:63], v[112:127]
v_mfma_f32_32x32x16_bf16 v[128:143], v[172:175], v[56:59], v[128:143]
v_mfma_f32_32x32x16_bf16 v[144:159], v[172:175], v[60:63], v[144:159]
Lsk_xa_22:
s_cmp_eq_u32 s38, 1
s_cbranch_scc1 Lq2_1
s_cmp_eq_u32 s38, 2
s_cbranch_scc1 Lq2_2
s_cmp_eq_u32 s38, 3
s_cbranch_scc1 Lq2_3
v_mfma_f32_32x32x16_bf16 v[160:175], v[80:83], a[0:3], 0
s_waitcnt vmcnt(14)
ds_read_b64_tr_b16 v[72:73], v10 offset:16384
ds_read_b64_tr_b16 v[74:75], v10 offset:17408
v_mfma_f32_32x32x16_bf16 v[176:191], v[80:83], a[4:7], 0
s_add_u32 m0, s41, 12288
s_add_u32 s42, s54, s67
buffer_load_dwordx4 v6, s[16:19], s42 offen lds
v_mfma_f32_32x32x16_bf16 v[192:207], v[84:87], a[0:3], 0
ds_read_b64_tr_b16 v[76:77], v11 offset:16384
ds_read_b64_tr_b16 v[78:79], v11 offset:17408
v_mfma_f32_32x32x16_bf16 v[208:223], v[84:87], a[4:7], 0
buffer_load_dwordx4 v7, s[16:19], s42 offen offset:1024 lds
v_cvt_pk_bf16_f32 v88, v96, v97
v_cvt_pk_bf16_f32 v89, v98, v99
s_waitcnt lgkmcnt(2)
v_mfma_f32_32x32x16_bf16 v[160:175], v[72:75], a[32:35], v[160:175]
s_waitcnt vmcnt(14)
ds_read_b64_tr_b16 v[80:81], v10 offset:18432
ds_read_b64_tr_b16 v[82:83], v10 offset:19456
v_cvt_pk_bf16_f32 v90, v100, v101
v_mfma_f32_32x32x16_bf16 v[176:191], v[72:75], a[36:39], v[176:191]
s_add_u32 m0, s41, 14336
s_add_u32 s42, s42, 18432
buffer_load_dwordx4 v6, s[16:19], s42 offen lds
v_cvt_pk_bf16_f32 v91, v102, v103
s_waitcnt lgkmcnt(2)
v_mfma_f32_32x32x16_bf16 v[192:207], v[76:79], a[32:35], v[192:207]
ds_read_b64_tr_b16 v[84:85], v11 offset:18432
ds_read_b64_tr_b16 v[86:87], v11 offset:19456
buffer_store_dwordx4 v[88:91], v30, s[4:7], s69 offen offset:0 sc1
v_cvt_pk_bf16_f32 v92, v112, v113
v_mfma_f32_32x32x16_bf16 v[208:223], v[76:79], a[36:39], v[208:223]
buffer_load_dwordx4 v7, s[16:19], s42 offen offset:1024 lds
v_cvt_pk_bf16_f32 v93, v114, v115
s_waitcnt lgkmcnt(2)
v_mfma_f32_32x32x16_bf16 v[160:175], v[80:83], a[64:67], v[160:175]
s_waitcnt vmcnt(15)
ds_read_b64_tr_b16 v[72:73], v10 offset:0
ds_read_b64_tr_b16 v[74:75], v10 offset:1024
v_cvt_pk_bf16_f32 v94, v116, v117
v_mfma_f32_32x32x16_bf16 v[176:191], v[80:83], a[68:71], v[176:191]
s_add_u32 m0, s41, 16384
s_add_u32 s42, s42, 18432
buffer_load_dwordx4 v6, s[16:19], s42 offen lds
v_cvt_pk_bf16_f32 v95, v118, v119
buffer_store_dwordx4 v[92:95], v29, s[4:7], s69 offen offset:0 sc1
s_waitcnt lgkmcnt(2)
v_mfma_f32_32x32x16_bf16 v[192:207], v[84:87], a[64:67], v[192:207]
ds_read_b64_tr_b16 v[76:77], v11 offset:0
ds_read_b64_tr_b16 v[78:79], v11 offset:1024
v_cvt_pk_bf16_f32 v88, v104, v105
v_mfma_f32_32x32x16_bf16 v[208:223], v[84:87], a[68:71], v[208:223]
buffer_load_dwordx4 v7, s[16:19], s42 offen offset:1024 lds
v_cvt_pk_bf16_f32 v89, v106, v107
s_waitcnt lgkmcnt(2)
v_mfma_f32_32x32x16_bf16 v[160:175], v[72:75], a[96:99], v[160:175]
s_waitcnt vmcnt(16)
ds_read_b64_tr_b16 v[80:81], v10 offset:2048
ds_read_b64_tr_b16 v[82:83], v10 offset:3072
v_cvt_pk_bf16_f32 v90, v108, v109
v_mfma_f32_32x32x16_bf16 v[176:191], v[72:75], a[100:103], v[176:191]
s_add_u32 m0, s41, 18432
s_add_u32 s42, s42, 18432
buffer_load_dwordx4 v6, s[16:19], s42 offen lds
v_cvt_pk_bf16_f32 v91, v110, v111
buffer_store_dwordx4 v[88:91], v30, s[4:7], s69 offen offset:256 sc1
s_waitcnt lgkmcnt(2)
v_mfma_f32_32x32x16_bf16 v[192:207], v[76:79], a[96:99], v[192:207]
ds_read_b64_tr_b16 v[84:85], v11 offset:2048
ds_read_b64_tr_b16 v[86:87], v11 offset:3072
v_cvt_pk_bf16_f32 v92, v120, v121
v_mfma_f32_32x32x16_bf16 v[208:223], v[76:79], a[100:103], v[208:223]
buffer_load_dwordx4 v7, s[16:19], s42 offen offset:1024 lds
v_cvt_pk_bf16_f32 v93, v122, v123
s_waitcnt lgkmcnt(2)
v_mfma_f32_32x32x16_bf16 v[160:175], v[80:83], a[128:131], v[160:175]
s_waitcnt vmcnt(17)
ds_read_b64_tr_b16 v[72:73], v10 offset:4096
ds_read_b64_tr_b16 v[74:75], v10 offset:5120
v_cvt_pk_bf16_f32 v94, v124, v125
v_cvt_pk_bf16_f32 v95, v126, v127
v_mfma_f32_32x32x16_bf16 v[176:191], v[80:83], a[132:135], v[176:191]
s_add_u32 m0, s41, 0
s_add_u32 s42, s55, s67
buffer_load_dwordx4 v6, s[16:19], s42 offen lds
buffer_store_dwordx4 v[92:95], v29, s[4:7], s69 offen offset:256 sc1
s_waitcnt lgkmcnt(2)
v_mfma_f32_32x32x16_bf16 v[192:207], v[84:87], a[128:131], v[192:207]
ds_read_b64_tr_b16 v[76:77], v11 offset:4096
ds_read_b64_tr_b16 v[78:79], v11 offset:5120
v_cvt_pk_bf16_f32 v88, v128, v129
v_mfma_f32_32x32x16_bf16 v[208:223], v[84:87], a[132:135], v[208:223]
buffer_load_dwordx4 v7, s[16:19], s42 offen offset:1024 lds
v_cvt_pk_bf16_f32 v89, v130, v131
s_waitcnt lgkmcnt(2)
v_mfma_f32_32x32x16_bf16 v[160:175], v[72:75], a[160:163], v[160:175]
s_waitcnt vmcnt(18)
ds_read_b64_tr_b16 v[80:81], v10 offset:6144
ds_read_b64_tr_b16 v[82:83], v10 offset:7168
v_cvt_pk_bf16_f32 v90, v132, v133
v_cvt_pk_bf16_f32 v91, v134, v135
v_mfma_f32_32x32x16_bf16 v[176:191], v[72:75], a[164:167], v[176:191]
s_add_u32 m0, s41, 2048
s_add_u32 s42, s42, 18432
buffer_load_dwordx4 v6, s[16:19], s42 offen lds
buffer_store_dwordx4 v[88:91], v30, s[4:7], s69 offen offset:512 sc1
s_waitcnt lgkmcnt(2)
v_mfma_f32_32x32x16_bf16 v[192:207], v[76:79], a[160:163], v[192:207]
ds_read_b64_tr_b16 v[84:85], v11 offset:6144
ds_read_b64_tr_b16 v[86:87], v11 offset:7168
v_cvt_pk_bf16_f32 v92, v144, v145
v_mfma_f32_32x32x16_bf16 v[208:223], v[76:79], a[164:167], v[208:223]
buffer_load_dwordx4 v7, s[16:19], s42 offen offset:1024 lds
v_cvt_pk_bf16_f32 v93, v146, v147
v_cvt_pk_bf16_f32 v94, v148, v149
s_waitcnt lgkmcnt(2)
v_mfma_f32_32x32x16_bf16 v[160:175], v[80:83], a[192:195], v[160:175]
s_waitcnt vmcnt(19)
ds_read_b64_tr_b16 v[72:73], v10 offset:8192
ds_read_b64_tr_b16 v[74:75], v10 offset:9216
v_cvt_pk_bf16_f32 v95, v150, v151
v_mfma_f32_32x32x16_bf16 v[176:191], v[80:83], a[196:199], v[176:191]
s_add_u32 m0, s41, 4096
s_add_u32 s42, s42, 18432
buffer_load_dwordx4 v6, s[16:19], s42 offen lds
buffer_store_dwordx4 v[92:95], v29, s[4:7], s69 offen offset:512 sc1
s_waitcnt lgkmcnt(2)
v_mfma_f32_32x32x16_bf16 v[192:207], v[84:87], a[192:195], v[192:207]
ds_read_b64_tr_b16 v[76:77], v11 offset:8192
ds_read_b64_tr_b16 v[78:79], v11 offset:9216
v_cvt_pk_bf16_f32 v88, v136, v137
v_mfma_f32_32x32x16_bf16 v[208:223], v[84:87], a[196:199], v[208:223]
buffer_load_dwordx4 v7, s[16:19], s42 offen offset:1024 lds
v_cvt_pk_bf16_f32 v89, v138, v139
v_cvt_pk_bf16_f32 v90, v140, v141
s_waitcnt lgkmcnt(2)
v_mfma_f32_32x32x16_bf16 v[160:175], v[72:75], a[224:227], v[160:175]
s_waitcnt vmcnt(20)
ds_read_b64_tr_b16 v[80:81], v10 offset:10240
ds_read_b64_tr_b16 v[82:83], v10 offset:11264
v_cvt_pk_bf16_f32 v91, v142, v143
v_mfma_f32_32x32x16_bf16 v[176:191], v[72:75], a[228:231], v[176:191]
s_add_u32 m0, s41, 6144
s_add_u32 s42, s42, 18432
buffer_load_dwordx4 v6, s[16:19], s42 offen lds
buffer_store_dwordx4 v[88:91], v30, s[4:7], s69 offen offset:768 sc1
s_waitcnt lgkmcnt(2)
v_mfma_f32_32x32x16_bf16 v[192:207], v[76:79], a[224:227], v[192:207]
ds_read_b64_tr_b16 v[84:85], v11 offset:10240
ds_read_b64_tr_b16 v[86:87], v11 offset:11264
v_cvt_pk_bf16_f32 v92, v152, v153
v_cvt_pk_bf16_f32 v93, v154, v155
v_mfma_f32_32x32x16_bf16 v[208:223], v[76:79], a[228:231], v[208:223]
buffer_load_dwordx4 v7, s[16:19], s42 offen offset:1024 lds
v_cvt_pk_bf16_f32 v94, v156, v157
s_waitcnt lgkmcnt(2)
v_mfma_f32_32x32x16_bf16 v[160:175], v[80:83], v[224:227], v[160:175]
s_waitcnt vmcnt(21)
ds_read_b64_tr_b16 v[72:73], v10 offset:12288
ds_read_b64_tr_b16 v[74:75], v10 offset:13312
v_cvt_pk_bf16_f32 v95, v158, v159
ds_read_b128 v[56:59], v12 offset:0
v_mfma_f32_32x32x16_bf16 v[176:191], v[80:83], v[228:231], v[176:191]
s_add_u32 m0, s41, 8192
s_add_u32 s42, s56, s67
buffer_load_dwordx4 v6, s[16:19], s42 offen lds
buffer_store_dwordx4 v[92:95], v29, s[4:7], s69 offen offset:768 sc1
ds_read_b128 v[60:63], v12 offset:1024
s_waitcnt lgkmcnt(4)
v_mfma_f32_32x32x16_bf16 v[192:207], v[84:87], v[224:227], v[192:207]
ds_read_b64_tr_b16 v[76:77], v11 offset:12288
ds_read_b64_tr_b16 v[78:79], v11 offset:13312
v_mfma_f32_32x32x16_bf16 v[208:223], v[84:87], v[228:231], v[208:223]
buffer_load_dwordx4 v7, s[16:19], s42 offen offset:1024 lds
s_waitcnt lgkmcnt(2)
v_mfma_f32_32x32x16_bf16 v[160:175], v[32:35], v[56:59], v[160:175]
v_mfma_f32_32x32x16_bf16 v[176:191], v[32:35], v[60:63], v[176:191]
v_mfma_f32_32x32x16_bf16 v[192:207], v[36:39], v[56:59], v[192:207]
v_mfma_f32_32x32x16_bf16 v[208:223], v[36:39], v[60:63], v[208:223]
s_cmp_eq_u32 s26, 1
s_cbranch_scc0 Lsk_xq_23
ds_read_b128 v[64:67], v12 offset:8192
ds_read_b128 v[68:71], v12 offset:9216
s_waitcnt lgkmcnt(0)
v_mfma_f32_32x32x16_bf16 v[160:175], v[40:43], v[64:67], v[160:175]
v_mfma_f32_32x32x16_bf16 v[176:191], v[40:43], v[68:71], v[176:191]
v_mfma_f32_32x32x16_bf16 v[192:207], v[44:47], v[64:67], v[192:207]
v_mfma_f32_32x32x16_bf16 v[208:223], v[44:47], v[68:71], v[208:223]
Lsk_xq_23:
s_branch Lq2_j
Lq2_1:
v_mfma_f32_32x32x16_bf16 v[208:223], v[80:83], a[8:11], 0
s_waitcnt vmcnt(14)
ds_read_b64_tr_b16 v[72:73], v10 offset:16384
ds_read_b64_tr_b16 v[74:75], v10 offset:17408
v_mfma_f32_32x32x16_bf16 v[160:175], v[80:83], a[12:15], 0
s_add_u32 m0, s41, 12288
s_add_u32 s42, s54, s67
buffer_load_dwordx4 v6, s[16:19], s42 offen lds
v_mfma_f32_32x32x16_bf16 v[176:191], v[84:87], a[8:11], 0
ds_read_b64_tr_b16 v[76:77], v11 offset:16384
ds_read_b64_tr_b16 v[78:79], v11 offset:17408
v_mfma_f32_32x32x16_bf16 v[192:207], v[84:87], a[12:15], 0
buffer_load_dwordx4 v7, s[16:19], s42 offen offset:1024 lds
v_cvt_pk_bf16_f32 v88, v96, v97
v_cvt_pk_bf16_f32 v89, v98, v99
s_waitcnt lgkmcnt(2)
v_mfma_f32_32x32x16_bf16 v[208:223], v[72:75], a[40:43], v[208:223]
s_waitcnt vmcnt(14)
ds_read_b64_tr_b16 v[80:81], v10 offset:18432
ds_read_b64_tr_b16 v[82:83], v10 offset:19456
v_cvt_pk_bf16_f32 v90, v100, v101
v_mfma_f32_32x32x16_bf16 v[160:175], v[72:75], a[44:47], v[160:175]
s_add_u32 m0, s41, 14336
s_add_u32 s42, s42, 18432
buffer_load_dwordx4 v6, s[16:19], s42 offen lds
v_cvt_pk_bf16_f32 v91, v102, v103
s_waitcnt lgkmcnt(2)
v_mfma_f32_32x32x16_bf16 v[176:191], v[76:79], a[40:43], v[176:191]
ds_read_b64_tr_b16 v[84:85], v11 offset:18432
ds_read_b64_tr_b16 v[86:87], v11 offset:19456
buffer_store_dwordx4 v[88:91], v30, s[4:7], s69 offen offset:0 sc1
v_cvt_pk_bf16_f32 v92, v112, v113
v_mfma_f32_32x32x16_bf16 v[192:207], v[76:79], a[44:47], v[192:207]
buffer_load_dwordx4 v7, s[16:19], s42 offen offset:1024 lds
v_cvt_pk_bf16_f32 v93, v114, v115
s_waitcnt lgkmcnt(2)
v_mfma_f32_32x32x16_bf16 v[208:223], v[80:83], a[72:75], v[208:223]
s_waitcnt vmcnt(15)
ds_read_b64_tr_b16 v[72:73], v10 offset:0
ds_read_b64_tr_b16 v[74:75], v10 offset:1024
v_cvt_pk_bf16_f32 v94, v116, v117
v_mfma_f32_32x32x16_bf16 v[160:175], v[80:83], a[76:79], v[160:175]
s_add_u32 m0, s41, 16384
s_add_u32 s42, s42, 18432
buffer_load_dwordx4 v6, s[16:19], s42 offen lds
v_cvt_pk_bf16_f32 v95, v118, v119
buffer_store_dwordx4 v[92:95], v29, s[4:7], s69 offen offset:0 sc1
s_waitcnt lgkmcnt(2)
v_mfma_f32_32x32x16_bf16 v[176:191], v[84:87], a[72:75], v[176:191]
ds_read_b64_tr_b16 v[76:77], v11 offset:0
ds_read_b64_tr_b16 v[78:79], v11 offset:1024
v_cvt_pk_bf16_f32 v88, v104, v105
v_mfma_f32_32x32x16_bf16 v[192:207], v[84:87], a[76:79], v[192:207]
buffer_load_dwordx4 v7, s[16:19], s42 offen offset:1024 lds
v_cvt_pk_bf16_f32 v89, v106, v107
s_waitcnt lgkmcnt(2)
v_mfma_f32_32x32x16_bf16 v[208:223], v[72:75], a[104:107], v[208:223]
s_waitcnt vmcnt(16)
ds_read_b64_tr_b16 v[80:81], v10 offset:2048
ds_read_b64_tr_b16 v[82:83], v10 offset:3072
v_cvt_pk_bf16_f32 v90, v108, v109
v_mfma_f32_32x32x16_bf16 v[160:175], v[72:75], a[108:111], v[160:175]
s_add_u32 m0, s41, 18432
s_add_u32 s42, s42, 18432
buffer_load_dwordx4 v6, s[16:19], s42 offen lds
v_cvt_pk_bf16_f32 v91, v110, v111
buffer_store_dwordx4 v[88:91], v30, s[4:7], s69 offen offset:256 sc1
s_waitcnt lgkmcnt(2)
v_mfma_f32_32x32x16_bf16 v[176:191], v[76:79], a[104:107], v[176:191]
ds_read_b64_tr_b16 v[84:85], v11 offset:2048
ds_read_b64_tr_b16 v[86:87], v11 offset:3072
v_cvt_pk_bf16_f32 v92, v120, v121
v_mfma_f32_32x32x16_bf16 v[192:207], v[76:79], a[108:111], v[192:207]
buffer_load_dwordx4 v7, s[16:19], s42 offen offset:1024 lds
v_cvt_pk_bf16_f32 v93, v122, v123
s_waitcnt lgkmcnt(2)
v_mfma_f32_32x32x16_bf16 v[208:223], v[80:83], a[136:139], v[208:223]
s_waitcnt vmcnt(17)
ds_read_b64_tr_b16 v[72:73], v10 offset:4096
ds_read_b64_tr_b16 v[74:75], v10 offset:5120
v_cvt_pk_bf16_f32 v94, v124, v125
v_cvt_pk_bf16_f32 v95, v126, v127
v_mfma_f32_32x32x16_bf16 v[160:175], v[80:83], a[140:143], v[160:175]
s_add_u32 m0, s41, 0
s_add_u32 s42, s55, s67
buffer_load_dwordx4 v6, s[16:19], s42 offen lds
buffer_store_dwordx4 v[92:95], v29, s[4:7], s69 offen offset:256 sc1
s_waitcnt lgkmcnt(2)
v_mfma_f32_32x32x16_bf16 v[176:191], v[84:87], a[136:139], v[176:191]
ds_read_b64_tr_b16 v[76:77], v11 offset:4096
ds_read_b64_tr_b16 v[78:79], v11 offset:5120
v_cvt_pk_bf16_f32 v88, v128, v129
v_mfma_f32_32x32x16_bf16 v[192:207], v[84:87], a[140:143], v[192:207]
buffer_load_dwordx4 v7, s[16:19], s42 offen offset:1024 lds
v_cvt_pk_bf16_f32 v89, v130, v131
s_waitcnt lgkmcnt(2)
v_mfma_f32_32x32x16_bf16 v[208:223], v[72:75], a[168:171], v[208:223]
s_waitcnt vmcnt(18)
ds_read_b64_tr_b16 v[80:81], v10 offset:6144
ds_read_b64_tr_b16 v[82:83], v10 offset:7168
v_cvt_pk_bf16_f32 v90, v132, v133
v_cvt_pk_bf16_f32 v91, v134, v135
v_mfma_f32_32x32x16_bf16 v[160:175], v[72:75], a[172:175], v[160:175]
s_add_u32 m0, s41, 2048
s_add_u32 s42, s42, 18432
buffer_load_dwordx4 v6, s[16:19], s42 offen lds
buffer_store_dwordx4 v[88:91], v30, s[4:7], s69 offen offset:512 sc1
s_waitcnt lgkmcnt(2)
v_mfma_f32_32x32x16_bf16 v[176:191], v[76:79], a[168:171], v[176:191]
ds_read_b64_tr_b16 v[84:85], v11 offset:6144
ds_read_b64_tr_b16 v[86:87], v11 offset:7168
v_cvt_pk_bf16_f32 v92, v144, v145
v_mfma_f32_32x32x16_bf16 v[192:207], v[76:79], a[172:175], v[192:207]
buffer_load_dwordx4 v7, s[16:19], s42 offen offset:1024 lds
v_cvt_pk_bf16_f32 v93, v146, v147
v_cvt_pk_bf16_f32 v94, v148, v149
s_waitcnt lgkmcnt(2)
v_mfma_f32_32x32x16_bf16 v[208:223], v[80:83], a[200:203], v[208:223]
s_waitcnt vmcnt(19)
ds_read_b64_tr_b16 v[72:73], v10 offset:8192
ds_read_b64_tr_b16 v[74:75], v10 offset:9216
v_cvt_pk_bf16_f32 v95, v150, v151
v_mfma_f32_32x32x16_bf16 v[160:175], v[80:83], a[204:207], v[160:175]
s_add_u32 m0, s41, 4096
s_add_u32 s42, s42, 18432
buffer_load_dwordx4 v6, s[16:19], s42 offen lds
buffer_store_dwordx4 v[92:95], v29, s[4:7], s69 offen offset:512 sc1
s_waitcnt lgkmcnt(2)
v_mfma_f32_32x32x16_bf16 v[176:191], v[84:87], a[200:203], v[176:191]
ds_read_b64_tr_b16 v[76:77], v11 offset:8192
ds_read_b64_tr_b16 v[78:79], v11 offset:9216
v_cvt_pk_bf16_f32 v88, v136, v137
v_mfma_f32_32x32x16_bf16 v[192:207], v[84:87], a[204:207], v[192:207]
buffer_load_dwordx4 v7, s[16:19], s42 offen offset:1024 lds
v_cvt_pk_bf16_f32 v89, v138, v139
v_cvt_pk_bf16_f32 v90, v140, v141
s_waitcnt lgkmcnt(2)
v_mfma_f32_32x32x16_bf16 v[208:223], v[72:75], a[232:235], v[208:223]
s_waitcnt vmcnt(20)
ds_read_b64_tr_b16 v[80:81], v10 offset:10240
ds_read_b64_tr_b16 v[82:83], v10 offset:11264
v_cvt_pk_bf16_f32 v91, v142, v143
v_mfma_f32_32x32x16_bf16 v[160:175], v[72:75], a[236:239], v[160:175]
s_add_u32 m0, s41, 6144
s_add_u32 s42, s42, 18432
buffer_load_dwordx4 v6, s[16:19], s42 offen lds
buffer_store_dwordx4 v[88:91], v30, s[4:7], s69 offen offset:768 sc1
s_waitcnt lgkmcnt(2)
v_mfma_f32_32x32x16_bf16 v[176:191], v[76:79], a[232:235], v[176:191]
ds_read_b64_tr_b16 v[84:85], v11 offset:10240
ds_read_b64_tr_b16 v[86:87], v11 offset:11264
v_cvt_pk_bf16_f32 v92, v152, v153
v_cvt_pk_bf16_f32 v93, v154, v155
v_mfma_f32_32x32x16_bf16 v[192:207], v[76:79], a[236:239], v[192:207]
buffer_load_dwordx4 v7, s[16:19], s42 offen offset:1024 lds
v_cvt_pk_bf16_f32 v94, v156, v157
s_waitcnt lgkmcnt(2)
v_mfma_f32_32x32x16_bf16 v[208:223], v[80:83], v[232:235], v[208:223]
s_waitcnt vmcnt(21)
ds_read_b64_tr_b16 v[72:73], v10 offset:12288
ds_read_b64_tr_b16 v[74:75], v10 offset:13312
v_cvt_pk_bf16_f32 v95, v158, v159
ds_read_b128 v[56:59], v12 offset:2048
v_mfma_f32_32x32x16_bf16 v[160:175], v[80:83], v[236:239], v[160:175]
s_add_u32 m0, s41, 8192
s_add_u32 s42, s56, s67
buffer_load_dwordx4 v6, s[16:19], s42 offen lds
buffer_store_dwordx4 v[92:95], v29, s[4:7], s69 offen offset:768 sc1
ds_read_b128 v[60:63], v12 offset:3072
s_waitcnt lgkmcnt(4)
v_mfma_f32_32x32x16_bf16 v[176:191], v[84:87], v[232:235], v[176:191]
ds_read_b64_tr_b16 v[76:77], v11 offset:12288
ds_read_b64_tr_b16 v[78:79], v11 offset:13312
v_mfma_f32_32x32x16_bf16 v[192:207], v[84:87], v[236:239], v[192:207]
buffer_load_dwordx4 v7, s[16:19], s42 offen offset:1024 lds
s_waitcnt lgkmcnt(2)
v_mfma_f32_32x32x16_bf16 v[208:223], v[32:35], v[56:59], v[208:223]
v_mfma_f32_32x32x16_bf16 v[160:175], v[32:35], v[60:63], v[160:175]
v_mfma_f32_32x32x16_bf16 v[176:191], v[36:39], v[56:59], v[176:191]
v_mfma_f32_32x32x16_bf16 v[192:207], v[36:39], v[60:63], v[192:207]
s_cmp_eq_u32 s26, 1
s_cbranch_scc0 Lsk_xq_24
ds_read_b128 v[64:67], v12 offset:10240
ds_read_b128 v[68:71], v12 offset:11264
s_waitcnt lgkmcnt(0)
v_mfma_f32_32x32x16_bf16 v[208:223], v[40:43], v[64:67], v[208:223]
v_mfma_f32_32x32x16_bf16 v[160:175], v[40:43], v[68:71], v[160:175]
v_mfma_f32_32x32x16_bf16 v[176:191], v[44:47], v[64:67], v[176:191]
v_mfma_f32_32x32x16_bf16 v[192:207], v[44:47], v[68:71], v[192:207]
Lsk_xq_24:
s_branch Lq2_j
Lq2_2:
v_mfma_f32_32x32x16_bf16 v[192:207], v[80:83], a[16:19], 0
s_waitcnt vmcnt(14)
ds_read_b64_tr_b16 v[72:73], v10 offset:16384
ds_read_b64_tr_b16 v[74:75], v10 offset:17408
v_mfma_f32_32x32x16_bf16 v[208:223], v[80:83], a[20:23], 0
s_add_u32 m0, s41, 12288
s_add_u32 s42, s54, s67
buffer_load_dwordx4 v6, s[16:19], s42 offen lds
v_mfma_f32_32x32x16_bf16 v[160:175], v[84:87], a[16:19], 0
ds_read_b64_tr_b16 v[76:77], v11 offset:16384
ds_read_b64_tr_b16 v[78:79], v11 offset:17408
v_mfma_f32_32x32x16_bf16 v[176:191], v[84:87], a[20:23], 0
buffer_load_dwordx4 v7, s[16:19], s42 offen offset:1024 lds
v_cvt_pk_bf16_f32 v88, v96, v97
v_cvt_pk_bf16_f32 v89, v98, v99
s_waitcnt lgkmcnt(2)
v_mfma_f32_32x32x16_bf16 v[192:207], v[72:75], a[48:51], v[192:207]
s_waitcnt vmcnt(14)
ds_read_b64_tr_b16 v[80:81], v10 offset:18432
ds_read_b64_tr_b16 v[82:83], v10 offset:19456
v_cvt_pk_bf16_f32 v90, v100, v101
v_mfma_f32_32x32x16_bf16 v[208:223], v[72:75], a[52:55], v[208:223]
s_add_u32 m0, s41, 14336
s_add_u32 s42, s42, 18432
buffer_load_dwordx4 v6, s[16:19], s42 offen lds
v_cvt_pk_bf16_f32 v91, v102, v103
s_waitcnt lgkmcnt(2)
v_mfma_f32_32x32x16_bf16 v[160:175], v[76:79], a[48:51], v[160:175]
ds_read_b64_tr_b16 v[84:85], v11 offset:18432
ds_read_b64_tr_b16 v[86:87], v11 offset:19456
buffer_store_dwordx4 v[88:91], v30, s[4:7], s69 offen offset:0 sc1
v_cvt_pk_bf16_f32 v92, v112, v113
v_mfma_f32_32x32x16_bf16 v[176:191], v[76:79], a[52:55], v[176:191]
buffer_load_dwordx4 v7, s[16:19], s42 offen offset:1024 lds
v_cvt_pk_bf16_f32 v93, v114, v115
s_waitcnt lgkmcnt(2)
v_mfma_f32_32x32x16_bf16 v[192:207], v[80:83], a[80:83], v[192:207]
s_waitcnt vmcnt(15)
ds_read_b64_tr_b16 v[72:73], v10 offset:0
ds_read_b64_tr_b16 v[74:75], v10 offset:1024
v_cvt_pk_bf16_f32 v94, v116, v117
v_mfma_f32_32x32x16_bf16 v[208:223], v[80:83], a[84:87], v[208:223]
s_add_u32 m0, s41, 16384
s_add_u32 s42, s42, 18432
buffer_load_dwordx4 v6, s[16:19], s42 offen lds
v_cvt_pk_bf16_f32 v95, v118, v119
buffer_store_dwordx4 v[92:95], v29, s[4:7], s69 offen offset:0 sc1
s_waitcnt lgkmcnt(2)
v_mfma_f32_32x32x16_bf16 v[160:175], v[84:87], a[80:83], v[160:175]
ds_read_b64_tr_b16 v[76:77], v11 offset:0
ds_read_b64_tr_b16 v[78:79], v11 offset:1024
v_cvt_pk_bf16_f32 v88, v104, v105
v_mfma_f32_32x32x16_bf16 v[176:191], v[84:87], a[84:87], v[176:191]
buffer_load_dwordx4 v7, s[16:19], s42 offen offset:1024 lds
v_cvt_pk_bf16_f32 v89, v106, v107
s_waitcnt lgkmcnt(2)
v_mfma_f32_32x32x16_bf16 v[192:207], v[72:75], a[112:115], v[192:207]
s_waitcnt vmcnt(16)
ds_read_b64_tr_b16 v[80:81], v10 offset:2048
ds_read_b64_tr_b16 v[82:83], v10 offset:3072
v_cvt_pk_bf16_f32 v90, v108, v109
v_mfma_f32_32x32x16_bf16 v[208:223], v[72:75], a[116:119], v[208:223]
s_add_u32 m0, s41, 18432
s_add_u32 s42, s42, 18432
buffer_load_dwordx4 v6, s[16:19], s42 offen lds
v_cvt_pk_bf16_f32 v91, v110, v111
buffer_store_dwordx4 v[88:91], v30, s[4:7], s69 offen offset:256 sc1
s_waitcnt lgkmcnt(2)
v_mfma_f32_32x32x16_bf16 v[160:175], v[76:79], a[112:115], v[160:175]
ds_read_b64_tr_b16 v[84:85], v11 offset:2048
ds_read_b64_tr_b16 v[86:87], v11 offset:3072
v_cvt_pk_bf16_f32 v92, v120, v121
v_mfma_f32_32x32x16_bf16 v[176:191], v[76:79], a[116:119], v[176:191]
buffer_load_dwordx4 v7, s[16:19], s42 offen offset:1024 lds
v_cvt_pk_bf16_f32 v93, v122, v123
s_waitcnt lgkmcnt(2)
v_mfma_f32_32x32x16_bf16 v[192:207], v[80:83], a[144:147], v[192:207]
s_waitcnt vmcnt(17)
ds_read_b64_tr_b16 v[72:73], v10 offset:4096
ds_read_b64_tr_b16 v[74:75], v10 offset:5120
v_cvt_pk_bf16_f32 v94, v124, v125
v_cvt_pk_bf16_f32 v95, v126, v127
v_mfma_f32_32x32x16_bf16 v[208:223], v[80:83], a[148:151], v[208:223]
s_add_u32 m0, s41, 0
s_add_u32 s42, s55, s67
buffer_load_dwordx4 v6, s[16:19], s42 offen lds
buffer_store_dwordx4 v[92:95], v29, s[4:7], s69 offen offset:256 sc1
s_waitcnt lgkmcnt(2)
v_mfma_f32_32x32x16_bf16 v[160:175], v[84:87], a[144:147], v[160:175]
ds_read_b64_tr_b16 v[76:77], v11 offset:4096
ds_read_b64_tr_b16 v[78:79], v11 offset:5120
v_cvt_pk_bf16_f32 v88, v128, v129
v_mfma_f32_32x32x16_bf16 v[176:191], v[84:87], a[148:151], v[176:191]
buffer_load_dwordx4 v7, s[16:19], s42 offen offset:1024 lds
v_cvt_pk_bf16_f32 v89, v130, v131
s_waitcnt lgkmcnt(2)
v_mfma_f32_32x32x16_bf16 v[192:207], v[72:75], a[176:179], v[192:207]
s_waitcnt vmcnt(18)
ds_read_b64_tr_b16 v[80:81], v10 offset:6144
ds_read_b64_tr_b16 v[82:83], v10 offset:7168
v_cvt_pk_bf16_f32 v90, v132, v133
v_cvt_pk_bf16_f32 v91, v134, v135
v_mfma_f32_32x32x16_bf16 v[208:223], v[72:75], a[180:183], v[208:223]
s_add_u32 m0, s41, 2048
s_add_u32 s42, s42, 18432
buffer_load_dwordx4 v6, s[16:19], s42 offen lds
buffer_store_dwordx4 v[88:91], v30, s[4:7], s69 offen offset:512 sc1
s_waitcnt lgkmcnt(2)
v_mfma_f32_32x32x16_bf16 v[160:175], v[76:79], a[176:179], v[160:175]
ds_read_b64_tr_b16 v[84:85], v11 offset:6144
ds_read_b64_tr_b16 v[86:87], v11 offset:7168
v_cvt_pk_bf16_f32 v92, v144, v145
v_mfma_f32_32x32x16_bf16 v[176:191], v[76:79], a[180:183], v[176:191]
buffer_load_dwordx4 v7, s[16:19], s42 offen offset:1024 lds
v_cvt_pk_bf16_f32 v93, v146, v147
v_cvt_pk_bf16_f32 v94, v148, v149
s_waitcnt lgkmcnt(2)
v_mfma_f32_32x32x16_bf16 v[192:207], v[80:83], a[208:211], v[192:207]
s_waitcnt vmcnt(19)
ds_read_b64_tr_b16 v[72:73], v10 offset:8192
ds_read_b64_tr_b16 v[74:75], v10 offset:9216
v_cvt_pk_bf16_f32 v95, v150, v151
v_mfma_f32_32x32x16_bf16 v[208:223], v[80:83], a[212:215], v[208:223]
s_add_u32 m0, s41, 4096
s_add_u32 s42, s42, 18432
buffer_load_dwordx4 v6, s[16:19], s42 offen lds
buffer_store_dwordx4 v[92:95], v29, s[4:7], s69 offen offset:512 sc1
s_waitcnt lgkmcnt(2)
v_mfma_f32_32x32x16_bf16 v[160:175], v[84:87], a[208:211], v[160:175]
ds_read_b64_tr_b16 v[76:77], v11 offset:8192
ds_read_b64_tr_b16 v[78:79], v11 offset:9216
v_cvt_pk_bf16_f32 v88, v136, v137
v_mfma_f32_32x32x16_bf16 v[176:191], v[84:87], a[212:215], v[176:191]
buffer_load_dwordx4 v7, s[16:19], s42 offen offset:1024 lds
v_cvt_pk_bf16_f32 v89, v138, v139
v_cvt_pk_bf16_f32 v90, v140, v141
s_waitcnt lgkmcnt(2)
v_mfma_f32_32x32x16_bf16 v[192:207], v[72:75], a[240:243], v[192:207]
s_waitcnt vmcnt(20)
ds_read_b64_tr_b16 v[80:81], v10 offset:10240
ds_read_b64_tr_b16 v[82:83], v10 offset:11264
v_cvt_pk_bf16_f32 v91, v142, v143
v_mfma_f32_32x32x16_bf16 v[208:223], v[72:75], a[244:247], v[208:223]
s_add_u32 m0, s41, 6144
s_add_u32 s42, s42, 18432
buffer_load_dwordx4 v6, s[16:19], s42 offen lds
buffer_store_dwordx4 v[88:91], v30, s[4:7], s69 offen offset:768 sc1
s_waitcnt lgkmcnt(2)
v_mfma_f32_32x32x16_bf16 v[160:175], v[76:79], a[240:243], v[160:175]
ds_read_b64_tr_b16 v[84:85], v11 offset:10240
ds_read_b64_tr_b16 v[86:87], v11 offset:11264
v_cvt_pk_bf16_f32 v92, v152, v153
v_cvt_pk_bf16_f32 v93, v154, v155
v_mfma_f32_32x32x16_bf16 v[176:191], v[76:79], a[244:247], v[176:191]
buffer_load_dwordx4 v7, s[16:19], s42 offen offset:1024 lds
v_cvt_pk_bf16_f32 v94, v156, v157
s_waitcnt lgkmcnt(2)
v_mfma_f32_32x32x16_bf16 v[192:207], v[80:83], v[240:243], v[192:207]
s_waitcnt vmcnt(21)
ds_read_b64_tr_b16 v[72:73], v10 offset:12288
ds_read_b64_tr_b16 v[74:75], v10 offset:13312
v_cvt_pk_bf16_f32 v95, v158, v159
ds_read_b128 v[56:59], v12 offset:4096
v_mfma_f32_32x32x16_bf16 v[208:223], v[80:83], v[244:247], v[208:223]
s_add_u32 m0, s41, 8192
s_add_u32 s42, s56, s67
buffer_load_dwordx4 v6, s[16:19], s42 offen lds
buffer_store_dwordx4 v[92:95], v29, s[4:7], s69 offen offset:768 sc1
ds_read_b128 v[60:63], v12 offset:5120
s_waitcnt lgkmcnt(4)
v_mfma_f32_32x32x16_bf16 v[160:175], v[84:87], v[240:243], v[160:175]
ds_read_b64_tr_b16 v[76:77], v11 offset:12288
ds_read_b64_tr_b16 v[78:79], v11 offset:13312
v_mfma_f32_32x32x16_bf16 v[176:191], v[84:87], v[244:247], v[176:191]
buffer_load_dwordx4 v7, s[16:19], s42 offen offset:1024 lds
s_waitcnt lgkmcnt(2)
v_mfma_f32_32x32x16_bf16 v[192:207], v[32:35], v[56:59], v[192:207]
v_mfma_f32_32x32x16_bf16 v[208:223], v[32:35], v[60:63], v[208:223]
v_mfma_f32_32x32x16_bf16 v[160:175], v[36:39], v[56:59], v[160:175]
v_mfma_f32_32x32x16_bf16 v[176:191], v[36:39], v[60:63], v[176:191]
s_branch Lq2_j
Lq2_3:
v_mfma_f32_32x32x16_bf16 v[176:191], v[80:83], a[24:27], 0
s_waitcnt vmcnt(14)
ds_read_b64_tr_b16 v[72:73], v10 offset:16384
ds_read_b64_tr_b16 v[74:75], v10 offset:17408
v_mfma_f32_32x32x16_bf16 v[192:207], v[80:83], a[28:31], 0
s_add_u32 m0, s41, 12288
s_add_u32 s42, s54, s67
buffer_load_dwordx4 v6, s[16:19], s42 offen lds
v_mfma_f32_32x32x16_bf16 v[208:223], v[84:87], a[24:27], 0
ds_read_b64_tr_b16 v[76:77], v11 offset:16384
ds_read_b64_tr_b16 v[78:79], v11 offset:17408
v_mfma_f32_32x32x16_bf16 v[160:175], v[84:87], a[28:31], 0
buffer_load_dwordx4 v7, s[16:19], s42 offen offset:1024 lds
v_cvt_pk_bf16_f32 v88, v96, v97
v_cvt_pk_bf16_f32 v89, v98, v99
s_waitcnt lgkmcnt(2)
v_mfma_f32_32x32x16_bf16 v[176:191], v[72:75], a[56:59], v[176:191]
s_waitcnt vmcnt(14)
ds_read_b64_tr_b16 v[80:81], v10 offset:18432
ds_read_b64_tr_b16 v[82:83], v10 offset:19456
v_cvt_pk_bf16_f32 v90, v100, v101
v_mfma_f32_32x32x16_bf16 v[192:207], v[72:75], a[60:63], v[192:207]
s_add_u32 m0, s41, 14336
s_add_u32 s42, s42, 18432
buffer_load_dwordx4 v6, s[16:19], s42 offen lds
v_cvt_pk_bf16_f32 v91, v102, v103
s_waitcnt lgkmcnt(2)
v_mfma_f32_32x32x16_bf16 v[208:223], v[76:79], a[56:59], v[208:223]
ds_read_b64_tr_b16 v[84:85], v11 offset:18432
ds_read_b64_tr_b16 v[86:87], v11 offset:19456
buffer_store_dwordx4 v[88:91], v30, s[4:7], s69 offen offset:0 sc1
v_cvt_pk_bf16_f32 v92, v112, v113
v_mfma_f32_32x32x16_bf16 v[160:175], v[76:79], a[60:63], v[160:175]
buffer_load_dwordx4 v7, s[16:19], s42 offen offset:1024 lds
v_cvt_pk_bf16_f32 v93, v114, v115
s_waitcnt lgkmcnt(2)
v_mfma_f32_32x32x16_bf16 v[176:191], v[80:83], a[88:91], v[176:191]
s_waitcnt vmcnt(15)
ds_read_b64_tr_b16 v[72:73], v10 offset:0
ds_read_b64_tr_b16 v[74:75], v10 offset:1024
v_cvt_pk_bf16_f32 v94, v116, v117
v_mfma_f32_32x32x16_bf16 v[192:207], v[80:83], a[92:95], v[192:207]
s_add_u32 m0, s41, 16384
s_add_u32 s42, s42, 18432
buffer_load_dwordx4 v6, s[16:19], s42 offen lds
v_cvt_pk_bf16_f32 v95, v118, v119
buffer_store_dwordx4 v[92:95], v29, s[4:7], s69 offen offset:0 sc1
s_waitcnt lgkmcnt(2)
v_mfma_f32_32x32x16_bf16 v[208:223], v[84:87], a[88:91], v[208:223]
ds_read_b64_tr_b16 v[76:77], v11 offset:0
ds_read_b64_tr_b16 v[78:79], v11 offset:1024
v_cvt_pk_bf16_f32 v88, v104, v105
v_mfma_f32_32x32x16_bf16 v[160:175], v[84:87], a[92:95], v[160:175]
buffer_load_dwordx4 v7, s[16:19], s42 offen offset:1024 lds
v_cvt_pk_bf16_f32 v89, v106, v107
s_waitcnt lgkmcnt(2)
v_mfma_f32_32x32x16_bf16 v[176:191], v[72:75], a[120:123], v[176:191]
s_waitcnt vmcnt(16)
ds_read_b64_tr_b16 v[80:81], v10 offset:2048
ds_read_b64_tr_b16 v[82:83], v10 offset:3072
v_cvt_pk_bf16_f32 v90, v108, v109
v_mfma_f32_32x32x16_bf16 v[192:207], v[72:75], a[124:127], v[192:207]
s_add_u32 m0, s41, 18432
s_add_u32 s42, s42, 18432
buffer_load_dwordx4 v6, s[16:19], s42 offen lds
v_cvt_pk_bf16_f32 v91, v110, v111
buffer_store_dwordx4 v[88:91], v30, s[4:7], s69 offen offset:256 sc1
s_waitcnt lgkmcnt(2)
v_mfma_f32_32x32x16_bf16 v[208:223], v[76:79], a[120:123], v[208:223]
ds_read_b64_tr_b16 v[84:85], v11 offset:2048
ds_read_b64_tr_b16 v[86:87], v11 offset:3072
v_cvt_pk_bf16_f32 v92, v120, v121
v_mfma_f32_32x32x16_bf16 v[160:175], v[76:79], a[124:127], v[160:175]
buffer_load_dwordx4 v7, s[16:19], s42 offen offset:1024 lds
v_cvt_pk_bf16_f32 v93, v122, v123
s_waitcnt lgkmcnt(2)
v_mfma_f32_32x32x16_bf16 v[176:191], v[80:83], a[152:155], v[176:191]
s_waitcnt vmcnt(17)
ds_read_b64_tr_b16 v[72:73], v10 offset:4096
ds_read_b64_tr_b16 v[74:75], v10 offset:5120
v_cvt_pk_bf16_f32 v94, v124, v125
v_cvt_pk_bf16_f32 v95, v126, v127
v_mfma_f32_32x32x16_bf16 v[192:207], v[80:83], a[156:159], v[192:207]
s_add_u32 m0, s41, 0
s_add_u32 s42, s55, s67
buffer_load_dwordx4 v6, s[16:19], s42 offen lds
buffer_store_dwordx4 v[92:95], v29, s[4:7], s69 offen offset:256 sc1
s_waitcnt lgkmcnt(2)
v_mfma_f32_32x32x16_bf16 v[208:223], v[84:87], a[152:155], v[208:223]
ds_read_b64_tr_b16 v[76:77], v11 offset:4096
ds_read_b64_tr_b16 v[78:79], v11 offset:5120
v_cvt_pk_bf16_f32 v88, v128, v129
v_mfma_f32_32x32x16_bf16 v[160:175], v[84:87], a[156:159], v[160:175]
buffer_load_dwordx4 v7, s[16:19], s42 offen offset:1024 lds
v_cvt_pk_bf16_f32 v89, v130, v131
s_waitcnt lgkmcnt(2)
v_mfma_f32_32x32x16_bf16 v[176:191], v[72:75], a[184:187], v[176:191]
s_waitcnt vmcnt(18)
ds_read_b64_tr_b16 v[80:81], v10 offset:6144
ds_read_b64_tr_b16 v[82:83], v10 offset:7168
v_cvt_pk_bf16_f32 v90, v132, v133
v_cvt_pk_bf16_f32 v91, v134, v135
v_mfma_f32_32x32x16_bf16 v[192:207], v[72:75], a[188:191], v[192:207]
s_add_u32 m0, s41, 2048
s_add_u32 s42, s42, 18432
buffer_load_dwordx4 v6, s[16:19], s42 offen lds
buffer_store_dwordx4 v[88:91], v30, s[4:7], s69 offen offset:512 sc1
s_waitcnt lgkmcnt(2)
v_mfma_f32_32x32x16_bf16 v[208:223], v[76:79], a[184:187], v[208:223]
ds_read_b64_tr_b16 v[84:85], v11 offset:6144
ds_read_b64_tr_b16 v[86:87], v11 offset:7168
v_cvt_pk_bf16_f32 v92, v144, v145
v_mfma_f32_32x32x16_bf16 v[160:175], v[76:79], a[188:191], v[160:175]
buffer_load_dwordx4 v7, s[16:19], s42 offen offset:1024 lds
v_cvt_pk_bf16_f32 v93, v146, v147
v_cvt_pk_bf16_f32 v94, v148, v149
s_waitcnt lgkmcnt(2)
v_mfma_f32_32x32x16_bf16 v[176:191], v[80:83], a[216:219], v[176:191]
s_waitcnt vmcnt(19)
ds_read_b64_tr_b16 v[72:73], v10 offset:8192
ds_read_b64_tr_b16 v[74:75], v10 offset:9216
v_cvt_pk_bf16_f32 v95, v150, v151
v_mfma_f32_32x32x16_bf16 v[192:207], v[80:83], a[220:223], v[192:207]
s_add_u32 m0, s41, 4096
s_add_u32 s42, s42, 18432
buffer_load_dwordx4 v6, s[16:19], s42 offen lds
buffer_store_dwordx4 v[92:95], v29, s[4:7], s69 offen offset:512 sc1
s_waitcnt lgkmcnt(2)
v_mfma_f32_32x32x16_bf16 v[208:223], v[84:87], a[216:219], v[208:223]
ds_read_b64_tr_b16 v[76:77], v11 offset:8192
ds_read_b64_tr_b16 v[78:79], v11 offset:9216
v_cvt_pk_bf16_f32 v88, v136, v137
v_mfma_f32_32x32x16_bf16 v[160:175], v[84:87], a[220:223], v[160:175]
buffer_load_dwordx4 v7, s[16:19], s42 offen offset:1024 lds
v_cvt_pk_bf16_f32 v89, v138, v139
v_cvt_pk_bf16_f32 v90, v140, v141
s_waitcnt lgkmcnt(2)
v_mfma_f32_32x32x16_bf16 v[176:191], v[72:75], a[248:251], v[176:191]
s_waitcnt vmcnt(20)
ds_read_b64_tr_b16 v[80:81], v10 offset:10240
ds_read_b64_tr_b16 v[82:83], v10 offset:11264
v_cvt_pk_bf16_f32 v91, v142, v143
v_mfma_f32_32x32x16_bf16 v[192:207], v[72:75], a[252:255], v[192:207]
s_add_u32 m0, s41, 6144
s_add_u32 s42, s42, 18432
buffer_load_dwordx4 v6, s[16:19], s42 offen lds
buffer_store_dwordx4 v[88:91], v30, s[4:7], s69 offen offset:768 sc1
s_waitcnt lgkmcnt(2)
v_mfma_f32_32x32x16_bf16 v[208:223], v[76:79], a[248:251], v[208:223]
ds_read_b64_tr_b16 v[84:85], v11 offset:10240
ds_read_b64_tr_b16 v[86:87], v11 offset:11264
v_cvt_pk_bf16_f32 v92, v152, v153
v_cvt_pk_bf16_f32 v93, v154, v155
v_mfma_f32_32x32x16_bf16 v[160:175], v[76:79], a[252:255], v[160:175]
buffer_load_dwordx4 v7, s[16:19], s42 offen offset:1024 lds
v_cvt_pk_bf16_f32 v94, v156, v157
s_waitcnt lgkmcnt(2)
v_mfma_f32_32x32x16_bf16 v[176:191], v[80:83], v[248:251], v[176:191]
s_waitcnt vmcnt(21)
ds_read_b64_tr_b16 v[72:73], v10 offset:12288
ds_read_b64_tr_b16 v[74:75], v10 offset:13312
v_cvt_pk_bf16_f32 v95, v158, v159
ds_read_b128 v[56:59], v12 offset:6144
v_mfma_f32_32x32x16_bf16 v[192:207], v[80:83], v[252:255], v[192:207]
s_add_u32 m0, s41, 8192
s_add_u32 s42, s56, s67
buffer_load_dwordx4 v6, s[16:19], s42 offen lds
buffer_store_dwordx4 v[92:95], v29, s[4:7], s69 offen offset:768 sc1
ds_read_b128 v[60:63], v12 offset:7168
s_waitcnt lgkmcnt(4)
v_mfma_f32_32x32x16_bf16 v[208:223], v[84:87], v[248:251], v[208:223]
ds_read_b64_tr_b16 v[76:77], v11 offset:12288
ds_read_b64_tr_b16 v[78:79], v11 offset:13312
v_mfma_f32_32x32x16_bf16 v[160:175], v[84:87], v[252:255], v[160:175]
buffer_load_dwordx4 v7, s[16:19], s42 offen offset:1024 lds
s_waitcnt lgkmcnt(2)
v_mfma_f32_32x32x16_bf16 v[176:191], v[32:35], v[56:59], v[176:191]
v_mfma_f32_32x32x16_bf16 v[192:207], v[32:35], v[60:63], v[192:207]
v_mfma_f32_32x32x16_bf16 v[208:223], v[36:39], v[56:59], v[208:223]
v_mfma_f32_32x32x16_bf16 v[160:175], v[36:39], v[60:63], v[160:175]
Lq2_j:
v_mfma_f32_32x32x16_bf16 v[96:111], v[72:75], a[0:3], 0
s_waitcnt vmcnt(21)
ds_read_b64_tr_b16 v[80:81], v10 offset:14336
ds_read_b64_tr_b16 v[82:83], v10 offset:15360
v_mfma_f32_32x32x16_bf16 v[112:127], v[72:75], a[4:7], 0
s_add_u32 m0, s41, 10240
s_add_u32 s42, s42, 18432
buffer_load_dwordx4 v6, s[16:19], s42 offen lds
s_nop 2
ds_write_b128 v16, v[176:179] offset:0
ds_write_b128 v16, v[180:183] offset:1024
s_waitcnt lgkmcnt(4)
v_mfma_f32_32x32x16_bf16 v[128:143], v[76:79], a[0:3], 0
ds_read_b64_tr_b16 v[84:85], v11 offset:14336
ds_read_b64_tr_b16 v[86:87], v11 offset:15360
ds_write_b128 v16, v[184:187] offset:2048
v_mfma_f32_32x32x16_bf16 v[144:159], v[76:79], a[4:7], 0
buffer_load_dwordx4 v7, s[16:19], s42 offen offset:1024 lds
ds_write_b128 v16, v[188:191] offset:3072
s_waitcnt lgkmcnt(6)
v_mfma_f32_32x32x16_bf16 v[96:111], v[80:83], a[8:11], v[96:111]
s_waitcnt vmcnt(20)
ds_read_b64_tr_b16 v[72:73], v10 offset:16384
ds_read_b64_tr_b16 v[74:75], v10 offset:17408
ds_write_b128 v17, v[192:195] offset:0
v_mfma_f32_32x32x16_bf16 v[112:127], v[80:83], a[12:15], v[112:127]
s_add_u32 m0, s41, 12288
s_add_u32 s42, s42, 18432
buffer_load_dwordx4 v6, s[16:19], s42 offen lds
ds_write_b128 v17, v[196:199] offset:1024
s_waitcnt lgkmcnt(6)
v_mfma_f32_32x32x16_bf16 v[128:143], v[84:87], a[8:11], v[128:143]
ds_read_b64_tr_b16 v[76:77], v11 offset:16384
ds_read_b64_tr_b16 v[78:79], v11 offset:17408
ds_write_b128 v17, v[200:203] offset:2048
v_mfma_f32_32x32x16_bf16 v[144:159], v[84:87], a[12:15], v[144:159]
buffer_load_dwordx4 v7, s[16:19], s42 offen offset:1024 lds
ds_write_b128 v17, v[204:207] offset:3072
s_waitcnt lgkmcnt(6)
v_mfma_f32_32x32x16_bf16 v[96:111], v[72:75], a[16:19], v[96:111]
s_waitcnt vmcnt(19)
ds_read_b64_tr_b16 v[80:81], v10 offset:18432
ds_read_b64_tr_b16 v[82:83], v10 offset:19456
ds_write_b128 v18, v[208:211] offset:0
v_mfma_f32_32x32x16_bf16 v[112:127], v[72:75], a[20:23], v[112:127]
s_add_u32 m0, s41, 14336
s_add_u32 s42, s42, 18432
buffer_load_dwordx4 v6, s[16:19], s42 offen lds
ds_write_b128 v18, v[212:215] offset:1024
s_waitcnt lgkmcnt(6)
v_mfma_f32_32x32x16_bf16 v[128:143], v[76:79], a[16:19], v[128:143]
ds_read_b64_tr_b16 v[84:85], v11 offset:18432
ds_read_b64_tr_b16 v[86:87], v11 offset:19456
ds_write_b128 v18, v[216:219] offset:2048
v_mfma_f32_32x32x16_bf16 v[144:159], v[76:79], a[20:23], v[144:159]
buffer_load_dwordx4 v7, s[16:19], s42 offen offset:1024 lds
ds_write_b128 v18, v[220:223] offset:3072
s_waitcnt lgkmcnt(6)
v_mfma_f32_32x32x16_bf16 v[96:111], v[80:83], a[24:27], v[96:111]
s_waitcnt vmcnt(18)
ds_read_b64_tr_b16 v[72:73], v10 offset:0
ds_read_b64_tr_b16 v[74:75], v10 offset:1024
v_mfma_f32_32x32x16_bf16 v[112:127], v[80:83], a[28:31], v[112:127]
s_add_u32 m0, s41, 16384
s_add_u32 s42, s57, s67
buffer_load_dwordx4 v6, s[16:19], s42 offen lds
s_waitcnt lgkmcnt(4)
v_mfma_f32_32x32x16_bf16 v[128:143], v[84:87], a[24:27], v[128:143]
ds_read_b64_tr_b16 v[76:77], v11 offset:0
ds_read_b64_tr_b16 v[78:79], v11 offset:1024
v_mfma_f32_32x32x16_bf16 v[144:159], v[84:87], a[28:31], v[144:159]
buffer_load_dwordx4 v7, s[16:19], s42 offen offset:1024 lds
s_waitcnt lgkmcnt(2)
v_mfma_f32_32x32x16_bf16 v[96:111], v[72:75], a[32:35], v[96:111]
s_waitcnt vmcnt(17)
ds_read_b64_tr_b16 v[80:81], v10 offset:2048
ds_read_b64_tr_b16 v[82:83], v10 offset:3072
v_mfma_f32_32x32x16_bf16 v[112:127], v[72:75], a[36:39], v[112:127]
s_add_u32 m0, s41, 18432
s_add_u32 s42, s42, 18432
buffer_load_dwordx4 v6, s[16:19], s42 offen lds
s_barrier
s_waitcnt lgkmcnt(2)
v_mfma_f32_32x32x16_bf16 v[128:143], v[76:79], a[32:35], v[128:143]
ds_read_b64_tr_b16 v[84:85], v11 offset:2048
ds_read_b64_tr_b16 v[86:87], v11 offset:3072
ds_read_b128 v[176:179], v19 offset:0
v_mfma_f32_32x32x16_bf16 v[144:159], v[76:79], a[36:39], v[144:159]
buffer_load_dwordx4 v7, s[16:19], s42 offen offset:1024 lds
ds_read_b128 v[180:183], v19 offset:1024
s_waitcnt lgkmcnt(4)
v_mfma_f32_32x32x16_bf16 v[96:111], v[80:83], a[40:43], v[96:111]
s_waitcnt vmcnt(16)
ds_read_b64_tr_b16 v[72:73], v10 offset:4096
ds_read_b64_tr_b16 v[74:75], v10 offset:5120
ds_read_b128 v[184:187], v19 offset:2048
v_mfma_f32_32x32x16_bf16 v[112:127], v[80:83], a[44:47], v[112:127]
s_add_u32 m0, s41, 0
s_add_u32 s42, s42, 18432
buffer_load_dwordx4 v6, s[16:19], s42 offen lds
ds_read_b128 v[188:191], v19 offset:3072
s_waitcnt lgkmcnt(6)
v_mfma_f32_32x32x16_bf16 v[128:143], v[84:87], a[40:43], v[128:143]
ds_read_b64_tr_b16 v[76:77], v11 offset:4096
ds_read_b64_tr_b16 v[78:79], v11 offset:5120
ds_read_b128 v[192:195], v19 offset:4096
v_mfma_f32_32x32x16_bf16 v[144:159], v[84:87], a[44:47], v[144:159]
buffer_load_dwordx4 v7, s[16:19], s42 offen offset:1024 lds
ds_read_b128 v[196:199], v19 offset:5120
s_waitcnt lgkmcnt(6)
v_mfma_f32_32x32x16_bf16 v[96:111], v[72:75], a[48:51], v[96:111]
s_waitcnt vmcnt(15)
ds_read_b64_tr_b16 v[80:81], v10 offset:6144
ds_read_b64_tr_b16 v[82:83], v10 offset:7168
ds_read_b128 v[200:203], v19 offset:6144
v_mfma_f32_32x32x16_bf16 v[112:127], v[72:75], a[52:55], v[112:127]
s_add_u32 m0, s41, 2048
s_add_u32 s42, s42, 18432
buffer_load_dwordx4 v6, s[16:19], s42 offen lds
ds_read_b128 v[204:207], v19 offset:7168
s_waitcnt lgkmcnt(6)
v_mfma_f32_32x32x16_bf16 v[128:143], v[76:79], a[48:51], v[128:143]
ds_read_b64_tr_b16 v[84:85], v11 offset:6144
ds_read_b64_tr_b16 v[86:87], v11 offset:7168
ds_read_b128 v[208:211], v19 offset:8192
v_mfma_f32_32x32x16_bf16 v[144:159], v[76:79], a[52:55], v[144:159]
buffer_load_dwordx4 v7, s[16:19], s42 offen offset:1024 lds
ds_read_b128 v[212:215], v19 offset:9216
s_waitcnt lgkmcnt(6)
v_mfma_f32_32x32x16_bf16 v[96:111], v[80:83], a[56:59], v[96:111]
s_waitcnt vmcnt(14)
ds_read_b64_tr_b16 v[72:73], v10 offset:8192
ds_read_b64_tr_b16 v[74:75], v10 offset:9216
ds_read_b128 v[216:219], v19 offset:10240
v_mfma_f32_32x32x16_bf16 v[112:127], v[80:83], a[60:63], v[112:127]
s_add_u32 m0, s41, 4096
s_add_u32 s42, s58, s67
buffer_load_dwordx4 v6, s[16:19], s42 offen lds
ds_read_b128 v[220:223], v19 offset:11264
s_waitcnt lgkmcnt(6)
v_mfma_f32_32x32x16_bf16 v[128:143], v[84:87], a[56:59], v[128:143]
ds_read_b64_tr_b16 v[76:77], v11 offset:8192
ds_read_b64_tr_b16 v[78:79], v11 offset:9216
v_mfma_f32_32x32x16_bf16 v[144:159], v[84:87], a[60:63], v[144:159]
buffer_load_dwordx4 v7, s[16:19], s42 offen offset:1024 lds
s_waitcnt lgkmcnt(4)
v_mfma_f32_32x32x16_bf16 v[96:111], v[72:75], a[64:67], v[96:111]
s_waitcnt vmcnt(14)
ds_read_b64_tr_b16 v[80:81], v10 offset:10240
ds_read_b64_tr_b16 v[82:83], v10 offset:11264
s_mov_b64 exec, 4
buffer_store_dword v25, v25, s[4:7], 0 offen sc1
s_mov_b64 exec, -1
v_add_f32 v160, v160, v176
v_add_f32 v161, v161, v177
v_mfma_f32_32x32x16_bf16 v[112:127], v[72:75], a[68:71], v[112:127]
s_add_u32 m0, s41, 6144
s_add_u32 s42, s42, 18432
buffer_load_dwordx4 v6, s[16:19], s42 offen lds
v_add_f32 v162, v162, v178
v_add_f32 v163, v163, v179
v_add_f32 v164, v164, v180
s_waitcnt lgkmcnt(2)
v_mfma_f32_32x32x16_bf16 v[128:143], v[76:79], a[64:67], v[128:143]
ds_read_b64_tr_b16 v[84:85], v11 offset:10240
ds_read_b64_tr_b16 v[86:87], v11 offset:11264
v_add_f32 v165, v165, v181
v_add_f32 v166, v166, v182
v_add_f32 v167, v167, v183
v_mfma_f32_32x32x16_bf16 v[144:159], v[76:79], a[68:71], v[144:159]
buffer_load_dwordx4 v7, s[16:19], s42 offen offset:1024 lds
v_add_f32 v168, v168, v184
v_add_f32 v169, v169, v185
v_add_f32 v170, v170, v186
s_waitcnt lgkmcnt(2)
v_mfma_f32_32x32x16_bf16 v[96:111], v[80:83], a[72:75], v[96:111]
s_waitcnt vmcnt(15)
ds_read_b64_tr_b16 v[72:73], v10 offset:12288
ds_read_b64_tr_b16 v[74:75], v10 offset:13312
v_add_f32 v171, v171, v187
v_add_f32 v172, v172, v188
v_add_f32 v173, v173, v189
v_mfma_f32_32x32x16_bf16 v[112:127], v[80:83], a[76:79], v[112:127]
s_add_u32 m0, s41, 8192
s_add_u32 s42, s42, 18432
buffer_load_dwordx4 v6, s[16:19], s42 offen lds
v_add_f32 v174, v174, v190
v_add_f32 v175, v175, v191
s_waitcnt lgkmcnt(2)
v_mfma_f32_32x32x16_bf16 v[128:143], v[84:87], a[72:75], v[128:143]
ds_read_b64_tr_b16 v[76:77], v11 offset:12288
ds_read_b64_tr_b16 v[78:79], v11 offset:13312
v_add_f32 v160, v160, v192
v_add_f32 v161, v161, v193
v_mfma_f32_32x32x16_bf16 v[144:159], v[84:87], a[76:79], v[144:159]
buffer_load_dwordx4 v7, s[16:19], s42 offen offset:1024 lds
v_add_f32 v162, v162, v194
v_add_f32 v163, v163, v195
v_add_f32 v164, v164, v196
s_waitcnt lgkmcnt(2)
v_mfma_f32_32x32x16_bf16 v[96:111], v[72:75], a[80:83], v[96:111]
s_waitcnt vmcnt(15)
ds_read_b64_tr_b16 v[80:81], v10 offset:14336
ds_read_b64_tr_b16 v[82:83], v10 offset:15360
v_add_f32 v165, v165, v197
v_add_f32 v166, v166, v198
v_add_f32 v167, v167, v199
v_mfma_f32_32x32x16_bf16 v[112:127], v[72:75], a[84:87], v[112:127]
s_add_u32 m0, s41, 10240
s_add_u32 s42, s42, 18432
buffer_load_dwordx4 v6, s[16:19], s42 offen lds
v_add_f32 v168, v168, v200
v_add_f32 v169, v169, v201
v_add_f32 v170, v170, v202
s_waitcnt lgkmcnt(2)
v_mfma_f32_32x32x16_bf16 v[128:143], v[76:79], a[80:83], v[128:143]
ds_read_b64_tr_b16 v[84:85], v11 offset:14336
ds_read_b64_tr_b16 v[86:87], v11 offset:15360
v_add_f32 v171, v171, v203
v_add_f32 v172, v172, v204
v_add_f32 v173, v173, v205
v_mfma_f32_32x32x16_bf16 v[144:159], v[76:79], a[84:87], v[144:159]
buffer_load_dwordx4 v7, s[16:19], s42 offen offset:1024 lds
v_add_f32 v174, v174, v206
v_add_f32 v175, v175, v207
s_waitcnt lgkmcnt(2)
v_mfma_f32_32x32x16_bf16 v[96:111], v[80:83], a[88:91], v[96:111]
s_waitcnt vmcnt(15)
ds_read_b64_tr_b16 v[72:73], v10 offset:16384
ds_read_b64_tr_b16 v[74:75], v10 offset:17408
v_add_f32 v160, v160, v208
v_add_f32 v161, v161, v209
v_mfma_f32_32x32x16_bf16 v[112:127], v[80:83], a[92:95], v[112:127]
s_add_u32 m0, s41, 12288
s_add_u32 s42, s59, s67
buffer_load_dwordx4 v6, s[16:19], s42 offen lds
v_add_f32 v162, v162, v210
v_add_f32 v163, v163, v211
v_add_f32 v164, v164, v212
s_waitcnt lgkmcnt(2)
v_mfma_f32_32x32x16_bf16 v[128:143], v[84:87], a[88:91], v[128:143]
ds_read_b64_tr_b16 v[76:77], v11 offset:16384
ds_read_b64_tr_b16 v[78:79], v11 offset:17408
v_add_f32 v165, v165, v213
v_add_f32 v166, v166, v214
v_add_f32 v167, v167, v215
v_mfma_f32_32x32x16_bf16 v[144:159], v[84:87], a[92:95], v[144:159]
buffer_load_dwordx4 v7, s[16:19], s42 offen offset:1024 lds
v_add_f32 v168, v168, v216
v_add_f32 v169, v169, v217
v_add_f32 v170, v170, v218
s_waitcnt lgkmcnt(2)
v_mfma_f32_32x32x16_bf16 v[96:111], v[72:75], a[96:99], v[96:111]
s_waitcnt vmcnt(15)
ds_read_b64_tr_b16 v[80:81], v10 offset:18432
ds_read_b64_tr_b16 v[82:83], v10 offset:19456
v_add_f32 v171, v171, v219
v_add_f32 v172, v172, v220
v_add_f32 v173, v173, v221
v_mfma_f32_32x32x16_bf16 v[112:127], v[72:75], a[100:103], v[112:127]
s_add_u32 m0, s41, 14336
s_add_u32 s42, s42, 18432
buffer_load_dwordx4 v6, s[16:19], s42 offen lds
v_add_f32 v174, v174, v222
v_add_f32 v175, v175, v223
s_waitcnt lgkmcnt(2)
v_mfma_f32_32x32x16_bf16 v[128:143], v[76:79], a[96:99], v[128:143]
ds_read_b64_tr_b16 v[84:85], v11 offset:18432
ds_read_b64_tr_b16 v[86:87], v11 offset:19456
v_cvt_pk_bf16_f32 v88, v160, v161
v_cvt_pk_bf16_f32 v89, v162, v163
v_mfma_f32_32x32x16_bf16 v[144:159], v[76:79], a[100:103], v[144:159]
buffer_load_dwordx4 v7, s[16:19], s42 offen offset:1024 lds
v_cvt_pk_bf16_f32 v90, v164, v165
v_cvt_pk_bf16_f32 v91, v166, v167
s_waitcnt lgkmcnt(2)
v_mfma_f32_32x32x16_bf16 v[96:111], v[80:83], a[104:107], v[96:111]
s_waitcnt vmcnt(15)
ds_read_b64_tr_b16 v[72:73], v10 offset:0
ds_read_b64_tr_b16 v[74:75], v10 offset:1024
buffer_store_dwordx4 v[88:91], v30, s[4:7], s71 offen offset:0 sc1
v_mfma_f32_32x32x16_bf16 v[112:127], v[80:83], a[108:111], v[112:127]
s_add_u32 m0, s41, 16384
s_add_u32 s42, s42, 18432
buffer_load_dwordx4 v6, s[16:19], s42 offen lds
v_cvt_pk_bf16_f32 v92, v168, v169
v_cvt_pk_bf16_f32 v93, v170, v171
s_waitcnt lgkmcnt(2)
v_mfma_f32_32x32x16_bf16 v[128:143], v[84:87], a[104:107], v[128:143]
ds_read_b64_tr_b16 v[76:77], v11 offset:0
ds_read_b64_tr_b16 v[78:79], v11 offset:1024
v_cvt_pk_bf16_f32 v94, v172, v173
v_cvt_pk_bf16_f32 v95, v174, v175
v_mfma_f32_32x32x16_bf16 v[144:159], v[84:87], a[108:111], v[144:159]
buffer_load_dwordx4 v7, s[16:19], s42 offen offset:1024 lds
buffer_store_dwordx4 v[92:95], v30, s[4:7], s71 offen offset:256 sc1
s_waitcnt lgkmcnt(2)
v_mfma_f32_32x32x16_bf16 v[96:111], v[72:75], a[112:115], v[96:111]
s_waitcnt vmcnt(17)
ds_read_b64_tr_b16 v[80:81], v10 offset:2048
ds_read_b64_tr_b16 v[82:83], v10 offset:3072
v_mfma_f32_32x32x16_bf16 v[112:127], v[72:75], a[116:119], v[112:127]
s_add_u32 m0, s41, 18432
s_add_u32 s42, s42, 18432
buffer_load_dwordx4 v6, s[16:19], s42 offen lds
s_waitcnt lgkmcnt(2)
v_mfma_f32_32x32x16_bf16 v[128:143], v[76:79], a[112:115], v[128:143]
ds_read_b64_tr_b16 v[84:85], v11 offset:2048
ds_read_b64_tr_b16 v[86:87], v11 offset:3072
v_mfma_f32_32x32x16_bf16 v[144:159], v[76:79], a[116:119], v[144:159]
buffer_load_dwordx4 v7, s[16:19], s42 offen offset:1024 lds
s_waitcnt lgkmcnt(2)
v_mfma_f32_32x32x16_bf16 v[96:111], v[80:83], a[120:123], v[96:111]
s_waitcnt vmcnt(17)
ds_read_b64_tr_b16 v[72:73], v10 offset:4096
ds_read_b64_tr_b16 v[74:75], v10 offset:5120
v_and_b32 v50, 7, v1
v_lshlrev_b32 v50, 2, v50
v_mfma_f32_32x32x16_bf16 v[112:127], v[80:83], a[124:127], v[112:127]
s_add_u32 m0, s41, 0
s_add_u32 s42, s60, s67
buffer_load_dwordx4 v6, s[16:19], s42 offen lds
s_mul_i32 s22, s37, 52224
s_waitcnt lgkmcnt(2)
v_mfma_f32_32x32x16_bf16 v[128:143], v[84:87], a[120:123], v[128:143]
ds_read_b64_tr_b16 v[76:77], v11 offset:4096
ds_read_b64_tr_b16 v[78:79], v11 offset:5120
s_mul_i32 s3, s38, 4352
s_add_u32 s23, s22, s3
v_mfma_f32_32x32x16_bf16 v[144:159], v[84:87], a[124:127], v[144:159]
buffer_load_dwordx4 v7, s[16:19], s42 offen offset:1024 lds
s_add_u32 s23, s23, 25329664
s_waitcnt lgkmcnt(2)
v_mfma_f32_32x32x16_bf16 v[96:111], v[72:75], a[128:131], v[96:111]
s_waitcnt vmcnt(16)
ds_read_b64_tr_b16 v[80:81], v10 offset:6144
ds_read_b64_tr_b16 v[82:83], v10 offset:7168
s_lshl_b32 s3, s37, 3
v_mfma_f32_32x32x16_bf16 v[112:127], v[72:75], a[132:135], v[112:127]
s_add_u32 m0, s41, 2048
s_add_u32 s42, s42, 18432
buffer_load_dwordx4 v6, s[16:19], s42 offen lds
s_add_u32 s3, s3, s36
s_mul_i32 s24, s3, 73728
s_waitcnt lgkmcnt(2)
v_mfma_f32_32x32x16_bf16 v[128:143], v[76:79], a[128:131], v[128:143]
ds_read_b64_tr_b16 v[84:85], v11 offset:6144
ds_read_b64_tr_b16 v[86:87], v11 offset:7168
s_lshl_b32 s3, s36, 8
v_mfma_f32_32x32x16_bf16 v[144:159], v[76:79], a[132:135], v[144:159]
buffer_load_dwordx4 v7, s[16:19], s42 offen offset:1024 lds
s_add_u32 s3, s3, s37
s_waitcnt lgkmcnt(2)
v_mfma_f32_32x32x16_bf16 v[96:111], v[80:83], a[136:139], v[96:111]
s_waitcnt vmcnt(16)
ds_read_b64_tr_b16 v[72:73], v10 offset:8192
ds_read_b64_tr_b16 v[74:75], v10 offset:9216
s_mul_i32 s25, s3, 1152
v_mul_u32_u24 v51, 9216, v50
v_mfma_f32_32x32x16_bf16 v[112:127], v[80:83], a[140:143], v[112:127]
s_add_u32 m0, s41, 4096
s_add_u32 s42, s42, 18432
buffer_load_dwordx4 v6, s[16:19], s42 offen lds
v_lshrrev_b32 v52, 3, v1
s_waitcnt lgkmcnt(2)
v_mfma_f32_32x32x16_bf16 v[128:143], v[84:87], a[136:139], v[128:143]
ds_read_b64_tr_b16 v[76:77], v11 offset:8192
ds_read_b64_tr_b16 v[78:79], v11 offset:9216
v_lshl_add_u32 v51, v52, 4, v51
v_mfma_f32_32x32x16_bf16 v[144:159], v[84:87], a[140:143], v[144:159]
buffer_load_dwordx4 v7, s[16:19], s42 offen offset:1024 lds
s_and_b32 s3, s38, 2
s_lshr_b32 s43, s36, 2
s_waitcnt lgkmcnt(2)
v_mfma_f32_32x32x16_bf16 v[96:111], v[72:75], a[144:147], v[96:111]
s_waitcnt vmcnt(16)
ds_read_b64_tr_b16 v[80:81], v10 offset:10240
ds_read_b64_tr_b16 v[82:83], v10 offset:11264
s_add_u32 s3, s3, s43
v_mfma_f32_32x32x16_bf16 v[112:127], v[72:75], a[148:151], v[112:127]
s_add_u32 m0, s41, 6144
s_add_u32 s42, s42, 18432
buffer_load_dwordx4 v6, s[16:19], s42 offen lds
s_mul_i32 s3, s3, 4352
s_waitcnt lgkmcnt(2)
v_mfma_f32_32x32x16_bf16 v[128:143], v[76:79], a[144:147], v[128:143]
ds_read_b64_tr_b16 v[84:85], v11 offset:10240
ds_read_b64_tr_b16 v[86:87], v11 offset:11264
s_add_u32 s22, s22, s3
s_add_u32 s22, s22, 25347072
v_mfma_f32_32x32x16_bf16 v[144:159], v[76:79], a[148:151], v[144:159]
buffer_load_dwordx4 v7, s[16:19], s42 offen offset:1024 lds
s_lshl_b32 s3, s66, 3
s_waitcnt lgkmcnt(2)
v_mfma_f32_32x32x16_bf16 v[96:111], v[80:83], a[152:155], v[96:111]
s_waitcnt vmcnt(16)
ds_read_b64_tr_b16 v[72:73], v10 offset:12288
ds_read_b64_tr_b16 v[74:75], v10 offset:13312
s_waitcnt vmcnt(10)
s_mov_b64 exec, 8
buffer_store_dword v25, v25, s[4:7], 0 offen sc1
s_mov_b64 exec, -1
s_add_u32 s27, s24, s3
v_mfma_f32_32x32x16_bf16 v[112:127], v[80:83], a[156:159], v[112:127]
s_add_u32 m0, s41, 8192
s_add_u32 s42, s61, s67
buffer_load_dwordx4 v6, s[16:19], s42 offen lds
s_lshl_b32 s3, s97, 3
s_add_u32 s28, s24, s3
s_waitcnt lgkmcnt(2)
v_mfma_f32_32x32x16_bf16 v[128:143], v[84:87], a[152:155], v[128:143]
ds_read_b64_tr_b16 v[76:77], v11 offset:12288
ds_read_b64_tr_b16 v[78:79], v11 offset:13312
s_lshl_b32 s3, s38, 8
v_mfma_f32_32x32x16_bf16 v[144:159], v[84:87], a[156:159], v[144:159]
buffer_load_dwordx4 v7, s[16:19], s42 offen offset:1024 lds
s_add_u32 s28, s28, s3
s_waitcnt lgkmcnt(2)
v_mfma_f32_32x32x16_bf16 v[96:111], v[72:75], a[160:163], v[96:111]
ds_read_b64_tr_b16 v[80:81], v10 offset:14336
ds_read_b64_tr_b16 v[82:83], v10 offset:15360
v_mfma_f32_32x32x16_bf16 v[112:127], v[72:75], a[164:167], v[112:127]
s_add_u32 m0, s41, 10240
s_add_u32 s42, s42, 18432
buffer_load_dwordx4 v6, s[16:19], s42 offen lds
s_waitcnt lgkmcnt(2)
v_mfma_f32_32x32x16_bf16 v[128:143], v[76:79], a[160:163], v[128:143]
ds_read_b64_tr_b16 v[84:85], v11 offset:14336
ds_read_b64_tr_b16 v[86:87], v11 offset:15360
v_mfma_f32_32x32x16_bf16 v[144:159], v[76:79], a[164:167], v[144:159]
buffer_load_dwordx4 v7, s[16:19], s42 offen offset:1024 lds
s_waitcnt lgkmcnt(2)
v_mfma_f32_32x32x16_bf16 v[96:111], v[80:83], a[168:171], v[96:111]
ds_read_b64_tr_b16 v[72:73], v10 offset:16384
ds_read_b64_tr_b16 v[74:75], v10 offset:17408
v_mfma_f32_32x32x16_bf16 v[112:127], v[80:83], a[172:175], v[112:127]
s_add_u32 m0, s41, 12288
s_add_u32 s42, s42, 18432
buffer_load_dwordx4 v6, s[16:19], s42 offen lds
s_waitcnt lgkmcnt(2)
v_mfma_f32_32x32x16_bf16 v[128:143], v[84:87], a[168:171], v[128:143]
ds_read_b64_tr_b16 v[76:77], v11 offset:16384
ds_read_b64_tr_b16 v[78:79], v11 offset:17408
v_mfma_f32_32x32x16_bf16 v[144:159], v[84:87], a[172:175], v[144:159]
buffer_load_dwordx4 v7, s[16:19], s42 offen offset:1024 lds
s_waitcnt lgkmcnt(2)
v_mfma_f32_32x32x16_bf16 v[96:111], v[72:75], a[176:179], v[96:111]
s_waitcnt vmcnt(15)
ds_read_b64_tr_b16 v[80:81], v10 offset:18432
ds_read_b64_tr_b16 v[82:83], v10 offset:19456
v_mfma_f32_32x32x16_bf16 v[112:127], v[72:75], a[180:183], v[112:127]
s_add_u32 m0, s41, 14336
s_add_u32 s42, s42, 18432
buffer_load_dwordx4 v6, s[16:19], s42 offen lds
s_waitcnt lgkmcnt(2)
v_mfma_f32_32x32x16_bf16 v[128:143], v[76:79], a[176:179], v[128:143]
ds_read_b64_tr_b16 v[84:85], v11 offset:18432
ds_read_b64_tr_b16 v[86:87], v11 offset:19456
v_mfma_f32_32x32x16_bf16 v[144:159], v[76:79], a[180:183], v[144:159]
buffer_load_dwordx4 v7, s[16:19], s42 offen offset:1024 lds
s_waitcnt lgkmcnt(2)
v_mfma_f32_32x32x16_bf16 v[96:111], v[80:83], a[184:187], v[96:111]
s_waitcnt vmcnt(15)
ds_read_b64_tr_b16 v[72:73], v10 offset:0
ds_read_b64_tr_b16 v[74:75], v10 offset:1024
v_mfma_f32_32x32x16_bf16 v[112:127], v[80:83], a[188:191], v[112:127]
s_add_u32 m0, s41, 16384
s_add_u32 s42, s62, s67
buffer_load_dwordx4 v6, s[16:19], s42 offen lds
s_waitcnt lgkmcnt(2)
v_mfma_f32_32x32x16_bf16 v[128:143], v[84:87], a[184:187], v[128:143]
ds_read_b64_tr_b16 v[76:77], v11 offset:0
ds_read_b64_tr_b16 v[78:79], v11 offset:1024
v_mfma_f32_32x32x16_bf16 v[144:159], v[84:87], a[188:191], v[144:159]
buffer_load_dwordx4 v7, s[16:19], s42 offen offset:1024 lds
s_waitcnt lgkmcnt(2)
v_mfma_f32_32x32x16_bf16 v[96:111], v[72:75], a[192:195], v[96:111]
s_waitcnt vmcnt(15)
ds_read_b64_tr_b16 v[80:81], v10 offset:2048
ds_read_b64_tr_b16 v[82:83], v10 offset:3072
v_mfma_f32_32x32x16_bf16 v[112:127], v[72:75], a[196:199], v[112:127]
s_add_u32 m0, s41, 18432
s_add_u32 s42, s42, 18432
buffer_load_dwordx4 v6, s[16:19], s42 offen lds
s_waitcnt lgkmcnt(2)
v_mfma_f32_32x32x16_bf16 v[128:143], v[76:79], a[192:195], v[128:143]
ds_read_b64_tr_b16 v[84:85], v11 offset:2048
ds_read_b64_tr_b16 v[86:87], v11 offset:3072
v_mfma_f32_32x32x16_bf16 v[144:159], v[76:79], a[196:199], v[144:159]
buffer_load_dwordx4 v7, s[16:19], s42 offen offset:1024 lds
s_waitcnt lgkmcnt(2)
v_mfma_f32_32x32x16_bf16 v[96:111], v[80:83], a[200:203], v[96:111]
s_waitcnt vmcnt(15)
ds_read_b64_tr_b16 v[72:73], v10 offset:4096
ds_read_b64_tr_b16 v[74:75], v10 offset:5120
v_mfma_f32_32x32x16_bf16 v[112:127], v[80:83], a[204:207], v[112:127]
s_add_u32 m0, s41, 0
s_add_u32 s42, s42, 18432
buffer_load_dwordx4 v6, s[16:19], s42 offen lds
s_waitcnt lgkmcnt(2)
v_mfma_f32_32x32x16_bf16 v[128:143], v[84:87], a[200:203], v[128:143]
ds_read_b64_tr_b16 v[76:77], v11 offset:4096
ds_read_b64_tr_b16 v[78:79], v11 offset:5120
v_mfma_f32_32x32x16_bf16 v[144:159], v[84:87], a[204:207], v[144:159]
buffer_load_dwordx4 v7, s[16:19], s42 offen offset:1024 lds
s_waitcnt lgkmcnt(2)
v_mfma_f32_32x32x16_bf16 v[96:111], v[72:75], a[208:211], v[96:111]
s_waitcnt vmcnt(15)
ds_read_b64_tr_b16 v[80:81], v10 offset:6144
ds_read_b64_tr_b16 v[82:83], v10 offset:7168
v_mfma_f32_32x32x16_bf16 v[112:127], v[72:75], a[212:215], v[112:127]
s_add_u32 m0, s41, 2048
s_add_u32 s42, s42, 18432
buffer_load_dwordx4 v6, s[16:19], s42 offen lds
s_waitcnt lgkmcnt(2)
v_mfma_f32_32x32x16_bf16 v[128:143], v[76:79], a[208:211], v[128:143]
ds_read_b64_tr_b16 v[84:85], v11 offset:6144
ds_read_b64_tr_b16 v[86:87], v11 offset:7168
v_mfma_f32_32x32x16_bf16 v[144:159], v[76:79], a[212:215], v[144:159]
buffer_load_dwordx4 v7, s[16:19], s42 offen offset:1024 lds
s_waitcnt lgkmcnt(2)
v_mfma_f32_32x32x16_bf16 v[96:111], v[80:83], a[216:219], v[96:111]
s_waitcnt vmcnt(14)
ds_read_b64_tr_b16 v[72:73], v10 offset:8192
ds_read_b64_tr_b16 v[74:75], v10 offset:9216
v_mfma_f32_32x32x16_bf16 v[112:127], v[80:83], a[220:223], v[112:127]
s_waitcnt lgkmcnt(2)
v_mfma_f32_32x32x16_bf16 v[128:143], v[84:87], a[216:219], v[128:143]
ds_read_b64_tr_b16 v[76:77], v11 offset:8192
ds_read_b64_tr_b16 v[78:79], v11 offset:9216
buffer_load_dword v53, v50, s[4:7], s23 offen sc1
v_mfma_f32_32x32x16_bf16 v[144:159], v[84:87], a[220:223], v[144:159]
buffer_load_dword v54, v50, s[4:7], s22 offen sc1
s_waitcnt lgkmcnt(2)
v_mfma_f32_32x32x16_bf16 v[96:111], v[72:75], a[224:227], v[96:111]
s_waitcnt vmcnt(14)
ds_read_b64_tr_b16 v[80:81], v10 offset:10240
ds_read_b64_tr_b16 v[82:83], v10 offset:11264
s_lshl_b32 s43, s36, 5
s_add_u32 s43, s43, 574
s_lshr_b32 s3, s67, 1
v_mfma_f32_32x32x16_bf16 v[112:127], v[72:75], a[228:231], v[112:127]
v_add_u32 v64, s3, v22
v_add_u32 v65, 32, v64
s_waitcnt lgkmcnt(2)
v_mfma_f32_32x32x16_bf16 v[128:143], v[76:79], a[224:227], v[128:143]
ds_read_b64_tr_b16 v[84:85], v11 offset:10240
ds_read_b64_tr_b16 v[86:87], v11 offset:11264
v_mul_u32_u24 v66, s43, v64
v_add_u32 v67, v66, v64
v_mfma_f32_32x32x16_bf16 v[144:159], v[76:79], a[228:231], v[144:159]
v_mul_hi_u32 v68, v66, s100
v_mul_hi_u32 v69, v67, s100
v_mul_hi_u32 v70, v64, s100
s_waitcnt lgkmcnt(2)
v_mfma_f32_32x32x16_bf16 v[96:111], v[80:83], a[232:235], v[96:111]
s_waitcnt vmcnt(12)
ds_read_b64_tr_b16 v[72:73], v10 offset:12288
ds_read_b64_tr_b16 v[74:75], v10 offset:13312
v_mul_u32_u24 v68, s101, v68
v_mul_u32_u24 v69, s101, v69
v_mfma_f32_32x32x16_bf16 v[112:127], v[80:83], a[236:239], v[112:127]
v_mul_u32_u24 v70, s101, v70
v_sub_u32 v68, v66, v68
s_waitcnt lgkmcnt(2)
v_mfma_f32_32x32x16_bf16 v[128:143], v[84:87], a[232:235], v[128:143]
ds_read_b64_tr_b16 v[76:77], v11 offset:12288
ds_read_b64_tr_b16 v[78:79], v11 offset:13312
v_sub_u32 v69, v67, v69
v_sub_u32 v70, v64, v70
v_mfma_f32_32x32x16_bf16 v[144:159], v[84:87], a[236:239], v[144:159]
v_cvt_f32_u32 v68, v68
v_cvt_f32_u32 v69, v69
v_cvt_f32_u32 v70, v70
s_waitcnt lgkmcnt(2)
v_mfma_f32_32x32x16_bf16 v[96:111], v[72:75], a[240:243], v[96:111]
s_waitcnt vmcnt(10)
ds_read_b64_tr_b16 v[80:81], v10 offset:14336
ds_read_b64_tr_b16 v[82:83], v10 offset:15360
v_fmamk_f32 v68, v68, 0x3ae38e39, v23
v_fmamk_f32 v69, v69, 0x3ae38e39, v23
v_mfma_f32_32x32x16_bf16 v[112:127], v[72:75], a[244:247], v[112:127]
v_mul_f32 v70, 0x3ae38e39, v70
v_cos_f32 v214, v68
s_waitcnt lgkmcnt(2)
v_mfma_f32_32x32x16_bf16 v[128:143], v[76:79], a[240:243], v[128:143]
ds_read_b64_tr_b16 v[84:85], v11 offset:14336
ds_read_b64_tr_b16 v[86:87], v11 offset:15360
v_cos_f32 v215, v69
v_cos_f32 v20, v70
v_mul_u32_u24 v66, s43, v65
v_mfma_f32_32x32x16_bf16 v[144:159], v[76:79], a[244:247], v[144:159]
v_add_u32 v67, v66, v65
v_mul_hi_u32 v68, v66, s100
s_waitcnt lgkmcnt(2)
v_mfma_f32_32x32x16_bf16 v[96:111], v[80:83], a[248:251], v[96:111]
s_waitcnt vmcnt(8)
ds_read_b64_tr_b16 v[72:73], v10 offset:16384
ds_read_b64_tr_b16 v[74:75], v10 offset:17408
v_mul_hi_u32 v69, v67, s100
v_mul_hi_u32 v70, v65, s100
v_mfma_f32_32x32x16_bf16 v[112:127], v[80:83], a[252:255], v[112:127]
v_mul_u32_u24 v68, s101, v68
v_mul_u32_u24 v69, s101, v69
s_waitcnt lgkmcnt(2)
v_mfma_f32_32x32x16_bf16 v[128:143], v[84:87], a[248:251], v[128:143]
ds_read_b64_tr_b16 v[76:77], v11 offset:16384
ds_read_b64_tr_b16 v[78:79], v11 offset:17408
v_mul_u32_u24 v70, s101, v70
v_sub_u32 v68, v66, v68
v_sub_u32 v69, v67, v69
v_mfma_f32_32x32x16_bf16 v[144:159], v[84:87], a[252:255], v[144:159]
v_sub_u32 v70, v65, v70
v_cvt_f32_u32 v68, v68
s_waitcnt lgkmcnt(2)
v_mfma_f32_32x32x16_bf16 v[96:111], v[72:75], v[224:227], v[96:111]
s_waitcnt vmcnt(6)
ds_read_b64_tr_b16 v[80:81], v10 offset:18432
ds_read_b64_tr_b16 v[82:83], v10 offset:19456
v_cvt_f32_u32 v69, v69
v_cvt_f32_u32 v70, v70
s_waitcnt vmcnt(0)
v_cmp_eq_u32 vcc, 0, v53
v_cmp_eq_u32 s[30:31], 0, v54
s_or_b64 vcc, vcc, s[30:31]
s_cbranch_scc1 Lsp_A
Lbk_A:
v_mfma_f32_32x32x16_bf16 v[112:127], v[72:75], v[228:231], v[112:127]
v_fmamk_f32 v68, v68, 0x3ae38e39, v23
v_fmamk_f32 v69, v69, 0x3ae38e39, v23
v_mul_f32 v70, 0x3ae38e39, v70
buffer_load_dwordx4 v[176:179], v12, s[4:7], s27 offen sc1
s_add_u32 s27, s27, 9216
s_waitcnt lgkmcnt(2)
v_mfma_f32_32x32x16_bf16 v[128:143], v[76:79], v[224:227], v[128:143]
ds_read_b64_tr_b16 v[84:85], v11 offset:18432
ds_read_b64_tr_b16 v[86:87], v11 offset:19456
v_cos_f32 v222, v68
v_cos_f32 v223, v69
v_mfma_f32_32x32x16_bf16 v[144:159], v[76:79], v[228:231], v[144:159]
v_cos_f32 v21, v70
v_add_f32 v20, v20, v20
buffer_load_dwordx4 v[180:183], v12, s[4:7], s27 offen sc1
s_add_u32 s27, s27, 9216
s_waitcnt lgkmcnt(2)
v_mfma_f32_32x32x16_bf16 v[96:111], v[80:83], v[232:235], v[96:111]
ds_read_b64_tr_b16 v[72:73], v10 offset:0
ds_read_b64_tr_b16 v[74:75], v10 offset:1024
v_add_f32 v21, v21, v21
v_fma_f32 v208, v20, v215, -v214
v_mfma_f32_32x32x16_bf16 v[112:127], v[80:83], v[236:239], v[112:127]
v_fma_f32 v216, v21, v223, -v222
v_fma_f32 v209, v20, v208, -v215
v_fma_f32 v217, v21, v216, -v223
buffer_load_dwordx4 v[184:187], v12, s[4:7], s27 offen sc1
s_add_u32 s27, s27, 9216
s_waitcnt lgkmcnt(2)
v_mfma_f32_32x32x16_bf16 v[128:143], v[84:87], v[232:235], v[128:143]
ds_read_b64_tr_b16 v[76:77], v11 offset:0
ds_read_b64_tr_b16 v[78:79], v11 offset:1024
s_cmp_eq_u32 s36, 0
s_cselect_b64 vcc, -1, 0
v_cndmask_b32 v71, v208, v24, vcc
v_cvt_pk_bf16_f32 v160, v71, v209
s_cmp_eq_u32 s36, 0
s_cselect_b64 vcc, -1, 0
v_cndmask_b32 v71, v216, v24, vcc
v_cvt_pk_bf16_f32 v164, v71, v217
v_mfma_f32_32x32x16_bf16 v[144:159], v[84:87], v[236:239], v[144:159]
v_fma_f32 v210, v20, v209, -v208
v_fma_f32 v218, v21, v217, -v216
buffer_load_dwordx4 v[188:191], v12, s[4:7], s27 offen sc1
s_add_u32 s27, s27, 9216
s_waitcnt lgkmcnt(2)
v_mfma_f32_32x32x16_bf16 v[96:111], v[72:75], v[240:243], v[96:111]
ds_read_b64_tr_b16 v[80:81], v10 offset:2048
ds_read_b64_tr_b16 v[82:83], v10 offset:3072
v_fma_f32 v211, v20, v210, -v209
v_fma_f32 v219, v21, v218, -v217
v_cvt_pk_bf16_f32 v161, v210, v211
buffer_load_dwordx4 v[192:195], v12, s[4:7], s27 offen sc1
s_add_u32 s27, s27, 9216
v_mfma_f32_32x32x16_bf16 v[112:127], v[72:75], v[244:247], v[112:127]
v_cvt_pk_bf16_f32 v165, v218, v219
v_fma_f32 v212, v20, v211, -v210
s_waitcnt lgkmcnt(2)
v_mfma_f32_32x32x16_bf16 v[128:143], v[76:79], v[240:243], v[128:143]
ds_read_b64_tr_b16 v[84:85], v11 offset:2048
ds_read_b64_tr_b16 v[86:87], v11 offset:3072
v_fma_f32 v220, v21, v219, -v218
v_fma_f32 v213, v20, v212, -v211
buffer_load_dwordx4 v[196:199], v12, s[4:7], s27 offen sc1
s_add_u32 s27, s27, 9216
v_mfma_f32_32x32x16_bf16 v[144:159], v[76:79], v[244:247], v[144:159]
v_fma_f32 v221, v21, v220, -v219
v_cvt_pk_bf16_f32 v162, v212, v213
s_waitcnt lgkmcnt(2)
v_mfma_f32_32x32x16_bf16 v[96:111], v[80:83], v[248:251], v[96:111]
v_cvt_pk_bf16_f32 v166, v220, v221
v_fma_f32 v214, v20, v213, -v212
v_fma_f32 v222, v21, v221, -v220
buffer_load_dwordx4 v[200:203], v12, s[4:7], s27 offen sc1
s_add_u32 s27, s27, 9216
v_mfma_f32_32x32x16_bf16 v[112:127], v[80:83], v[252:255], v[112:127]
v_fma_f32 v215, v20, v214, -v213
v_fma_f32 v223, v21, v222, -v221
s_waitcnt lgkmcnt(0)
v_mfma_f32_32x32x16_bf16 v[128:143], v[84:87], v[248:251], v[128:143]
v_cvt_pk_bf16_f32 v163, v214, v215
v_cvt_pk_bf16_f32 v167, v222, v223
buffer_load_dwordx4 v[204:207], v12, s[4:7], s27 offen sc1
s_add_u32 s27, s27, 9216
v_mfma_f32_32x32x16_bf16 v[144:159], v[84:87], v[252:255], v[144:159]
ds_read_b128 v[56:59], v12 offset:0
ds_read_b128 v[60:63], v12 offset:1024
s_waitcnt lgkmcnt(0)
v_mfma_f32_32x32x16_bf16 v[96:111], v[160:163], v[56:59], v[96:111]
ds_read_b128 v[64:67], v12 offset:2048
ds_read_b128 v[68:71], v12 offset:3072
v_fma_f32 v208, v20, v215, -v214
v_fma_f32 v216, v21, v223, -v222
v_fma_f32 v209, v20, v208, -v215
v_fma_f32 v217, v21, v216, -v223
v_cvt_pk_bf16_f32 v168, v208, v209
v_mfma_f32_32x32x16_bf16 v[112:127], v[160:163], v[60:63], v[112:127]
v_cvt_pk_bf16_f32 v172, v216, v217
v_fma_f32 v210, v20, v209, -v208
v_fma_f32 v218, v21, v217, -v216
v_fma_f32 v211, v20, v210, -v209
v_fma_f32 v219, v21, v218, -v217
v_cvt_pk_bf16_f32 v169, v210, v211
v_cvt_pk_bf16_f32 v173, v218, v219
v_mfma_f32_32x32x16_bf16 v[128:143], v[164:167], v[56:59], v[128:143]
v_fma_f32 v212, v20, v211, -v210
v_fma_f32 v220, v21, v219, -v218
v_fma_f32 v213, v20, v212, -v211
v_fma_f32 v221, v21, v220, -v219
v_cvt_pk_bf16_f32 v170, v212, v213
v_cvt_pk_bf16_f32 v174, v220, v221
v_fma_f32 v214, v20, v213, -v212
v_mfma_f32_32x32x16_bf16 v[144:159], v[164:167], v[60:63], v[144:159]
v_fma_f32 v222, v21, v221, -v220
v_fma_f32 v215, v20, v214, -v213
v_fma_f32 v223, v21, v222, -v221
v_cvt_pk_bf16_f32 v171, v214, v215
v_cvt_pk_bf16_f32 v175, v222, v223
s_mov_b64 exec, 0xffff
buffer_load_dwordx4 v[224:227], v12, s[4:7], s28 offen sc1
s_add_u32 s28, s28, 9216
buffer_load_dwordx4 v[228:231], v12, s[4:7], s28 offen sc1
s_add_u32 s28, s28, 9216
buffer_load_dwordx4 v[232:235], v12, s[4:7], s28 offen sc1
s_add_u32 s28, s28, 9216
buffer_load_dwordx4 v[236:239], v12, s[4:7], s28 offen sc1
s_add_u32 s28, s28, 9216
buffer_load_dwordx4 v[240:243], v12, s[4:7], s28 offen sc1
s_add_u32 s28, s28, 9216
buffer_load_dwordx4 v[244:247], v12, s[4:7], s28 offen sc1
s_add_u32 s28, s28, 9216
buffer_load_dwordx4 v[248:251], v12, s[4:7], s28 offen sc1
s_add_u32 s28, s28, 9216
buffer_load_dwordx4 v[252:255], v12, s[4:7], s28 offen sc1
s_add_u32 s28, s28, 9216
s_mov_b64 exec, -1
s_waitcnt lgkmcnt(0)
v_mfma_f32_32x32x16_bf16 v[96:111], v[168:171], v[64:67], v[96:111]
ds_read_b128 v[56:59], v12 offset:4096
ds_read_b128 v[60:63], v12 offset:5120
v_fma_f32 v208, v20, v215, -v214
v_fma_f32 v216, v21, v223, -v222
v_fma_f32 v209, v20, v208, -v215
v_fma_f32 v217, v21, v216, -v223
v_cvt_pk_bf16_f32 v160, v208, v209
v_mfma_f32_32x32x16_bf16 v[112:127], v[168:171], v[68:71], v[112:127]
v_cvt_pk_bf16_f32 v164, v216, v217
v_fma_f32 v210, v20, v209, -v208
v_fma_f32 v218, v21, v217, -v216
v_fma_f32 v211, v20, v210, -v209
v_fma_f32 v219, v21, v218, -v217
v_cvt_pk_bf16_f32 v161, v210, v211
v_mfma_f32_32x32x16_bf16 v[128:143], v[172:175], v[64:67], v[128:143]
v_cvt_pk_bf16_f32 v165, v218, v219
v_fma_f32 v212, v20, v211, -v210
v_fma_f32 v220, v21, v219, -v218
v_fma_f32 v213, v20, v212, -v211
v_fma_f32 v221, v21, v220, -v219
v_cvt_pk_bf16_f32 v162, v212, v213
v_cvt_pk_bf16_f32 v166, v220, v221
v_mfma_f32_32x32x16_bf16 v[144:159], v[172:175], v[68:71], v[144:159]
v_fma_f32 v214, v20, v213, -v212
v_fma_f32 v222, v21, v221, -v220
v_fma_f32 v215, v20, v214, -v213
v_fma_f32 v223, v21, v222, -v221
v_cvt_pk_bf16_f32 v163, v214, v215
v_cvt_pk_bf16_f32 v167, v222, v223
s_waitcnt lgkmcnt(0)
v_mfma_f32_32x32x16_bf16 v[96:111], v[160:163], v[56:59], v[96:111]
ds_read_b128 v[64:67], v12 offset:6144
ds_read_b128 v[68:71], v12 offset:7168
v_fma_f32 v208, v20, v215, -v214
v_fma_f32 v216, v21, v223, -v222
v_fma_f32 v209, v20, v208, -v215
v_fma_f32 v217, v21, v216, -v223
v_cvt_pk_bf16_f32 v168, v208, v209
v_mfma_f32_32x32x16_bf16 v[112:127], v[160:163], v[60:63], v[112:127]
v_cvt_pk_bf16_f32 v172, v216, v217
v_fma_f32 v210, v20, v209, -v208
v_fma_f32 v218, v21, v217, -v216
v_fma_f32 v211, v20, v210, -v209
v_fma_f32 v219, v21, v218, -v217
v_cvt_pk_bf16_f32 v169, v210, v211
v_mfma_f32_32x32x16_bf16 v[128:143], v[164:167], v[56:59], v[128:143]
v_cvt_pk_bf16_f32 v173, v218, v219
v_fma_f32 v212, v20, v211, -v210
v_fma_f32 v220, v21, v219, -v218
v_fma_f32 v213, v20, v212, -v211
v_fma_f32 v221, v21, v220, -v219
v_cvt_pk_bf16_f32 v170, v212, v213
v_cvt_pk_bf16_f32 v174, v220, v221
v_mfma_f32_32x32x16_bf16 v[144:159], v[164:167], v[60:63], v[144:159]
v_fma_f32 v214, v20, v213, -v212
v_fma_f32 v222, v21, v221, -v220
v_fma_f32 v215, v20, v214, -v213
v_fma_f32 v223, v21, v222, -v221
v_cvt_pk_bf16_f32 v171, v214, v215
v_cvt_pk_bf16_f32 v175, v222, v223
s_waitcnt lgkmcnt(0)
v_mfma_f32_32x32x16_bf16 v[96:111], v[168:171], v[64:67], v[96:111]
v_mfma_f32_32x32x16_bf16 v[112:127], v[168:171], v[68:71], v[112:127]
v_mfma_f32_32x32x16_bf16 v[128:143], v[172:175], v[64:67], v[128:143]
v_mfma_f32_32x32x16_bf16 v[144:159], v[172:175], v[68:71], v[144:159]
s_cmp_eq_u32 s26, 1
s_cbranch_scc0 Lsk_xb_25
s_lshl_b32 s43, s36, 4
s_add_u32 s43, s43, 766
s_lshr_b32 s3, s67, 1
v_add_u32 v64, s3, v22
v_add_u32 v65, 32, v64
v_mul_u32_u24 v66, s43, v64
v_add_u32 v67, v66, v64
v_mul_hi_u32 v68, v66, s100
v_mul_hi_u32 v69, v67, s100
v_mul_hi_u32 v70, v64, s100
v_mul_u32_u24 v68, s101, v68
v_mul_u32_u24 v69, s101, v69
v_mul_u32_u24 v70, s101, v70
v_sub_u32 v68, v66, v68
v_sub_u32 v69, v67, v69
v_sub_u32 v70, v64, v70
v_cvt_f32_u32 v68, v68
v_cvt_f32_u32 v69, v69
v_cvt_f32_u32 v70, v70
v_fmamk_f32 v68, v68, 0x3ae38e39, v23
v_fmamk_f32 v69, v69, 0x3ae38e39, v23
v_mul_f32 v70, 0x3ae38e39, v70
v_cos_f32 v214, v68
v_cos_f32 v215, v69
v_cos_f32 v20, v70
v_mul_u32_u24 v66, s43, v65
v_add_u32 v67, v66, v65
v_mul_hi_u32 v68, v66, s100
v_mul_hi_u32 v69, v67, s100
v_mul_hi_u32 v70, v65, s100
v_mul_u32_u24 v68, s101, v68
v_mul_u32_u24 v69, s101, v69
v_mul_u32_u24 v70, s101, v70
v_sub_u32 v68, v66, v68
v_sub_u32 v69, v67, v69
v_sub_u32 v70, v65, v70
v_cvt_f32_u32 v68, v68
v_cvt_f32_u32 v69, v69
v_cvt_f32_u32 v70, v70
v_fmamk_f32 v68, v68, 0x3ae38e39, v23
v_fmamk_f32 v69, v69, 0x3ae38e39, v23
v_mul_f32 v70, 0x3ae38e39, v70
v_cos_f32 v222, v68
v_cos_f32 v223, v69
v_cos_f32 v21, v70
v_add_f32 v20, v20, v20
v_add_f32 v21, v21, v21
ds_read_b128 v[64:67], v12 offset:8192
ds_read_b128 v[68:71], v12 offset:9216
v_fma_f32 v208, v20, v215, -v214
v_fma_f32 v216, v21, v223, -v222
v_fma_f32 v209, v20, v208, -v215
v_fma_f32 v217, v21, v216, -v223
v_cvt_pk_bf16_f32 v160, v208, v209
v_cvt_pk_bf16_f32 v164, v216, v217
v_fma_f32 v210, v20, v209, -v208
v_fma_f32 v218, v21, v217, -v216
v_fma_f32 v211, v20, v210, -v209
v_fma_f32 v219, v21, v218, -v217
v_cvt_pk_bf16_f32 v161, v210, v211
v_cvt_pk_bf16_f32 v165, v218, v219
v_fma_f32 v212, v20, v211, -v210
v_fma_f32 v220, v21, v219, -v218
v_fma_f32 v213, v20, v212, -v211
v_fma_f32 v221, v21, v220, -v219
v_cvt_pk_bf16_f32 v162, v212, v213
v_cvt_pk_bf16_f32 v166, v220, v221
v_fma_f32 v214, v20, v213, -v212
v_fma_f32 v222, v21, v221, -v220
v_fma_f32 v215, v20, v214, -v213
v_fma_f32 v223, v21, v222, -v221
v_cvt_pk_bf16_f32 v163, v214, v215
v_cvt_pk_bf16_f32 v167, v222, v223
s_waitcnt lgkmcnt(0)
v_mfma_f32_32x32x16_bf16 v[96:111], v[160:163], v[64:67], v[96:111]
v_mfma_f32_32x32x16_bf16 v[112:127], v[160:163], v[68:71], v[112:127]
v_mfma_f32_32x32x16_bf16 v[128:143], v[164:167], v[64:67], v[128:143]
v_mfma_f32_32x32x16_bf16 v[144:159], v[164:167], v[68:71], v[144:159]
ds_read_b128 v[56:59], v12 offset:10240
ds_read_b128 v[60:63], v12 offset:11264
v_fma_f32 v208, v20, v215, -v214
v_fma_f32 v216, v21, v223, -v222
v_fma_f32 v209, v20, v208, -v215
v_fma_f32 v217, v21, v216, -v223
v_cvt_pk_bf16_f32 v168, v208, v209
v_cvt_pk_bf16_f32 v172, v216, v217
v_fma_f32 v210, v20, v209, -v208
v_fma_f32 v218, v21, v217, -v216
v_fma_f32 v211, v20, v210, -v209
v_fma_f32 v219, v21, v218, -v217
v_cvt_pk_bf16_f32 v169, v210, v211
v_cvt_pk_bf16_f32 v173, v218, v219
v_fma_f32 v212, v20, v211, -v210
v_fma_f32 v220, v21, v219, -v218
v_fma_f32 v213, v20, v212, -v211
v_fma_f32 v221, v21, v220, -v219
v_cvt_pk_bf16_f32 v170, v212, v213
v_cvt_pk_bf16_f32 v174, v220, v221
v_fma_f32 v214, v20, v213, -v212
v_fma_f32 v222, v21, v221, -v220
v_fma_f32 v215, v20, v214, -v213
v_fma_f32 v223, v21, v222, -v221
v_cvt_pk_bf16_f32 v171, v214, v215
v_cvt_pk_bf16_f32 v175, v222, v223
s_waitcnt lgkmcnt(0)
v_mfma_f32_32x32x16_bf16 v[96:111], v[168:171], v[56:59], v[96:111]
v_mfma_f32_32x32x16_bf16 v[112:127], v[168:171], v[60:63], v[112:127]
v_mfma_f32_32x32x16_bf16 v[128:143], v[172:175], v[56:59], v[128:143]
v_mfma_f32_32x32x16_bf16 v[144:159], v[172:175], v[60:63], v[144:159]
Lsk_xb_25:
s_nop 8
v_cvt_pk_bf16_f32 v88, v96, v97
v_cvt_pk_bf16_f32 v89, v98, v99
v_cvt_pk_bf16_f32 v90, v100, v101
v_cvt_pk_bf16_f32 v91, v102, v103
buffer_store_dwordx4 v[88:91], v30, s[4:7], s70 offen offset:0 sc1
v_cvt_pk_bf16_f32 v92, v112, v113
v_cvt_pk_bf16_f32 v93, v114, v115
v_cvt_pk_bf16_f32 v94, v116, v117
v_cvt_pk_bf16_f32 v95, v118, v119
buffer_store_dwordx4 v[92:95], v29, s[4:7], s70 offen offset:0 sc1
v_cvt_pk_bf16_f32 v88, v104, v105
v_cvt_pk_bf16_f32 v89, v106, v107
v_cvt_pk_bf16_f32 v90, v108, v109
v_cvt_pk_bf16_f32 v91, v110, v111
buffer_store_dwordx4 v[88:91], v30, s[4:7], s70 offen offset:256 sc1
v_cvt_pk_bf16_f32 v92, v120, v121
v_cvt_pk_bf16_f32 v93, v122, v123
v_cvt_pk_bf16_f32 v94, v124, v125
v_cvt_pk_bf16_f32 v95, v126, v127
buffer_store_dwordx4 v[92:95], v29, s[4:7], s70 offen offset:256 sc1
v_cvt_pk_bf16_f32 v88, v128, v129
v_cvt_pk_bf16_f32 v89, v130, v131
v_cvt_pk_bf16_f32 v90, v132, v133
v_cvt_pk_bf16_f32 v91, v134, v135
buffer_store_dwordx4 v[88:91], v30, s[4:7], s70 offen offset:512 sc1
v_cvt_pk_bf16_f32 v92, v144, v145
v_cvt_pk_bf16_f32 v93, v146, v147
v_cvt_pk_bf16_f32 v94, v148, v149
v_cvt_pk_bf16_f32 v95, v150, v151
buffer_store_dwordx4 v[92:95], v29, s[4:7], s70 offen offset:512 sc1
v_cvt_pk_bf16_f32 v88, v136, v137
v_cvt_pk_bf16_f32 v89, v138, v139
v_cvt_pk_bf16_f32 v90, v140, v141
v_cvt_pk_bf16_f32 v91, v142, v143
buffer_store_dwordx4 v[88:91], v30, s[4:7], s70 offen offset:768 sc1
v_cvt_pk_bf16_f32 v92, v152, v153
v_cvt_pk_bf16_f32 v93, v154, v155
v_cvt_pk_bf16_f32 v94, v156, v157
v_cvt_pk_bf16_f32 v95, v158, v159
buffer_store_dwordx4 v[92:95], v29, s[4:7], s70 offen offset:768 sc1
s_waitcnt vmcnt(23)
v_dot2_f32_bf16 v40, v176, s20, 0
v_dot2_f32_bf16 v41, v176, s21, 0
v_dot2_f32_bf16 v42, v177, s20, 0
v_dot2_f32_bf16 v43, v177, s21, 0
v_dot2_f32_bf16 v44, v178, s20, 0
v_dot2_f32_bf16 v45, v178, s21, 0
v_dot2_f32_bf16 v46, v179, s20, 0
v_dot2_f32_bf16 v47, v179, s21, 0
s_waitcnt vmcnt(22)
v_dot2_f32_bf16 v40, v180, s20, v40
v_dot2_f32_bf16 v41, v180, s21, v41
v_dot2_f32_bf16 v42, v181, s20, v42
v_dot2_f32_bf16 v43, v181, s21, v43
v_dot2_f32_bf16 v44, v182, s20, v44
v_dot2_f32_bf16 v45, v182, s21, v45
v_dot2_f32_bf16 v46, v183, s20, v46
v_dot2_f32_bf16 v47, v183, s21, v47
s_waitcnt vmcnt(21)
v_dot2_f32_bf16 v40, v184, s20, v40
v_dot2_f32_bf16 v41, v184, s21, v41
v_dot2_f32_bf16 v42, v185, s20, v42
v_dot2_f32_bf16 v43, v185, s21, v43
v_dot2_f32_bf16 v44, v186, s20, v44
v_dot2_f32_bf16 v45, v186, s21, v45
v_dot2_f32_bf16 v46, v187, s20, v46
v_dot2_f32_bf16 v47, v187, s21, v47
s_waitcnt vmcnt(20)
v_dot2_f32_bf16 v40, v188, s20, v40
v_dot2_f32_bf16 v41, v188, s21, v41
v_dot2_f32_bf16 v42, v189, s20, v42
v_dot2_f32_bf16 v43, v189, s21, v43
v_dot2_f32_bf16 v44, v190, s20, v44
v_dot2_f32_bf16 v45, v190, s21, v45
v_dot2_f32_bf16 v46, v191, s20, v46
v_dot2_f32_bf16 v47, v191, s21, v47
s_waitcnt vmcnt(19)
v_dot2_f32_bf16 v40, v192, s20, v40
v_dot2_f32_bf16 v41, v192, s21, v41
v_dot2_f32_bf16 v42, v193, s20, v42
v_dot2_f32_bf16 v43, v193, s21, v43
v_dot2_f32_bf16 v44, v194, s20, v44
v_dot2_f32_bf16 v45, v194, s21, v45
v_dot2_f32_bf16 v46, v195, s20, v46
v_dot2_f32_bf16 v47, v195, s21, v47
s_waitcnt vmcnt(18)
v_dot2_f32_bf16 v40, v196, s20, v40
v_dot2_f32_bf16 v41, v196, s21, v41
v_dot2_f32_bf16 v42, v197, s20, v42
v_dot2_f32_bf16 v43, v197, s21, v43
v_dot2_f32_bf16 v44, v198, s20, v44
v_dot2_f32_bf16 v45, v198, s21, v45
v_dot2_f32_bf16 v46, v199, s20, v46
v_dot2_f32_bf16 v47, v199, s21, v47
s_waitcnt vmcnt(17)
v_dot2_f32_bf16 v40, v200, s20, v40
v_dot2_f32_bf16 v41, v200, s21, v41
v_dot2_f32_bf16 v42, v201, s20, v42
v_dot2_f32_bf16 v43, v201, s21, v43
v_dot2_f32_bf16 v44, v202, s20, v44
v_dot2_f32_bf16 v45, v202, s21, v45
v_dot2_f32_bf16 v46, v203, s20, v46
v_dot2_f32_bf16 v47, v203, s21, v47
s_waitcnt vmcnt(16)
v_dot2_f32_bf16 v40, v204, s20, v40
v_dot2_f32_bf16 v41, v204, s21, v41
v_dot2_f32_bf16 v42, v205, s20, v42
v_dot2_f32_bf16 v43, v205, s21, v43
v_dot2_f32_bf16 v44, v206, s20, v44
v_dot2_f32_bf16 v45, v206, s21, v45
v_dot2_f32_bf16 v46, v207, s20, v46
v_dot2_f32_bf16 v47, v207, s21, v47
v_cvt_pk_bf16_f32 v40, v40, v41
v_cvt_pk_bf16_f32 v41, v42, v43
v_cvt_pk_bf16_f32 v42, v44, v45
v_cvt_pk_bf16_f32 v43, v46, v47
s_add_u32 s3, s25, s66
buffer_store_dwordx4 v[40:43], v51, s[32:35], s3 offen
s_waitcnt vmcnt(16)
v_dot2_f32_bf16 v56, v224, s20, 0
v_dot2_f32_bf16 v57, v224, s21, 0
v_dot2_f32_bf16 v58, v225, s20, 0
v_dot2_f32_bf16 v59, v225, s21, 0
v_dot2_f32_bf16 v60, v226, s20, 0
v_dot2_f32_bf16 v61, v226, s21, 0
v_dot2_f32_bf16 v62, v227, s20, 0
v_dot2_f32_bf16 v63, v227, s21, 0
s_waitcnt vmcnt(15)
v_dot2_f32_bf16 v56, v228, s20, v56
v_dot2_f32_bf16 v57, v228, s21, v57
v_dot2_f32_bf16 v58, v229, s20, v58
v_dot2_f32_bf16 v59, v229, s21, v59
v_dot2_f32_bf16 v60, v230, s20, v60
v_dot2_f32_bf16 v61, v230, s21, v61
v_dot2_f32_bf16 v62, v231, s20, v62
v_dot2_f32_bf16 v63, v231, s21, v63
s_waitcnt vmcnt(14)
v_dot2_f32_bf16 v56, v232, s20, v56
v_dot2_f32_bf16 v57, v232, s21, v57
v_dot2_f32_bf16 v58, v233, s20, v58
v_dot2_f32_bf16 v59, v233, s21, v59
v_dot2_f32_bf16 v60, v234, s20, v60
v_dot2_f32_bf16 v61, v234, s21, v61
v_dot2_f32_bf16 v62, v235, s20, v62
v_dot2_f32_bf16 v63, v235, s21, v63
s_waitcnt vmcnt(13)
v_dot2_f32_bf16 v56, v236, s20, v56
v_dot2_f32_bf16 v57, v236, s21, v57
v_dot2_f32_bf16 v58, v237, s20, v58
v_dot2_f32_bf16 v59, v237, s21, v59
v_dot2_f32_bf16 v60, v238, s20, v60
v_dot2_f32_bf16 v61, v238, s21, v61
v_dot2_f32_bf16 v62, v239, s20, v62
v_dot2_f32_bf16 v63, v239, s21, v63
s_waitcnt vmcnt(12)
v_dot2_f32_bf16 v56, v240, s20, v56
v_dot2_f32_bf16 v57, v240, s21, v57
v_dot2_f32_bf16 v58, v241, s20, v58
v_dot2_f32_bf16 v59, v241, s21, v59
v_dot2_f32_bf16 v60, v242, s20, v60
v_dot2_f32_bf16 v61, v242, s21, v61
v_dot2_f32_bf16 v62, v243, s20, v62
v_dot2_f32_bf16 v63, v243, s21, v63
s_waitcnt vmcnt(11)
v_dot2_f32_bf16 v56, v244, s20, v56
v_dot2_f32_bf16 v57, v244, s21, v57
v_dot2_f32_bf16 v58, v245, s20, v58
v_dot2_f32_bf16 v59, v245, s21, v59
v_dot2_f32_bf16 v60, v246, s20, v60
v_dot2_f32_bf16 v61, v246, s21, v61
v_dot2_f32_bf16 v62, v247, s20, v62
v_dot2_f32_bf16 v63, v247, s21, v63
s_waitcnt vmcnt(10)
v_dot2_f32_bf16 v56, v248, s20, v56
v_dot2_f32_bf16 v57, v248, s21, v57
v_dot2_f32_bf16 v58, v249, s20, v58
v_dot2_f32_bf16 v59, v249, s21, v59
v_dot2_f32_bf16 v60, v250, s20, v60
v_dot2_f32_bf16 v61, v250, s21, v61
v_dot2_f32_bf16 v62, v251, s20, v62
v_dot2_f32_bf16 v63, v251, s21, v63
s_waitcnt vmcnt(9)
v_dot2_f32_bf16 v56, v252, s20, v56
v_dot2_f32_bf16 v57, v252, s21, v57
v_dot2_f32_bf16 v58, v253, s20, v58
v_dot2_f32_bf16 v59, v253, s21, v59
v_dot2_f32_bf16 v60, v254, s20, v60
v_dot2_f32_bf16 v61, v254, s21, v61
v_dot2_f32_bf16 v62, v255, s20, v62
v_dot2_f32_bf16 v63, v255, s21, v63
v_cvt_pk_bf16_f32 v56, v56, v57
v_cvt_pk_bf16_f32 v57, v58, v59
v_cvt_pk_bf16_f32 v58, v60, v61
v_cvt_pk_bf16_f32 v59, v62, v63
s_add_u32 s3, s25, s97
s_lshl_b32 s43, s38, 5
s_add_u32 s3, s3, s43
s_mov_b64 exec, 0xffff
buffer_store_dwordx4 v[56:59], v51, s[32:35], s3 offen
s_mov_b64 exec, -1
s_add_u32 s23, s23, 34816
s_lshl_b32 s3, s67, 3
s_add_u32 s27, s24, s3
s_waitcnt vmcnt(2)
s_mov_b64 exec, 16
buffer_store_dword v25, v25, s[4:7], 0 offen sc1
s_mov_b64 exec, -1
buffer_load_dword v53, v50, s[4:7], s23 offen sc1
s_waitcnt vmcnt(0)
v_cmp_eq_u32 vcc, 0, v53
s_or_b64 vcc, vcc, vcc
s_cbranch_scc1 Lsp_B
Lbk_B:
buffer_load_dwordx4 v[160:163], v12, s[4:7], s27 offen sc1
s_add_u32 s27, s27, 9216
buffer_load_dwordx4 v[164:167], v12, s[4:7], s27 offen sc1
s_add_u32 s27, s27, 9216
buffer_load_dwordx4 v[168:171], v12, s[4:7], s27 offen sc1
s_add_u32 s27, s27, 9216
buffer_load_dwordx4 v[172:175], v12, s[4:7], s27 offen sc1
s_add_u32 s27, s27, 9216
buffer_load_dwordx4 v[176:179], v12, s[4:7], s27 offen sc1
s_add_u32 s27, s27, 9216
buffer_load_dwordx4 v[180:183], v12, s[4:7], s27 offen sc1
s_add_u32 s27, s27, 9216
buffer_load_dwordx4 v[184:187], v12, s[4:7], s27 offen sc1
s_add_u32 s27, s27, 9216
buffer_load_dwordx4 v[188:191], v12, s[4:7], s27 offen sc1
s_add_u32 s27, s27, 9216
s_waitcnt vmcnt(7)
v_dot2_f32_bf16 v64, v160, s20, 0
v_dot2_f32_bf16 v65, v160, s21, 0
v_dot2_f32_bf16 v66, v161, s20, 0
v_dot2_f32_bf16 v67, v161, s21, 0
v_dot2_f32_bf16 v68, v162, s20, 0
v_dot2_f32_bf16 v69, v162, s21, 0
v_dot2_f32_bf16 v70, v163, s20, 0
v_dot2_f32_bf16 v71, v163, s21, 0
s_waitcnt vmcnt(6)
v_dot2_f32_bf16 v64, v164, s20, v64
v_dot2_f32_bf16 v65, v164, s21, v65
v_dot2_f32_bf16 v66, v165, s20, v66
v_dot2_f32_bf16 v67, v165, s21, v67
v_dot2_f32_bf16 v68, v166, s20, v68
v_dot2_f32_bf16 v69, v166, s21, v69
v_dot2_f32_bf16 v70, v167, s20, v70
v_dot2_f32_bf16 v71, v167, s21, v71
s_waitcnt vmcnt(5)
v_dot2_f32_bf16 v64, v168, s20, v64
v_dot2_f32_bf16 v65, v168, s21, v65
v_dot2_f32_bf16 v66, v169, s20, v66
v_dot2_f32_bf16 v67, v169, s21, v67
v_dot2_f32_bf16 v68, v170, s20, v68
v_dot2_f32_bf16 v69, v170, s21, v69
v_dot2_f32_bf16 v70, v171, s20, v70
v_dot2_f32_bf16 v71, v171, s21, v71
s_waitcnt vmcnt(4)
v_dot2_f32_bf16 v64, v172, s20, v64
v_dot2_f32_bf16 v65, v172, s21, v65
v_dot2_f32_bf16 v66, v173, s20, v66
v_dot2_f32_bf16 v67, v173, s21, v67
v_dot2_f32_bf16 v68, v174, s20, v68
v_dot2_f32_bf16 v69, v174, s21, v69
v_dot2_f32_bf16 v70, v175, s20, v70
v_dot2_f32_bf16 v71, v175, s21, v71
s_waitcnt vmcnt(3)
v_dot2_f32_bf16 v64, v176, s20, v64
v_dot2_f32_bf16 v65, v176, s21, v65
v_dot2_f32_bf16 v66, v177, s20, v66
v_dot2_f32_bf16 v67, v177, s21, v67
v_dot2_f32_bf16 v68, v178, s20, v68
v_dot2_f32_bf16 v69, v178, s21, v69
v_dot2_f32_bf16 v70, v179, s20, v70
v_dot2_f32_bf16 v71, v179, s21, v71
s_waitcnt vmcnt(2)
v_dot2_f32_bf16 v64, v180, s20, v64
v_dot2_f32_bf16 v65, v180, s21, v65
v_dot2_f32_bf16 v66, v181, s20, v66
v_dot2_f32_bf16 v67, v181, s21, v67
v_dot2_f32_bf16 v68, v182, s20, v68
v_dot2_f32_bf16 v69, v182, s21, v69
v_dot2_f32_bf16 v70, v183, s20, v70
v_dot2_f32_bf16 v71, v183, s21, v71
s_waitcnt vmcnt(1)
v_dot2_f32_bf16 v64, v184, s20, v64
v_dot2_f32_bf16 v65, v184, s21, v65
v_dot2_f32_bf16 v66, v185, s20, v66
v_dot2_f32_bf16 v67, v185, s21, v67
v_dot2_f32_bf16 v68, v186, s20, v68
v_dot2_f32_bf16 v69, v186, s21, v69
v_dot2_f32_bf16 v70, v187, s20, v70
v_dot2_f32_bf16 v71, v187, s21, v71
s_waitcnt vmcnt(0)
v_dot2_f32_bf16 v64, v188, s20, v64
v_dot2_f32_bf16 v65, v188, s21, v65
v_dot2_f32_bf16 v66, v189, s20, v66
v_dot2_f32_bf16 v67, v189, s21, v67
v_dot2_f32_bf16 v68, v190, s20, v68
v_dot2_f32_bf16 v69, v190, s21, v69
v_dot2_f32_bf16 v70, v191, s20, v70
v_dot2_f32_bf16 v71, v191, s21, v71
v_cvt_pk_bf16_f32 v64, v64, v65
v_cvt_pk_bf16_f32 v65, v66, v67
v_cvt_pk_bf16_f32 v66, v68, v69
v_cvt_pk_bf16_f32 v67, v70, v71
s_add_u32 s3, s25, s67
buffer_store_dwordx4 v[64:67], v51, s[32:35], s3 offen
Lkf_end:
s_endpgm
Lsp_C:
s_mov_b32 s53, 0
Lsl_C:
global_load_dword v68, v66, s[72:73] sc1
s_waitcnt vmcnt(0)
s_add_u32 s53, s53, 1
s_cmp_ge_u32 s53, 20000
s_cbranch_scc1 Lbk_C
v_cmp_gt_u32 vcc, 32, v68
s_or_b64 vcc, vcc, vcc
s_cbranch_scc1 Lsl_C
s_nop 4
s_branch Lbk_C
Lsp_R:
s_mov_b32 s53, 0
Lsl_R:
buffer_load_dword v69, v67, s[4:7], s22 offen sc1
s_waitcnt vmcnt(0)
s_add_u32 s53, s53, 1
s_cmp_ge_u32 s53, 20000
s_cbranch_scc1 Lbk_R
v_cmp_eq_u32 vcc, 0, v69
s_or_b64 vcc, vcc, vcc
s_cbranch_scc1 Lsl_R
s_nop 4
s_branch Lbk_R
Lsp_E:
s_mov_b32 s53, 0
Lsl_E:
buffer_load_dword v68, v66, s[4:7], s22 offen sc1
buffer_load_dword v69, v66, s[4:7], s23 offen sc1
s_waitcnt vmcnt(0)
s_add_u32 s53, s53, 1
s_cmp_ge_u32 s53, 20000
s_cbranch_scc1 Lbk_E
v_cmp_eq_u32 vcc, 0, v68
v_cmp_eq_u32 s[28:29], 0, v69
s_or_b64 vcc, vcc, s[28:29]
s_cbranch_scc1 Lsl_E
s_nop 4
s_branch Lbk_E
Lsp_A:
s_mov_b32 s53, 0
Lsl_A:
buffer_load_dword v53, v50, s[4:7], s23 offen sc1
buffer_load_dword v54, v50, s[4:7], s22 offen sc1
s_waitcnt vmcnt(0)
s_add_u32 s53, s53, 1
s_cmp_ge_u32 s53, 20000
s_cbranch_scc1 Lbk_A
v_cmp_eq_u32 vcc, 0, v53
v_cmp_eq_u32 s[30:31], 0, v54
s_or_b64 vcc, vcc, s[30:31]
s_cbranch_scc1 Lsl_A
s_nop 4
s_branch Lbk_A
Lsp_B:
s_mov_b32 s53, 0
Lsl_B:
buffer_load_dword v53, v50, s[4:7], s23 offen sc1
s_waitcnt vmcnt(0)
s_add_u32 s53, s53, 1
s_cmp_ge_u32 s53, 20000
s_cbranch_scc1 Lbk_B
v_cmp_eq_u32 vcc, 0, v53
s_or_b64 vcc, vcc, vcc
s_cbranch_scc1 Lsl_B
s_nop 4
s_branch Lbk_B
Lkf_last:
s_endpgm
.section .rodata,"a"
.p2align 6
.amdhsa_kernel gated_mix__spectral_gfnet__dense_activation_silu__prompt_kernel
  .amdhsa_next_free_vgpr 512
  .amdhsa_next_free_sgpr 102
  .amdhsa_accum_offset 256
  .amdhsa_group_segment_fixed_size 0
  .amdhsa_kernarg_size 80
  .amdhsa_user_sgpr_count 2
  .amdhsa_user_sgpr_kernarg_segment_ptr 1
  .amdhsa_system_sgpr_workgroup_id_x 1
.end_amdhsa_kernel
```
